```python
import torch

def _softmax(x, axis=-1):
    return torch.softmax(x, dim=axis)
def _gelu(x):
    return torch.nn.functional.gelu(x, approximate="tanh")
def _silu(x):
    return torch.nn.functional.silu(x)
def _sigmoid(x):
    return torch.sigmoid(x)
def _layernorm(x, axis=-1, eps=1e-5):
    m = x.mean(dim=axis, keepdim=True)
    v = x.var(dim=axis, keepdim=True, unbiased=False)
    return (x - m) / torch.sqrt(v + eps)
def _scatter_add(tgt, idx, src, axis=0):
    return tgt.clone().index_add_(axis, idx, src)
def _segment_sum(src, seg, n):
    out = torch.zeros((n,) + src.shape[1:], dtype=src.dtype)
    return out.index_add_(0, seg, src)
def _pad(x, pw):
    flat = tuple(v for pair in reversed(pw) for v in pair)
    return torch.nn.functional.pad(x, flat)

kernel_name = 'recurrent_scan__grouped_kv_mqa__glu_gated_swiglu__prompt'

def setup_inputs():

    _w = (lambda a: (lambda t: t.to(torch.bfloat16) if t.is_floating_point() else t)(torch.as_tensor(a)))
    def _A_setup():
        B, S, D, H = 1, 2048, 576, 32
        Dh = D // H
        return {
            "x": _w((lambda *s: torch.randn(*s, dtype=torch.bfloat16) * 0.05)(B, S, D)),
            "wq": _w((lambda *s: torch.randn(*s, dtype=torch.bfloat16) * 0.2)(D, H * Dh)),
            "wk": _w((lambda *s: torch.randn(*s, dtype=torch.bfloat16) * 0.2)(D, Dh)),
            "wv": _w((lambda *s: torch.randn(*s, dtype=torch.bfloat16) * 0.2)(D, Dh)),
            "wo": _w((lambda *s: torch.randn(*s, dtype=torch.bfloat16) * 0.2)(H * Dh, D)),
        }
    _A_in = _A_setup()

    def _B_setup():
        B, S, D, F = 1, 2048, 576, 4608
        return {
            "x": _w((lambda *s: torch.randn(*s, dtype=torch.bfloat16) * 0.05)(B, S, D)),
            "w1": _w((lambda *s: torch.randn(*s, dtype=torch.bfloat16) * 0.1)(D, F) * (2.0 / D) ** 0.5),
            "w3": _w((lambda *s: torch.randn(*s, dtype=torch.bfloat16) * 0.1)(D, F) * (2.0 / D) ** 0.5),
            "w2": _w((lambda *s: torch.randn(*s, dtype=torch.bfloat16) * 0.1)(F, D) * (2.0 / F) ** 0.5),
        }
    _B_in = _B_setup()

    return {
        "A_x": _A_in["x"],
        "A_wq": _A_in["wq"],
        "A_wk": _A_in["wk"],
        "A_wv": _A_in["wv"],
        "A_wo": _A_in["wo"],
        "B_x": _B_in["x"],
        "B_w1": _B_in["w1"],
        "B_w3": _B_in["w3"],
        "B_w2": _B_in["w2"],
    }

def reference(A_x, A_wq, A_wk, A_wv, A_wo, B_x, B_w1, B_w3, B_w2):
    def _A_ref(x, wq, wk, wv, wo):
        B, S, D = x.shape
        H = 32
        Dh = D // H
        q = (lambda x, *d: x.permute(*d))((x @ wq).reshape(B, S, H, Dh), 0, 2, 1, 3)
        k = x @ wk
        v = x @ wv
        scores = torch.einsum("bhqd,bkd->bhqk", q, k) * (Dh ** -0.5)
        p = _softmax(scores, axis=-1)
        o = torch.einsum("bhqk,bkd->bhqd", p, v)
        return (lambda x, *d: x.permute(*d))(o, 0, 2, 1, 3).reshape(B, S, H * Dh) @ wo

    def _B_ref(x, w1, w3, w2):
        gate = torch.einsum("bsd,df->bsf", x, w1)
        up = torch.einsum("bsd,df->bsf", x, w3)
        h = _silu(gate) * up
        out = torch.einsum("bsf,fd->bsd", h, w2)
        return out

    x = A_x
    xn = _layernorm(x, axis=-1)
    s = _A_ref(xn, A_wq, A_wk, A_wv, A_wo)
    g = _silu(_B_ref(xn, B_w1, B_w3, B_w2))
    return x + s * g
```

```asm
; @launch grid=(256,1,1) block=(512,1,1) lds=163840
.amdgcn_target "amdgcn-amd-amdhsa--gfx950"
.text
.globl recurrent_scan__grouped_kv_mqa__glu_gated_swiglu__prompt_kernel
.p2align 8
.type recurrent_scan__grouped_kv_mqa__glu_gated_swiglu__prompt_kernel,@function
recurrent_scan__grouped_kv_mqa__glu_gated_swiglu__prompt_kernel:
    s_cmp_ge_u32 s2, 256
    s_cbranch_scc1 recurrent_scan__grouped_kv_mqa__glu_gated_swiglu__prompt_kernel_end
    s_load_dwordx2 s[8:9], s[0:1], 0
    s_load_dwordx16 s[32:47], s[0:1], 0
    s_load_dwordx8 s[48:55], s[0:1], 64
    s_mov_b32 s91, 0x100000
    v_lshrrev_b32 v2, 6, v0
    v_and_b32 v1, 63, v0
    s_and_b32 s56, s2, 7
    v_readfirstlane_b32 s3, v2
    s_lshr_b32 s57, s2, 3
    s_and_b32 s7, s56, 3
    s_lshr_b32 s56, s56, 2
    s_lshl_b32 s56, s56, 3
    s_lshr_b32 s4, s57, 2
    s_add_u32 s4, s4, s56
    s_and_b32 s6, s57, 3
    s_lshl_b32 s5, s7, 2
    s_add_u32 s5, s5, s6
    s_and_b32 s58, s4, 7
    s_lshl_b32 s59, s6, 1
    s_add_u32 s58, s58, s59
    s_cmp_ge_u32 s58, 9
    s_cselect_b32 s59, 9, 0
    s_sub_u32 s79, s58, s59
    v_lshlrev_b32 v2, 4, v0
    v_add_u32 v2, 147456, v2
    v_mov_b32 v4, 0
    v_mov_b32 v5, 0
    v_mov_b32 v6, 0
    v_mov_b32 v7, 0
    ds_write_b128 v2, v[4:7]
    s_cmp_lg_u32 s3, 7
    s_cbranch_scc1 pc_skip
    s_getpc_b64 s[64:65]
pc_ref:
    s_sub_u32 s64, s64, pc_ref-recurrent_scan__grouped_kv_mqa__glu_gated_swiglu__prompt_kernel
    s_subb_u32 s65, s65, 0
    s_lshr_b32 s66, s2, 3
    s_and_b32 s66, s66, 7
    s_lshl_b32 s66, s66, 13
    v_lshlrev_b32 v2, 7, v1
    v_add_u32 v2, s66, v2
    v_min_u32 v2, code_end-recurrent_scan__grouped_kv_mqa__glu_gated_swiglu__prompt_kernel-4, v2
    global_load_dword v255, v2, s[64:65]
pc_skip:
    s_and_b32 s60, s3, 3
    s_lshl_b32 s69, s4, 2
    s_add_u32 s69, s69, s60
    v_lshrrev_b32 v15, 3, v1
    v_and_b32 v16, 7, v1
    v_lshrrev_b32 v17, 4, v1
    v_xor_b32 v17, v17, v16
    s_lshl_b32 s58, s69, 5
    v_add_u32 v18, s58, v15
    v_mul_u32_u24 v18, 1152, v18
    v_lshl_add_u32 v22, v17, 4, v18
    v_xor_b32 v23, 64, v22
    v_add_u32 v23, 8192, v23
    v_add_u32 v19, 16384, v22
    v_add_u32 v20, 16384, v23
    s_lshl_b32 s60, s60, 12
    s_cmp_ge_u32 s3, 4
    s_cselect_b32 s56, 0, 1
    s_lshl_b32 s70, s56, 14
    s_add_u32 s70, s70, s60
    s_add_u32 s56, s56, s79
    s_cmp_ge_u32 s56, 9
    s_cselect_b32 s58, 9, 0
    s_sub_u32 s56, s56, s58
    s_lshl_b32 s72, s56, 7
    s_mov_b32 s10, 2359296
    s_mov_b32 s11, 0x00020000
    s_mov_b32 m0, s70
    s_waitcnt lgkmcnt(0)
    buffer_load_dwordx4 v22, s[8:11], s72 offen lds
    buffer_load_dwordx4 v23, s[8:11], s72 offen offset:1024 lds
    buffer_load_dwordx4 v19, s[8:11], s72 offen offset:2048 lds
    buffer_load_dwordx4 v20, s[8:11], s72 offen offset:3072 lds
    s_add_u32 s70, s70, 32768
    s_mov_b32 m0, s70
    s_add_u32 s72, s72, 256
    s_sub_u32 s57, s72, 1152
    s_cselect_b32 s72, s72, s57
    s_barrier
    s_mov_b32 s24, s54
    s_mov_b32 s25, s55
    s_mov_b32 s26, 33127424
    s_mov_b32 s27, 0x00020000
    s_mov_b32 s28, s52
    s_mov_b32 s29, s53
    s_mov_b32 s30, 256
    s_mov_b32 s31, 0x00020000
xl_loop:
    buffer_load_dwordx4 v22, s[8:11], s72 offen lds
    buffer_load_dwordx4 v23, s[8:11], s72 offen offset:1024 lds
    buffer_load_dwordx4 v19, s[8:11], s72 offen offset:2048 lds
    buffer_load_dwordx4 v20, s[8:11], s72 offen offset:3072 lds
    s_add_u32 s70, s70, 32768
    s_mov_b32 m0, s70
    s_add_u32 s72, s72, 256
    s_sub_u32 s57, s72, 1152
    s_cselect_b32 s72, s72, s57
    s_cmp_lt_u32 s70, 147456
    s_cbranch_scc1 xl_loop
    s_cmp_ge_u32 s3, 4
    s_cbranch_scc1 recurrent_scan__grouped_kv_mqa__glu_gated_swiglu__prompt_kernel_attn
    s_setprio 2
    s_lshr_b32 s57, s3, 1
    s_cmp_eq_u32 s57, 0
    s_cselect_b32 s20, s44, s46
    s_cselect_b32 s21, s45, s47
    s_mov_b32 s22, 5308416
    s_mov_b32 s23, 0x00020000
    v_lshrrev_b32 v15, 3, v1
    s_and_b32 s58, s3, 1
    s_lshl_b32 s58, s58, 3
    v_add_u32 v15, s58, v15
    v_bfe_u32 v17, v1, 4, 1
    s_lshr_b32 s58, s58, 2
    v_or_b32 v17, s58, v17
    v_bfe_u32 v18, v1, 1, 2
    v_xor_b32 v17, v17, v18
    v_and_b32 v16, 1, v1
    v_mul_u32_u24 v6, 9216, v15
    v_lshl_add_u32 v6, v17, 5, v6
    v_lshl_add_u32 v6, v16, 4, v6
    s_mul_i32 s58, s5, 576
    s_and_b32 s59, s5, 1
    s_lshl_b32 s59, s59, 6
    s_add_u32 s58, s58, s59
    v_add_u32 v6, s58, v6
    v_lshlrev_b32 v15, 2, v1
    s_lshl_b32 s58, s3, 8
    s_add_u32 s58, s58, 147456
    v_add_u32 v11, s58, v15
    v_and_b32 v16, 7, v1
    v_lshl_add_u32 v12, v16, 8, v15
    v_add_u32 v12, 147456, v12
    v_and_b32 v16, 3, v1
    v_bfe_u32 v15, v1, 4, 1
    v_lshrrev_b32 v17, 5, v1
    v_bfe_u32 v18, v1, 2, 2
    v_lshl_add_u32 v18, v17, 3, v18
    v_lshlrev_b32 v2, 7, v18
    v_lshl_add_u32 v2, v16, 3, v2
    v_mul_u32_u24 v18, 4160, v15
    v_add_u32 v2, v2, v18
    v_bfe_u32 v18, v1, 3, 1
    v_lshl_add_u32 v2, v18, 5, v2
    v_xor_b32 v3, 32, v2
    v_xor_b32 v4, 64, v2
    v_xor_b32 v5, 0x60, v2
    v_lshlrev_b32 v7, 4, v1
    v_and_b32 v15, 15, v1
    v_bfe_u32 v16, v1, 1, 3
    v_lshrrev_b32 v17, 4, v1
    v_xor_b32 v16, v16, v17
    v_lshlrev_b32 v80, 7, v15
    v_lshl_add_u32 v80, v16, 4, v80
    v_add_u32 v80, s60, v80
    v_mov_b32 v13, 1
    v_xor_b32 v81, 64, v80
    s_mov_b32 s67, 0x3f803f80
    v_mov_b32 v48, 0
    v_mov_b32 v52, 0
    v_mov_b32 v49, 0
    v_mov_b32 v53, 0
    v_mov_b32 v50, 0
    v_mov_b32 v54, 0
    v_mov_b32 v51, 0
    v_mov_b32 v55, 0
    s_mul_i32 s58, s79, 589824
    s_mov_b32 s12, s58
    s_add_u32 s13, s58, 146432
    s_add_u32 s14, s58, 292864
    s_add_u32 s15, s58, 439296
    s_add_u32 s58, s58, 589824
    s_cmp_eq_u32 s58, 5308416
    s_cselect_b32 s58, 0, s58
    s_mov_b32 s16, s58
    s_add_u32 s17, s58, 146432
    s_add_u32 s18, s58, 292864
    s_add_u32 s19, s58, 439296
    s_add_u32 s58, s58, 589824
    s_cmp_eq_u32 s58, 5308416
    s_cselect_b32 s58, 0, s58
    s_mov_b32 s32, s58
    s_add_u32 s33, s58, 146432
    s_add_u32 s34, s58, 292864
    s_add_u32 s35, s58, 439296
    s_add_u32 s58, s58, 589824
    s_cmp_eq_u32 s58, 5308416
    s_cselect_b32 s58, 0, s58
    s_mov_b32 s36, s58
    s_add_u32 s37, s58, 146432
    s_add_u32 s38, s58, 292864
    s_add_u32 s39, s58, 439296
    s_add_u32 s58, s58, 589824
    s_cmp_eq_u32 s58, 5308416
    s_cselect_b32 s58, 0, s58
    s_mov_b32 s40, s58
    s_add_u32 s41, s58, 146432
    s_add_u32 s42, s58, 292864
    s_add_u32 s43, s58, 439296
    s_add_u32 s58, s58, 589824
    s_cmp_eq_u32 s58, 5308416
    s_cselect_b32 s58, 0, s58
    s_mov_b32 s44, s58
    s_add_u32 s45, s58, 146432
    s_add_u32 s46, s58, 292864
    s_add_u32 s47, s58, 439296
    s_add_u32 s58, s58, 589824
    s_cmp_eq_u32 s58, 5308416
    s_cselect_b32 s58, 0, s58
    s_mov_b32 s50, s58
    s_add_u32 s51, s58, 146432
    s_add_u32 s52, s58, 292864
    s_add_u32 s53, s58, 439296
    s_add_u32 s58, s58, 589824
    s_cmp_eq_u32 s58, 5308416
    s_cselect_b32 s58, 0, s58
    s_mov_b32 s54, s58
    s_add_u32 s55, s58, 146432
    s_add_u32 s74, s58, 292864
    s_add_u32 s75, s58, 439296
    s_add_u32 s58, s58, 589824
    s_cmp_eq_u32 s58, 5308416
    s_cselect_b32 s58, 0, s58
    s_mov_b32 s76, s58
    s_add_u32 s77, s58, 146432
    s_add_u32 s78, s58, 292864
    s_add_u32 s61, s58, 439296
    v_add_u32 v15, 4096, v11
gm_xa0:
    ds_read_b32 v14, v15
    s_sub_u32 s91, s91, 1
    s_cmp_lt_i32 s91, 0
    s_cbranch_scc1 gm_xa0x
    s_waitcnt lgkmcnt(0)
    v_cmp_gt_u32 vcc, 1, v14
    s_cbranch_vccnz gm_xa0
gm_xa0x:
    s_waitcnt lgkmcnt(0)
    ds_read_b128 v[112:115], v80 offset:0
    ds_read_b128 v[116:119], v80 offset:2048
    ds_read_b128 v[120:123], v81 offset:0
    ds_read_b128 v[124:127], v81 offset:2048
    ds_add_u32 v11, v13 offset:3072
    s_waitcnt vmcnt(12)
    ds_read_b128 v[128:131], v80 offset:16384
    ds_read_b128 v[132:135], v80 offset:18432
    ds_read_b128 v[136:139], v81 offset:16384
    ds_read_b128 v[140:143], v81 offset:18432
    ds_add_u32 v11, v13 offset:3072
    s_waitcnt lgkmcnt(5)
    v_dot2c_f32_bf16 v48, s67, v112
    v_dot2c_f32_bf16 v52, v112, v112
    v_dot2c_f32_bf16 v49, s67, v113
    v_dot2c_f32_bf16 v53, v113, v113
    v_dot2c_f32_bf16 v48, s67, v114
    v_dot2c_f32_bf16 v52, v114, v114
    v_dot2c_f32_bf16 v49, s67, v115
    v_dot2c_f32_bf16 v53, v115, v115
    v_dot2c_f32_bf16 v50, s67, v116
    v_dot2c_f32_bf16 v54, v116, v116
    v_dot2c_f32_bf16 v51, s67, v117
    v_dot2c_f32_bf16 v55, v117, v117
    v_dot2c_f32_bf16 v50, s67, v118
    v_dot2c_f32_bf16 v54, v118, v118
    v_dot2c_f32_bf16 v51, s67, v119
    v_dot2c_f32_bf16 v55, v119, v119
    v_dot2c_f32_bf16 v48, s67, v120
    v_dot2c_f32_bf16 v52, v120, v120
    v_dot2c_f32_bf16 v49, s67, v121
    v_dot2c_f32_bf16 v53, v121, v121
    ds_read_b32 v14, v15
    v_dot2c_f32_bf16 v48, s67, v122
    v_dot2c_f32_bf16 v52, v122, v122
    v_dot2c_f32_bf16 v49, s67, v123
    v_dot2c_f32_bf16 v53, v123, v123
    v_dot2c_f32_bf16 v50, s67, v124
    v_dot2c_f32_bf16 v54, v124, v124
    v_dot2c_f32_bf16 v51, s67, v125
    v_dot2c_f32_bf16 v55, v125, v125
    v_dot2c_f32_bf16 v50, s67, v126
    v_dot2c_f32_bf16 v54, v126, v126
    v_dot2c_f32_bf16 v51, s67, v127
    v_dot2c_f32_bf16 v55, v127, v127
    s_waitcnt lgkmcnt(0)
    v_cmp_gt_u32 vcc, 2, v14
    s_cbranch_vccnz gm_xa2
gm_xa2b:
    ds_read_b128 v[144:147], v80 offset:32768
    ds_read_b128 v[148:151], v80 offset:34816
    ds_read_b128 v[152:155], v81 offset:32768
    ds_read_b128 v[156:159], v81 offset:34816
    ds_add_u32 v11, v13 offset:3072
    s_waitcnt lgkmcnt(5)
    v_dot2c_f32_bf16 v48, s67, v128
    v_dot2c_f32_bf16 v52, v128, v128
    v_dot2c_f32_bf16 v49, s67, v129
    v_dot2c_f32_bf16 v53, v129, v129
    v_dot2c_f32_bf16 v48, s67, v130
    v_dot2c_f32_bf16 v52, v130, v130
    v_dot2c_f32_bf16 v49, s67, v131
    v_dot2c_f32_bf16 v53, v131, v131
    v_dot2c_f32_bf16 v50, s67, v132
    v_dot2c_f32_bf16 v54, v132, v132
    v_dot2c_f32_bf16 v51, s67, v133
    v_dot2c_f32_bf16 v55, v133, v133
    v_dot2c_f32_bf16 v50, s67, v134
    v_dot2c_f32_bf16 v54, v134, v134
    v_dot2c_f32_bf16 v51, s67, v135
    v_dot2c_f32_bf16 v55, v135, v135
    v_dot2c_f32_bf16 v48, s67, v136
    v_dot2c_f32_bf16 v52, v136, v136
    v_dot2c_f32_bf16 v49, s67, v137
    v_dot2c_f32_bf16 v53, v137, v137
    v_dot2c_f32_bf16 v48, s67, v138
    v_dot2c_f32_bf16 v52, v138, v138
    v_dot2c_f32_bf16 v49, s67, v139
    v_dot2c_f32_bf16 v53, v139, v139
    v_dot2c_f32_bf16 v50, s67, v140
    v_dot2c_f32_bf16 v54, v140, v140
    v_dot2c_f32_bf16 v51, s67, v141
    v_dot2c_f32_bf16 v55, v141, v141
    v_dot2c_f32_bf16 v50, s67, v142
    v_dot2c_f32_bf16 v54, v142, v142
    v_dot2c_f32_bf16 v51, s67, v143
    v_dot2c_f32_bf16 v55, v143, v143
    s_waitcnt vmcnt(8)
    ds_read_b128 v[160:163], v80 offset:49152
    ds_read_b128 v[164:167], v80 offset:51200
    ds_read_b128 v[168:171], v81 offset:49152
    ds_read_b128 v[172:175], v81 offset:51200
    ds_add_u32 v11, v13 offset:3072
    v_add_u32 v80, 0x10000, v80
    v_add_u32 v81, 0x10000, v81
    s_waitcnt lgkmcnt(5)
    v_dot2c_f32_bf16 v48, s67, v144
    v_dot2c_f32_bf16 v52, v144, v144
    v_dot2c_f32_bf16 v49, s67, v145
    v_dot2c_f32_bf16 v53, v145, v145
    v_dot2c_f32_bf16 v48, s67, v146
    v_dot2c_f32_bf16 v52, v146, v146
    v_dot2c_f32_bf16 v49, s67, v147
    v_dot2c_f32_bf16 v53, v147, v147
    v_dot2c_f32_bf16 v50, s67, v148
    v_dot2c_f32_bf16 v54, v148, v148
    v_dot2c_f32_bf16 v51, s67, v149
    v_dot2c_f32_bf16 v55, v149, v149
    v_dot2c_f32_bf16 v50, s67, v150
    v_dot2c_f32_bf16 v54, v150, v150
    v_dot2c_f32_bf16 v51, s67, v151
    v_dot2c_f32_bf16 v55, v151, v151
    v_dot2c_f32_bf16 v48, s67, v152
    v_dot2c_f32_bf16 v52, v152, v152
    v_dot2c_f32_bf16 v49, s67, v153
    v_dot2c_f32_bf16 v53, v153, v153
    ds_read_b32 v14, v15
    v_dot2c_f32_bf16 v48, s67, v154
    v_dot2c_f32_bf16 v52, v154, v154
    v_dot2c_f32_bf16 v49, s67, v155
    v_dot2c_f32_bf16 v53, v155, v155
    v_dot2c_f32_bf16 v50, s67, v156
    v_dot2c_f32_bf16 v54, v156, v156
    v_dot2c_f32_bf16 v51, s67, v157
    v_dot2c_f32_bf16 v55, v157, v157
    v_dot2c_f32_bf16 v50, s67, v158
    v_dot2c_f32_bf16 v54, v158, v158
    v_dot2c_f32_bf16 v51, s67, v159
    v_dot2c_f32_bf16 v55, v159, v159
    s_waitcnt lgkmcnt(0)
    v_cmp_gt_u32 vcc, 3, v14
    s_cbranch_vccnz gm_xa4
gm_xa4b:
    ds_read_b128 v[176:179], v80 offset:0
    ds_read_b128 v[180:183], v80 offset:2048
    ds_read_b128 v[184:187], v81 offset:0
    ds_read_b128 v[188:191], v81 offset:2048
    ds_add_u32 v11, v13 offset:3072
    s_waitcnt lgkmcnt(5)
    v_dot2c_f32_bf16 v48, s67, v160
    v_dot2c_f32_bf16 v52, v160, v160
    v_dot2c_f32_bf16 v49, s67, v161
    v_dot2c_f32_bf16 v53, v161, v161
    v_dot2c_f32_bf16 v48, s67, v162
    v_dot2c_f32_bf16 v52, v162, v162
    v_dot2c_f32_bf16 v49, s67, v163
    v_dot2c_f32_bf16 v53, v163, v163
    v_dot2c_f32_bf16 v50, s67, v164
    v_dot2c_f32_bf16 v54, v164, v164
    v_dot2c_f32_bf16 v51, s67, v165
    v_dot2c_f32_bf16 v55, v165, v165
    v_dot2c_f32_bf16 v50, s67, v166
    v_dot2c_f32_bf16 v54, v166, v166
    v_dot2c_f32_bf16 v51, s67, v167
    v_dot2c_f32_bf16 v55, v167, v167
    v_dot2c_f32_bf16 v48, s67, v168
    v_dot2c_f32_bf16 v52, v168, v168
    v_dot2c_f32_bf16 v49, s67, v169
    v_dot2c_f32_bf16 v53, v169, v169
    v_dot2c_f32_bf16 v48, s67, v170
    v_dot2c_f32_bf16 v52, v170, v170
    v_dot2c_f32_bf16 v49, s67, v171
    v_dot2c_f32_bf16 v53, v171, v171
    v_dot2c_f32_bf16 v50, s67, v172
    v_dot2c_f32_bf16 v54, v172, v172
    v_dot2c_f32_bf16 v51, s67, v173
    v_dot2c_f32_bf16 v55, v173, v173
    v_dot2c_f32_bf16 v50, s67, v174
    v_dot2c_f32_bf16 v54, v174, v174
    v_dot2c_f32_bf16 v51, s67, v175
    v_dot2c_f32_bf16 v55, v175, v175
    s_waitcnt vmcnt(4)
    ds_read_b128 v[192:195], v80 offset:16384
    ds_read_b128 v[196:199], v80 offset:18432
    ds_read_b128 v[200:203], v81 offset:16384
    ds_read_b128 v[204:207], v81 offset:18432
    ds_add_u32 v11, v13 offset:3072
    s_waitcnt lgkmcnt(5)
    v_dot2c_f32_bf16 v48, s67, v176
    v_dot2c_f32_bf16 v52, v176, v176
    v_dot2c_f32_bf16 v49, s67, v177
    v_dot2c_f32_bf16 v53, v177, v177
    v_dot2c_f32_bf16 v48, s67, v178
    v_dot2c_f32_bf16 v52, v178, v178
    v_dot2c_f32_bf16 v49, s67, v179
    v_dot2c_f32_bf16 v53, v179, v179
    v_dot2c_f32_bf16 v50, s67, v180
    v_dot2c_f32_bf16 v54, v180, v180
    v_dot2c_f32_bf16 v51, s67, v181
    v_dot2c_f32_bf16 v55, v181, v181
    v_dot2c_f32_bf16 v50, s67, v182
    v_dot2c_f32_bf16 v54, v182, v182
    v_dot2c_f32_bf16 v51, s67, v183
    v_dot2c_f32_bf16 v55, v183, v183
    v_dot2c_f32_bf16 v48, s67, v184
    v_dot2c_f32_bf16 v52, v184, v184
    v_dot2c_f32_bf16 v49, s67, v185
    v_dot2c_f32_bf16 v53, v185, v185
    ds_read_b32 v14, v15
    v_dot2c_f32_bf16 v48, s67, v186
    v_dot2c_f32_bf16 v52, v186, v186
    v_dot2c_f32_bf16 v49, s67, v187
    v_dot2c_f32_bf16 v53, v187, v187
    v_dot2c_f32_bf16 v50, s67, v188
    v_dot2c_f32_bf16 v54, v188, v188
    v_dot2c_f32_bf16 v51, s67, v189
    v_dot2c_f32_bf16 v55, v189, v189
    v_dot2c_f32_bf16 v50, s67, v190
    v_dot2c_f32_bf16 v54, v190, v190
    v_dot2c_f32_bf16 v51, s67, v191
    v_dot2c_f32_bf16 v55, v191, v191
    s_waitcnt lgkmcnt(0)
    v_cmp_gt_u32 vcc, 4, v14
    s_cbranch_vccnz gm_xa6
gm_xa6b:
    ds_read_b128 v[208:211], v80 offset:32768
    ds_read_b128 v[212:215], v80 offset:34816
    ds_read_b128 v[216:219], v81 offset:32768
    ds_read_b128 v[220:223], v81 offset:34816
    ds_add_u32 v11, v13 offset:3072
    s_waitcnt lgkmcnt(5)
    v_dot2c_f32_bf16 v48, s67, v192
    v_dot2c_f32_bf16 v52, v192, v192
    v_dot2c_f32_bf16 v49, s67, v193
    v_dot2c_f32_bf16 v53, v193, v193
    v_dot2c_f32_bf16 v48, s67, v194
    v_dot2c_f32_bf16 v52, v194, v194
    v_dot2c_f32_bf16 v49, s67, v195
    v_dot2c_f32_bf16 v53, v195, v195
    v_dot2c_f32_bf16 v50, s67, v196
    v_dot2c_f32_bf16 v54, v196, v196
    v_dot2c_f32_bf16 v51, s67, v197
    v_dot2c_f32_bf16 v55, v197, v197
    v_dot2c_f32_bf16 v50, s67, v198
    v_dot2c_f32_bf16 v54, v198, v198
    v_dot2c_f32_bf16 v51, s67, v199
    v_dot2c_f32_bf16 v55, v199, v199
    v_dot2c_f32_bf16 v48, s67, v200
    v_dot2c_f32_bf16 v52, v200, v200
    v_dot2c_f32_bf16 v49, s67, v201
    v_dot2c_f32_bf16 v53, v201, v201
    v_dot2c_f32_bf16 v48, s67, v202
    v_dot2c_f32_bf16 v52, v202, v202
    v_dot2c_f32_bf16 v49, s67, v203
    v_dot2c_f32_bf16 v53, v203, v203
    v_dot2c_f32_bf16 v50, s67, v204
    v_dot2c_f32_bf16 v54, v204, v204
    v_dot2c_f32_bf16 v51, s67, v205
    v_dot2c_f32_bf16 v55, v205, v205
    v_dot2c_f32_bf16 v50, s67, v206
    v_dot2c_f32_bf16 v54, v206, v206
    v_dot2c_f32_bf16 v51, s67, v207
    v_dot2c_f32_bf16 v55, v207, v207
    s_waitcnt vmcnt(0)
    ds_read_b128 v[224:227], v80 offset:49152
    ds_read_b128 v[228:231], v80 offset:51200
    ds_read_b128 v[232:235], v81 offset:49152
    ds_read_b128 v[236:239], v81 offset:51200
    ds_add_u32 v11, v13 offset:3072
    v_add_u32 v80, 0x10000, v80
    v_add_u32 v81, 0x10000, v81
    s_waitcnt lgkmcnt(5)
    v_dot2c_f32_bf16 v48, s67, v208
    v_dot2c_f32_bf16 v52, v208, v208
    v_dot2c_f32_bf16 v49, s67, v209
    v_dot2c_f32_bf16 v53, v209, v209
    v_dot2c_f32_bf16 v48, s67, v210
    v_dot2c_f32_bf16 v52, v210, v210
    v_dot2c_f32_bf16 v49, s67, v211
    v_dot2c_f32_bf16 v53, v211, v211
    v_dot2c_f32_bf16 v50, s67, v212
    v_dot2c_f32_bf16 v54, v212, v212
    v_dot2c_f32_bf16 v51, s67, v213
    v_dot2c_f32_bf16 v55, v213, v213
    v_dot2c_f32_bf16 v50, s67, v214
    v_dot2c_f32_bf16 v54, v214, v214
    v_dot2c_f32_bf16 v51, s67, v215
    v_dot2c_f32_bf16 v55, v215, v215
    v_dot2c_f32_bf16 v48, s67, v216
    v_dot2c_f32_bf16 v52, v216, v216
    v_dot2c_f32_bf16 v49, s67, v217
    v_dot2c_f32_bf16 v53, v217, v217
    ds_read_b32 v14, v15
    v_dot2c_f32_bf16 v48, s67, v218
    v_dot2c_f32_bf16 v52, v218, v218
    v_dot2c_f32_bf16 v49, s67, v219
    v_dot2c_f32_bf16 v53, v219, v219
    v_dot2c_f32_bf16 v50, s67, v220
    v_dot2c_f32_bf16 v54, v220, v220
    v_dot2c_f32_bf16 v51, s67, v221
    v_dot2c_f32_bf16 v55, v221, v221
    v_dot2c_f32_bf16 v50, s67, v222
    v_dot2c_f32_bf16 v54, v222, v222
    v_dot2c_f32_bf16 v51, s67, v223
    v_dot2c_f32_bf16 v55, v223, v223
    s_waitcnt lgkmcnt(0)
    v_cmp_gt_u32 vcc, 5, v14
    s_cbranch_vccnz gm_xa8
gm_xa8b:
    ds_read_b128 v[240:243], v80 offset:0
    ds_read_b128 v[244:247], v80 offset:2048
    ds_read_b128 v[248:251], v81 offset:0
    ds_read_b128 v[252:255], v81 offset:2048
    ds_add_u32 v11, v13 offset:3072
    ds_write_b32 v11, v13
    s_waitcnt lgkmcnt(6)
    v_dot2c_f32_bf16 v48, s67, v224
    v_dot2c_f32_bf16 v52, v224, v224
    v_dot2c_f32_bf16 v49, s67, v225
    v_dot2c_f32_bf16 v53, v225, v225
    v_dot2c_f32_bf16 v48, s67, v226
    v_dot2c_f32_bf16 v52, v226, v226
    v_dot2c_f32_bf16 v49, s67, v227
    v_dot2c_f32_bf16 v53, v227, v227
    v_dot2c_f32_bf16 v50, s67, v228
    v_dot2c_f32_bf16 v54, v228, v228
    v_dot2c_f32_bf16 v51, s67, v229
    v_dot2c_f32_bf16 v55, v229, v229
    v_dot2c_f32_bf16 v50, s67, v230
    v_dot2c_f32_bf16 v54, v230, v230
    v_dot2c_f32_bf16 v51, s67, v231
    v_dot2c_f32_bf16 v55, v231, v231
    v_dot2c_f32_bf16 v48, s67, v232
    v_dot2c_f32_bf16 v52, v232, v232
    v_dot2c_f32_bf16 v49, s67, v233
    v_dot2c_f32_bf16 v53, v233, v233
    v_dot2c_f32_bf16 v48, s67, v234
    v_dot2c_f32_bf16 v52, v234, v234
    v_dot2c_f32_bf16 v49, s67, v235
    v_dot2c_f32_bf16 v53, v235, v235
    v_dot2c_f32_bf16 v50, s67, v236
    v_dot2c_f32_bf16 v54, v236, v236
    v_dot2c_f32_bf16 v51, s67, v237
    v_dot2c_f32_bf16 v55, v237, v237
    v_dot2c_f32_bf16 v50, s67, v238
    v_dot2c_f32_bf16 v54, v238, v238
    v_dot2c_f32_bf16 v51, s67, v239
    v_dot2c_f32_bf16 v55, v239, v239
    s_waitcnt lgkmcnt(0)
    v_dot2c_f32_bf16 v48, s67, v240
    v_dot2c_f32_bf16 v52, v240, v240
    v_dot2c_f32_bf16 v49, s67, v241
    v_dot2c_f32_bf16 v53, v241, v241
    v_dot2c_f32_bf16 v48, s67, v242
    v_dot2c_f32_bf16 v52, v242, v242
    v_dot2c_f32_bf16 v49, s67, v243
    v_dot2c_f32_bf16 v53, v243, v243
    v_dot2c_f32_bf16 v50, s67, v244
    v_dot2c_f32_bf16 v54, v244, v244
    v_dot2c_f32_bf16 v51, s67, v245
    v_dot2c_f32_bf16 v55, v245, v245
    v_dot2c_f32_bf16 v50, s67, v246
    v_dot2c_f32_bf16 v54, v246, v246
    v_dot2c_f32_bf16 v51, s67, v247
    v_dot2c_f32_bf16 v55, v247, v247
    v_dot2c_f32_bf16 v48, s67, v248
    v_dot2c_f32_bf16 v52, v248, v248
    v_dot2c_f32_bf16 v49, s67, v249
    v_dot2c_f32_bf16 v53, v249, v249
    v_dot2c_f32_bf16 v48, s67, v250
    v_dot2c_f32_bf16 v52, v250, v250
    v_dot2c_f32_bf16 v49, s67, v251
    v_dot2c_f32_bf16 v53, v251, v251
    v_dot2c_f32_bf16 v50, s67, v252
    v_dot2c_f32_bf16 v54, v252, v252
    v_dot2c_f32_bf16 v51, s67, v253
    v_dot2c_f32_bf16 v55, v253, v253
    v_dot2c_f32_bf16 v50, s67, v254
    v_dot2c_f32_bf16 v54, v254, v254
    v_dot2c_f32_bf16 v51, s67, v255
    v_dot2c_f32_bf16 v55, v255, v255
    s_mov_b32 s64, 1
    s_nop 1
    v_add_f32 v48, v48, v49
    v_add_f32 v50, v50, v51
    v_add_f32 v52, v52, v53
    v_add_f32 v54, v54, v55
    v_mov_b32 v49, v48
    v_mov_b32 v51, v50
    v_mov_b32 v53, v52
    v_mov_b32 v55, v54
    s_nop 0
    v_permlane32_swap_b32 v48, v49
    v_permlane32_swap_b32 v50, v51
    v_permlane32_swap_b32 v52, v53
    v_permlane32_swap_b32 v54, v55
    v_add_f32 v48, v48, v49
    v_add_f32 v50, v50, v51
    v_add_f32 v52, v52, v53
    v_add_f32 v54, v54, v55
    v_mov_b32 v49, v48
    v_mov_b32 v51, v50
    v_mov_b32 v53, v52
    v_mov_b32 v55, v54
    s_nop 0
    v_permlane16_swap_b32 v48, v49
    v_permlane16_swap_b32 v50, v51
    v_permlane16_swap_b32 v52, v53
    v_permlane16_swap_b32 v54, v55
    v_add_f32 v48, v48, v49
    v_add_f32 v50, v50, v51
    v_add_f32 v52, v52, v53
    v_add_f32 v54, v54, v55
    v_mul_f32 v56, 0xbae38e39, v48
    v_mul_f32 v57, 0xbae38e39, v50
    v_mul_f32 v52, 0x3ae38e39, v52
    v_mul_f32 v54, 0x3ae38e39, v54
    v_fma_f32 v52, -v56, v56, v52
    v_fma_f32 v54, -v57, v57, v54
    v_max_f32 v52, 0, v52
    v_max_f32 v54, 0, v54
    v_add_f32 v9, 0x3727c5ac, v52
    v_add_f32 v8, 0x3727c5ac, v54
    v_rsq_f32 v10, v9
    v_rsq_f32 v0, v8
    v_cmp_lt_u32 vcc, 0, v1
    v_bfrev_b32 v15, 1
    v_mul_f32 v58, 0x3fb8aa3b, v10
    v_mul_f32 v59, 0x3fb8aa3b, v0
    v_cvt_pk_bf16_f32 v58, v58, 0
    v_cvt_pk_bf16_f32 v59, v59, 0
    v_cndmask_b32 v23, 0, v15, vcc
    v_lshlrev_b32 v60, 16, v58
    v_lshlrev_b32 v61, 16, v59
    v_rcp_f32 v17, v60
    v_rcp_f32 v18, v61
    v_mul_f32 v56, v56, v60
    v_mul_f32 v57, v57, v61
    v_mul_f32 v9, v9, v60
    v_mul_f32 v8, v8, v61
    v_mul_f32 v10, v10, v17
    v_mul_f32 v0, v0, v18
    v_mul_f32 v9, v9, v60
    v_mul_f32 v8, v8, v61
    v_dot2_f32_bf16 v80, v112, v58, v56
    v_dot2_f32_bf16 v81, v112, v60, v56
    v_dot2_f32_bf16 v82, v113, v58, v56
    v_dot2_f32_bf16 v83, v113, v60, v56
    v_dot2_f32_bf16 v84, v114, v58, v56
    v_dot2_f32_bf16 v85, v114, v60, v56
    v_dot2_f32_bf16 v86, v115, v58, v56
    v_dot2_f32_bf16 v87, v115, v60, v56
    v_dot2_f32_bf16 v88, v116, v59, v57
    v_dot2_f32_bf16 v89, v116, v61, v57
    v_cvt_pk_bf16_f32 v112, v80, v81
    v_dot2_f32_bf16 v90, v117, v59, v57
    v_dot2_f32_bf16 v91, v117, v61, v57
    v_cvt_pk_bf16_f32 v113, v82, v83
    v_dot2_f32_bf16 v92, v118, v59, v57
    v_dot2_f32_bf16 v93, v118, v61, v57
    v_cvt_pk_bf16_f32 v114, v84, v85
    v_dot2_f32_bf16 v94, v119, v59, v57
    v_dot2_f32_bf16 v95, v119, v61, v57
    v_cvt_pk_bf16_f32 v115, v86, v87
    v_dot2_f32_bf16 v80, v120, v58, v56
    v_dot2_f32_bf16 v81, v120, v60, v56
    v_cvt_pk_bf16_f32 v116, v88, v89
    v_dot2_f32_bf16 v82, v121, v58, v56
    v_dot2_f32_bf16 v83, v121, v60, v56
    v_cvt_pk_bf16_f32 v117, v90, v91
    v_dot2_f32_bf16 v84, v122, v58, v56
    v_dot2_f32_bf16 v85, v122, v60, v56
    v_cvt_pk_bf16_f32 v118, v92, v93
    v_dot2_f32_bf16 v86, v123, v58, v56
    v_dot2_f32_bf16 v87, v123, v60, v56
    v_cvt_pk_bf16_f32 v119, v94, v95
    v_dot2_f32_bf16 v88, v124, v59, v57
    v_dot2_f32_bf16 v89, v124, v61, v57
    v_cvt_pk_bf16_f32 v120, v80, v81
    v_dot2_f32_bf16 v90, v125, v59, v57
    v_dot2_f32_bf16 v91, v125, v61, v57
    v_cvt_pk_bf16_f32 v121, v82, v83
    v_dot2_f32_bf16 v92, v126, v59, v57
    v_dot2_f32_bf16 v93, v126, v61, v57
    v_cvt_pk_bf16_f32 v122, v84, v85
    v_dot2_f32_bf16 v94, v127, v59, v57
    v_dot2_f32_bf16 v95, v127, v61, v57
    v_cvt_pk_bf16_f32 v123, v86, v87
    v_dot2_f32_bf16 v80, v128, v58, v56
    v_dot2_f32_bf16 v81, v128, v60, v56
    v_cvt_pk_bf16_f32 v124, v88, v89
    v_dot2_f32_bf16 v82, v129, v58, v56
    v_dot2_f32_bf16 v83, v129, v60, v56
    v_cvt_pk_bf16_f32 v125, v90, v91
    v_dot2_f32_bf16 v84, v130, v58, v56
    v_dot2_f32_bf16 v85, v130, v60, v56
    v_cvt_pk_bf16_f32 v126, v92, v93
    v_dot2_f32_bf16 v86, v131, v58, v56
    v_dot2_f32_bf16 v87, v131, v60, v56
    v_cvt_pk_bf16_f32 v127, v94, v95
    v_dot2_f32_bf16 v88, v132, v59, v57
    v_dot2_f32_bf16 v89, v132, v61, v57
    v_cvt_pk_bf16_f32 v128, v80, v81
    v_dot2_f32_bf16 v90, v133, v59, v57
    v_dot2_f32_bf16 v91, v133, v61, v57
    v_cvt_pk_bf16_f32 v129, v82, v83
    v_dot2_f32_bf16 v92, v134, v59, v57
    v_dot2_f32_bf16 v93, v134, v61, v57
    v_cvt_pk_bf16_f32 v130, v84, v85
    v_dot2_f32_bf16 v94, v135, v59, v57
    v_dot2_f32_bf16 v95, v135, v61, v57
    v_cvt_pk_bf16_f32 v131, v86, v87
    v_dot2_f32_bf16 v80, v136, v58, v56
    v_dot2_f32_bf16 v81, v136, v60, v56
    v_cvt_pk_bf16_f32 v132, v88, v89
    v_dot2_f32_bf16 v82, v137, v58, v56
    v_dot2_f32_bf16 v83, v137, v60, v56
    v_cvt_pk_bf16_f32 v133, v90, v91
    v_dot2_f32_bf16 v84, v138, v58, v56
    v_dot2_f32_bf16 v85, v138, v60, v56
    v_cvt_pk_bf16_f32 v134, v92, v93
    v_dot2_f32_bf16 v86, v139, v58, v56
    v_dot2_f32_bf16 v87, v139, v60, v56
    v_cvt_pk_bf16_f32 v135, v94, v95
    v_dot2_f32_bf16 v88, v140, v59, v57
    v_dot2_f32_bf16 v89, v140, v61, v57
    v_cvt_pk_bf16_f32 v136, v80, v81
    v_dot2_f32_bf16 v90, v141, v59, v57
    v_dot2_f32_bf16 v91, v141, v61, v57
    v_cvt_pk_bf16_f32 v137, v82, v83
    v_dot2_f32_bf16 v92, v142, v59, v57
    v_dot2_f32_bf16 v93, v142, v61, v57
    v_cvt_pk_bf16_f32 v138, v84, v85
    v_dot2_f32_bf16 v94, v143, v59, v57
    v_dot2_f32_bf16 v95, v143, v61, v57
    v_cvt_pk_bf16_f32 v139, v86, v87
    v_dot2_f32_bf16 v80, v144, v58, v56
    v_dot2_f32_bf16 v81, v144, v60, v56
    v_cvt_pk_bf16_f32 v140, v88, v89
    v_dot2_f32_bf16 v82, v145, v58, v56
    v_dot2_f32_bf16 v83, v145, v60, v56
    v_cvt_pk_bf16_f32 v141, v90, v91
    v_dot2_f32_bf16 v84, v146, v58, v56
    v_dot2_f32_bf16 v85, v146, v60, v56
    v_cvt_pk_bf16_f32 v142, v92, v93
    v_dot2_f32_bf16 v86, v147, v58, v56
    v_dot2_f32_bf16 v87, v147, v60, v56
    v_cvt_pk_bf16_f32 v143, v94, v95
    v_dot2_f32_bf16 v88, v148, v59, v57
    v_dot2_f32_bf16 v89, v148, v61, v57
    v_cvt_pk_bf16_f32 v144, v80, v81
    v_dot2_f32_bf16 v90, v149, v59, v57
    v_dot2_f32_bf16 v91, v149, v61, v57
    v_cvt_pk_bf16_f32 v145, v82, v83
    v_dot2_f32_bf16 v92, v150, v59, v57
    v_dot2_f32_bf16 v93, v150, v61, v57
    v_cvt_pk_bf16_f32 v146, v84, v85
    v_dot2_f32_bf16 v94, v151, v59, v57
    v_dot2_f32_bf16 v95, v151, v61, v57
    v_cvt_pk_bf16_f32 v147, v86, v87
    v_dot2_f32_bf16 v80, v152, v58, v56
    v_dot2_f32_bf16 v81, v152, v60, v56
    v_cvt_pk_bf16_f32 v148, v88, v89
    v_dot2_f32_bf16 v82, v153, v58, v56
    v_dot2_f32_bf16 v83, v153, v60, v56
    v_cvt_pk_bf16_f32 v149, v90, v91
    v_dot2_f32_bf16 v84, v154, v58, v56
    v_dot2_f32_bf16 v85, v154, v60, v56
    v_cvt_pk_bf16_f32 v150, v92, v93
    v_dot2_f32_bf16 v86, v155, v58, v56
    v_dot2_f32_bf16 v87, v155, v60, v56
    v_cvt_pk_bf16_f32 v151, v94, v95
    v_dot2_f32_bf16 v88, v156, v59, v57
    v_dot2_f32_bf16 v89, v156, v61, v57
    v_cvt_pk_bf16_f32 v152, v80, v81
    v_dot2_f32_bf16 v90, v157, v59, v57
    v_dot2_f32_bf16 v91, v157, v61, v57
    v_cvt_pk_bf16_f32 v153, v82, v83
    v_dot2_f32_bf16 v92, v158, v59, v57
    v_dot2_f32_bf16 v93, v158, v61, v57
    v_cvt_pk_bf16_f32 v154, v84, v85
    v_dot2_f32_bf16 v94, v159, v59, v57
    v_dot2_f32_bf16 v95, v159, v61, v57
    v_cvt_pk_bf16_f32 v155, v86, v87
    v_dot2_f32_bf16 v80, v160, v58, v56
    v_dot2_f32_bf16 v81, v160, v60, v56
    v_cvt_pk_bf16_f32 v156, v88, v89
    v_dot2_f32_bf16 v82, v161, v58, v56
    v_dot2_f32_bf16 v83, v161, v60, v56
    v_cvt_pk_bf16_f32 v157, v90, v91
    v_dot2_f32_bf16 v84, v162, v58, v56
    v_dot2_f32_bf16 v85, v162, v60, v56
    v_cvt_pk_bf16_f32 v158, v92, v93
    v_dot2_f32_bf16 v86, v163, v58, v56
    v_dot2_f32_bf16 v87, v163, v60, v56
    v_cvt_pk_bf16_f32 v159, v94, v95
    v_dot2_f32_bf16 v88, v164, v59, v57
    v_dot2_f32_bf16 v89, v164, v61, v57
    v_cvt_pk_bf16_f32 v160, v80, v81
    v_dot2_f32_bf16 v90, v165, v59, v57
    v_dot2_f32_bf16 v91, v165, v61, v57
    v_cvt_pk_bf16_f32 v161, v82, v83
    v_dot2_f32_bf16 v92, v166, v59, v57
    v_dot2_f32_bf16 v93, v166, v61, v57
    v_cvt_pk_bf16_f32 v162, v84, v85
    v_dot2_f32_bf16 v94, v167, v59, v57
    v_dot2_f32_bf16 v95, v167, v61, v57
    v_cvt_pk_bf16_f32 v163, v86, v87
    v_dot2_f32_bf16 v80, v168, v58, v56
    v_dot2_f32_bf16 v81, v168, v60, v56
    v_cvt_pk_bf16_f32 v164, v88, v89
    v_dot2_f32_bf16 v82, v169, v58, v56
    v_dot2_f32_bf16 v83, v169, v60, v56
    v_cvt_pk_bf16_f32 v165, v90, v91
    v_dot2_f32_bf16 v84, v170, v58, v56
    v_dot2_f32_bf16 v85, v170, v60, v56
    v_cvt_pk_bf16_f32 v166, v92, v93
    v_dot2_f32_bf16 v86, v171, v58, v56
    v_dot2_f32_bf16 v87, v171, v60, v56
    v_cvt_pk_bf16_f32 v167, v94, v95
    v_dot2_f32_bf16 v88, v172, v59, v57
    v_dot2_f32_bf16 v89, v172, v61, v57
    v_cvt_pk_bf16_f32 v168, v80, v81
    v_dot2_f32_bf16 v90, v173, v59, v57
    v_dot2_f32_bf16 v91, v173, v61, v57
    v_cvt_pk_bf16_f32 v169, v82, v83
    v_dot2_f32_bf16 v92, v174, v59, v57
    v_dot2_f32_bf16 v93, v174, v61, v57
    v_cvt_pk_bf16_f32 v170, v84, v85
    v_dot2_f32_bf16 v94, v175, v59, v57
    v_dot2_f32_bf16 v95, v175, v61, v57
    v_cvt_pk_bf16_f32 v171, v86, v87
    v_dot2_f32_bf16 v80, v176, v58, v56
    v_dot2_f32_bf16 v81, v176, v60, v56
    v_cvt_pk_bf16_f32 v172, v88, v89
    v_dot2_f32_bf16 v82, v177, v58, v56
    v_dot2_f32_bf16 v83, v177, v60, v56
    v_cvt_pk_bf16_f32 v173, v90, v91
    v_dot2_f32_bf16 v84, v178, v58, v56
    v_dot2_f32_bf16 v85, v178, v60, v56
    v_cvt_pk_bf16_f32 v174, v92, v93
    v_dot2_f32_bf16 v86, v179, v58, v56
    v_dot2_f32_bf16 v87, v179, v60, v56
    v_cvt_pk_bf16_f32 v175, v94, v95
    v_dot2_f32_bf16 v88, v180, v59, v57
    v_dot2_f32_bf16 v89, v180, v61, v57
    v_cvt_pk_bf16_f32 v176, v80, v81
    v_dot2_f32_bf16 v90, v181, v59, v57
    v_dot2_f32_bf16 v91, v181, v61, v57
    v_cvt_pk_bf16_f32 v177, v82, v83
    v_dot2_f32_bf16 v92, v182, v59, v57
    v_dot2_f32_bf16 v93, v182, v61, v57
    v_cvt_pk_bf16_f32 v178, v84, v85
    v_dot2_f32_bf16 v94, v183, v59, v57
    v_dot2_f32_bf16 v95, v183, v61, v57
    v_cvt_pk_bf16_f32 v179, v86, v87
    v_dot2_f32_bf16 v80, v184, v58, v56
    v_dot2_f32_bf16 v81, v184, v60, v56
    v_cvt_pk_bf16_f32 v180, v88, v89
    v_dot2_f32_bf16 v82, v185, v58, v56
    v_dot2_f32_bf16 v83, v185, v60, v56
    v_cvt_pk_bf16_f32 v181, v90, v91
    v_dot2_f32_bf16 v84, v186, v58, v56
    v_dot2_f32_bf16 v85, v186, v60, v56
    v_cvt_pk_bf16_f32 v182, v92, v93
    v_dot2_f32_bf16 v86, v187, v58, v56
    v_dot2_f32_bf16 v87, v187, v60, v56
    v_cvt_pk_bf16_f32 v183, v94, v95
    v_dot2_f32_bf16 v88, v188, v59, v57
    v_dot2_f32_bf16 v89, v188, v61, v57
    v_cvt_pk_bf16_f32 v184, v80, v81
    v_dot2_f32_bf16 v90, v189, v59, v57
    v_dot2_f32_bf16 v91, v189, v61, v57
    v_cvt_pk_bf16_f32 v185, v82, v83
    v_dot2_f32_bf16 v92, v190, v59, v57
    v_dot2_f32_bf16 v93, v190, v61, v57
    v_cvt_pk_bf16_f32 v186, v84, v85
    v_dot2_f32_bf16 v94, v191, v59, v57
    v_dot2_f32_bf16 v95, v191, v61, v57
    v_cvt_pk_bf16_f32 v187, v86, v87
    v_dot2_f32_bf16 v80, v192, v58, v56
    v_dot2_f32_bf16 v81, v192, v60, v56
    v_cvt_pk_bf16_f32 v188, v88, v89
    v_dot2_f32_bf16 v82, v193, v58, v56
    v_dot2_f32_bf16 v83, v193, v60, v56
    v_cvt_pk_bf16_f32 v189, v90, v91
    v_dot2_f32_bf16 v84, v194, v58, v56
    v_dot2_f32_bf16 v85, v194, v60, v56
    v_cvt_pk_bf16_f32 v190, v92, v93
    v_dot2_f32_bf16 v86, v195, v58, v56
    v_dot2_f32_bf16 v87, v195, v60, v56
    v_cvt_pk_bf16_f32 v191, v94, v95
    v_dot2_f32_bf16 v88, v196, v59, v57
    v_dot2_f32_bf16 v89, v196, v61, v57
    v_cvt_pk_bf16_f32 v192, v80, v81
    v_dot2_f32_bf16 v90, v197, v59, v57
    v_dot2_f32_bf16 v91, v197, v61, v57
    v_cvt_pk_bf16_f32 v193, v82, v83
    v_dot2_f32_bf16 v92, v198, v59, v57
    v_dot2_f32_bf16 v93, v198, v61, v57
    v_cvt_pk_bf16_f32 v194, v84, v85
    v_dot2_f32_bf16 v94, v199, v59, v57
    v_dot2_f32_bf16 v95, v199, v61, v57
    v_cvt_pk_bf16_f32 v195, v86, v87
    v_dot2_f32_bf16 v80, v200, v58, v56
    v_dot2_f32_bf16 v81, v200, v60, v56
    v_cvt_pk_bf16_f32 v196, v88, v89
    v_dot2_f32_bf16 v82, v201, v58, v56
    v_dot2_f32_bf16 v83, v201, v60, v56
    v_cvt_pk_bf16_f32 v197, v90, v91
    v_dot2_f32_bf16 v84, v202, v58, v56
    v_dot2_f32_bf16 v85, v202, v60, v56
    v_cvt_pk_bf16_f32 v198, v92, v93
    v_dot2_f32_bf16 v86, v203, v58, v56
    v_dot2_f32_bf16 v87, v203, v60, v56
    v_cvt_pk_bf16_f32 v199, v94, v95
    v_dot2_f32_bf16 v88, v204, v59, v57
    v_dot2_f32_bf16 v89, v204, v61, v57
    v_cvt_pk_bf16_f32 v200, v80, v81
    v_dot2_f32_bf16 v90, v205, v59, v57
    v_dot2_f32_bf16 v91, v205, v61, v57
    v_cvt_pk_bf16_f32 v201, v82, v83
    v_dot2_f32_bf16 v92, v206, v59, v57
    v_dot2_f32_bf16 v93, v206, v61, v57
    v_cvt_pk_bf16_f32 v202, v84, v85
    v_dot2_f32_bf16 v94, v207, v59, v57
    v_dot2_f32_bf16 v95, v207, v61, v57
    v_cvt_pk_bf16_f32 v203, v86, v87
    v_dot2_f32_bf16 v80, v208, v58, v56
    v_dot2_f32_bf16 v81, v208, v60, v56
    v_cvt_pk_bf16_f32 v204, v88, v89
    v_dot2_f32_bf16 v82, v209, v58, v56
    v_dot2_f32_bf16 v83, v209, v60, v56
    v_cvt_pk_bf16_f32 v205, v90, v91
    v_dot2_f32_bf16 v84, v210, v58, v56
    v_dot2_f32_bf16 v85, v210, v60, v56
    v_cvt_pk_bf16_f32 v206, v92, v93
    v_dot2_f32_bf16 v86, v211, v58, v56
    v_dot2_f32_bf16 v87, v211, v60, v56
    v_cvt_pk_bf16_f32 v207, v94, v95
    v_dot2_f32_bf16 v88, v212, v59, v57
    v_dot2_f32_bf16 v89, v212, v61, v57
    v_cvt_pk_bf16_f32 v208, v80, v81
    v_dot2_f32_bf16 v90, v213, v59, v57
    v_dot2_f32_bf16 v91, v213, v61, v57
    v_cvt_pk_bf16_f32 v209, v82, v83
    v_dot2_f32_bf16 v92, v214, v59, v57
    v_dot2_f32_bf16 v93, v214, v61, v57
    v_cvt_pk_bf16_f32 v210, v84, v85
    v_dot2_f32_bf16 v94, v215, v59, v57
    v_dot2_f32_bf16 v95, v215, v61, v57
    v_cvt_pk_bf16_f32 v211, v86, v87
    v_dot2_f32_bf16 v80, v216, v58, v56
    v_dot2_f32_bf16 v81, v216, v60, v56
    v_cvt_pk_bf16_f32 v212, v88, v89
    v_dot2_f32_bf16 v82, v217, v58, v56
    v_dot2_f32_bf16 v83, v217, v60, v56
    v_cvt_pk_bf16_f32 v213, v90, v91
    v_dot2_f32_bf16 v84, v218, v58, v56
    v_dot2_f32_bf16 v85, v218, v60, v56
    v_cvt_pk_bf16_f32 v214, v92, v93
    v_dot2_f32_bf16 v86, v219, v58, v56
    v_dot2_f32_bf16 v87, v219, v60, v56
    v_cvt_pk_bf16_f32 v215, v94, v95
    v_dot2_f32_bf16 v88, v220, v59, v57
    v_dot2_f32_bf16 v89, v220, v61, v57
    v_cvt_pk_bf16_f32 v216, v80, v81
    v_dot2_f32_bf16 v90, v221, v59, v57
    v_dot2_f32_bf16 v91, v221, v61, v57
    v_cvt_pk_bf16_f32 v217, v82, v83
    v_dot2_f32_bf16 v92, v222, v59, v57
    v_dot2_f32_bf16 v93, v222, v61, v57
    v_cvt_pk_bf16_f32 v218, v84, v85
    v_dot2_f32_bf16 v94, v223, v59, v57
    v_dot2_f32_bf16 v95, v223, v61, v57
    v_cvt_pk_bf16_f32 v219, v86, v87
    v_dot2_f32_bf16 v80, v224, v58, v56
    v_dot2_f32_bf16 v81, v224, v60, v56
    v_cvt_pk_bf16_f32 v220, v88, v89
    v_dot2_f32_bf16 v82, v225, v58, v56
    v_dot2_f32_bf16 v83, v225, v60, v56
    v_cvt_pk_bf16_f32 v221, v90, v91
    v_dot2_f32_bf16 v84, v226, v58, v56
    v_dot2_f32_bf16 v85, v226, v60, v56
    v_cvt_pk_bf16_f32 v222, v92, v93
    v_dot2_f32_bf16 v86, v227, v58, v56
    v_dot2_f32_bf16 v87, v227, v60, v56
    v_cvt_pk_bf16_f32 v223, v94, v95
    v_dot2_f32_bf16 v88, v228, v59, v57
    v_dot2_f32_bf16 v89, v228, v61, v57
    v_cvt_pk_bf16_f32 v224, v80, v81
    v_dot2_f32_bf16 v90, v229, v59, v57
    v_dot2_f32_bf16 v91, v229, v61, v57
    v_cvt_pk_bf16_f32 v225, v82, v83
    v_dot2_f32_bf16 v92, v230, v59, v57
    v_dot2_f32_bf16 v93, v230, v61, v57
    v_cvt_pk_bf16_f32 v226, v84, v85
    v_dot2_f32_bf16 v94, v231, v59, v57
    v_dot2_f32_bf16 v95, v231, v61, v57
    v_cvt_pk_bf16_f32 v227, v86, v87
    v_dot2_f32_bf16 v80, v232, v58, v56
    v_dot2_f32_bf16 v81, v232, v60, v56
    v_cvt_pk_bf16_f32 v228, v88, v89
    v_dot2_f32_bf16 v82, v233, v58, v56
    v_dot2_f32_bf16 v83, v233, v60, v56
    v_cvt_pk_bf16_f32 v229, v90, v91
    v_dot2_f32_bf16 v84, v234, v58, v56
    v_dot2_f32_bf16 v85, v234, v60, v56
    v_cvt_pk_bf16_f32 v230, v92, v93
    v_dot2_f32_bf16 v86, v235, v58, v56
    v_dot2_f32_bf16 v87, v235, v60, v56
    v_cvt_pk_bf16_f32 v231, v94, v95
    v_dot2_f32_bf16 v88, v236, v59, v57
    v_dot2_f32_bf16 v89, v236, v61, v57
    v_cvt_pk_bf16_f32 v232, v80, v81
    v_dot2_f32_bf16 v90, v237, v59, v57
    v_dot2_f32_bf16 v91, v237, v61, v57
    v_cvt_pk_bf16_f32 v233, v82, v83
    v_dot2_f32_bf16 v92, v238, v59, v57
    v_dot2_f32_bf16 v93, v238, v61, v57
    v_cvt_pk_bf16_f32 v234, v84, v85
    v_dot2_f32_bf16 v94, v239, v59, v57
    v_dot2_f32_bf16 v95, v239, v61, v57
    v_cvt_pk_bf16_f32 v235, v86, v87
    v_dot2_f32_bf16 v80, v240, v58, v56
    v_dot2_f32_bf16 v81, v240, v60, v56
    v_cvt_pk_bf16_f32 v236, v88, v89
    v_dot2_f32_bf16 v82, v241, v58, v56
    v_dot2_f32_bf16 v83, v241, v60, v56
    v_cvt_pk_bf16_f32 v237, v90, v91
    v_dot2_f32_bf16 v84, v242, v58, v56
    v_dot2_f32_bf16 v85, v242, v60, v56
    v_cvt_pk_bf16_f32 v238, v92, v93
    v_dot2_f32_bf16 v86, v243, v58, v56
    v_dot2_f32_bf16 v87, v243, v60, v56
    v_cvt_pk_bf16_f32 v239, v94, v95
    v_dot2_f32_bf16 v88, v244, v59, v57
    v_dot2_f32_bf16 v89, v244, v61, v57
    v_cvt_pk_bf16_f32 v240, v80, v81
    v_dot2_f32_bf16 v90, v245, v59, v57
    v_dot2_f32_bf16 v91, v245, v61, v57
    v_cvt_pk_bf16_f32 v241, v82, v83
    v_dot2_f32_bf16 v92, v246, v59, v57
    v_dot2_f32_bf16 v93, v246, v61, v57
    v_cvt_pk_bf16_f32 v242, v84, v85
    v_dot2_f32_bf16 v94, v247, v59, v57
    v_dot2_f32_bf16 v95, v247, v61, v57
    v_cvt_pk_bf16_f32 v243, v86, v87
    v_dot2_f32_bf16 v80, v248, v58, v56
    v_dot2_f32_bf16 v81, v248, v60, v56
    v_cvt_pk_bf16_f32 v244, v88, v89
    v_dot2_f32_bf16 v82, v249, v58, v56
    v_dot2_f32_bf16 v83, v249, v60, v56
    v_cvt_pk_bf16_f32 v245, v90, v91
    v_dot2_f32_bf16 v84, v250, v58, v56
    v_dot2_f32_bf16 v85, v250, v60, v56
    v_cvt_pk_bf16_f32 v246, v92, v93
    v_dot2_f32_bf16 v86, v251, v58, v56
    v_dot2_f32_bf16 v87, v251, v60, v56
    v_cvt_pk_bf16_f32 v247, v94, v95
    v_dot2_f32_bf16 v88, v252, v59, v57
    v_dot2_f32_bf16 v89, v252, v61, v57
    v_cvt_pk_bf16_f32 v248, v80, v81
    v_dot2_f32_bf16 v90, v253, v59, v57
    v_dot2_f32_bf16 v91, v253, v61, v57
    v_cvt_pk_bf16_f32 v249, v82, v83
    v_dot2_f32_bf16 v92, v254, v59, v57
    v_dot2_f32_bf16 v93, v254, v61, v57
    v_cvt_pk_bf16_f32 v250, v84, v85
    v_dot2_f32_bf16 v94, v255, v59, v57
    v_dot2_f32_bf16 v95, v255, v61, v57
    v_cvt_pk_bf16_f32 v251, v86, v87
    v_cvt_pk_bf16_f32 v252, v88, v89
    v_cvt_pk_bf16_f32 v253, v90, v91
    v_cvt_pk_bf16_f32 v254, v92, v93
    v_cvt_pk_bf16_f32 v255, v94, v95
    s_lshl_b32 s56, s69, 2
    s_add_u32 s56, s56, s7
    s_lshl_b32 s56, s56, 6
    s_add_u32 s56, s56, 33037312
    s_lshl_b32 s57, s6, 2
    s_add_u32 s90, s56, s57
    s_mov_b32 s64, 2
    s_and_b32 s66, s5, 1
    s_movk_i32 s71, 128
    s_mov_b32 s72, 0
    s_mov_b32 s65, 0x40000000
    s_mul_i32 s56, s69, 144
    s_mul_i32 s57, s5, 9
    s_add_u32 s56, s56, s57
    s_add_u32 s56, s56, s66
    s_lshl_b32 s73, s56, 11
    s_lshl_b32 s56, s66, 1
    s_sub_u32 s56, s56, 3
    v_mov_b32 v22, s56
    s_cmp_eq_u32 s66, 1
    s_cbranch_scc1 gm_qkv
gm_qkvb:
    s_mov_b32 s8, s48
    s_mov_b32 s9, s49
    s_mov_b32 s10, 5308416
    s_mov_b32 s11, 0x00020000
    s_mul_i32 s67, s69, 144
    s_mul_i32 s57, s7, 36
    s_add_u32 s67, s67, s57
    s_lshl_b32 s67, s67, 11
    s_lshl_b32 s57, s7, 6
    s_add_u32 s57, s57, s69
    s_mul_i32 s57, s57, 144
    s_mul_i32 s58, s6, 36
    s_add_u32 s57, s57, s58
    s_lshl_b32 s62, s57, 8
    s_add_u32 s62, s62, 21494784
    s_mul_i32 s56, s7, 1152
    s_lshl_b32 s57, s3, 4
    s_add_u32 s56, s56, s57
    s_mul_i32 s70, s56, 1152
    s_mul_i32 s57, s6, 288
    s_add_u32 s70, s70, s57
    v_and_b32 v10, 3, v1
    v_lshlrev_b32 v10, 2, v10
    s_and_b32 s63, s90, 0xffffffc0
    s_mul_i32 s57, s6, 7
    s_add_u32 s57, s57, 1
    s_lshr_b32 s57, s57, 1
    v_add_u32 v48, s57, v1
    v_subrev_u32 v49, 14, v48
    v_min_u32 v48, v48, v49
    v_mad_u32_u24 v49, v48, 9, 1
    v_lshrrev_b32 v49, 5, v49
    v_add_u32 v21, v48, v49
    s_add_u32 s57, s6, 2
    v_add_u32 v48, s57, v1
    v_and_b32 v48, 3, v48
    v_mad_u32_u24 v48, v48, 9, 8
    v_lshrrev_b32 v48, 1, v48
    v_cmp_lt_u32 vcc, 13, v1
    v_mov_b32 v49, 0x5000
    s_mov_b32 s59, 73728
    v_cndmask_b32 v21, v21, v48, vcc
    v_cmp_lt_u32 vcc, 17, v1
    s_mov_b32 s68, 4
    s_nop 0
    v_cndmask_b32 v21, v21, v49, vcc
    v_lshlrev_b32 v0, 12, v21
    v_add_u32 v0, s67, v0
    v_mul_lo_u32 v21, v21, s59
    v_add_u32 v21, s70, v21
    v_add_u32 v48, 0, v1
    v_mul_u32_u24 v49, 3641, v48
    v_lshrrev_b32 v49, 16, v49
    v_mul_u32_u24 v50, 864, v49
    v_add_u32 v15, v7, v50
    v_add_u32 v48, 64, v1
    v_mul_u32_u24 v49, 3641, v48
    v_lshrrev_b32 v49, 16, v49
    v_mul_u32_u24 v50, 864, v49
    v_add_u32 v16, v7, v50
    v_add_u32 v48, 128, v1
    v_mul_u32_u24 v49, 3641, v48
    v_lshrrev_b32 v49, 16, v49
    v_mul_u32_u24 v50, 864, v49
    v_add_u32 v17, v7, v50
    v_add_u32 v48, 192, v1
    v_mul_u32_u24 v49, 3641, v48
    v_lshrrev_b32 v49, 16, v49
    v_mul_u32_u24 v50, 864, v49
    v_add_u32 v18, v7, v50
    v_add_u32 v48, 224, v1
    v_mul_u32_u24 v49, 3641, v48
    v_lshrrev_b32 v49, 16, v49
    v_mul_u32_u24 v50, 864, v49
    v_add_u32 v20, v7, v50
    s_sub_u32 s56, s64, 1
gm_w0:
    ds_read_b32 v14, v12
    s_sub_u32 s91, s91, 1
    s_cmp_lt_i32 s91, 0
    s_cbranch_scc1 gm_w0x
    s_waitcnt lgkmcnt(0)
    v_cmp_gt_u32 vcc, s56, v14
    s_cbranch_vccnz gm_w0
gm_w0x:
    s_waitcnt lgkmcnt(0)
    ds_read_b64_tr_b16 v[24:25], v2 offset:0
    ds_read_b64_tr_b16 v[26:27], v2 offset:512
    ds_read_b64_tr_b16 v[28:29], v2 offset:8192
    ds_read_b64_tr_b16 v[30:31], v2 offset:8704
    ds_read_b64_tr_b16 v[32:33], v3 offset:0
    ds_read_b64_tr_b16 v[34:35], v3 offset:512
    ds_read_b64_tr_b16 v[36:37], v3 offset:8192
    ds_read_b64_tr_b16 v[38:39], v3 offset:8704
    s_mov_b32 s65, s73
    s_waitcnt vmcnt(16) lgkmcnt(4)
    s_add_u32 m0, s60, 81920
    v_mfma_f32_16x16x32_bf16 v[48:51], v[24:27], v[112:115], 0
    ds_add_u32 v11, v13
    ds_read_b64_tr_b16 v[40:41], v2 offset:2048
    v_mfma_f32_16x16x32_bf16 v[64:67], v[24:27], v[116:119], 0
    ds_read_b64_tr_b16 v[42:43], v2 offset:2560
    v_mfma_f32_16x16x32_bf16 v[56:59], v[28:31], v[112:115], 0
    buffer_load_dwordx4 v6, s[20:23], s44 offen offset:0 lds
    ds_read_b64_tr_b16 v[44:45], v2 offset:10240
    v_mfma_f32_16x16x32_bf16 v[72:75], v[28:31], v[116:119], 0
    ds_read_b64_tr_b16 v[46:47], v2 offset:10752
    s_waitcnt lgkmcnt(4)
    v_mfma_f32_16x16x32_bf16 v[52:55], v[32:35], v[112:115], 0
    ds_read_b64_tr_b16 v[24:25], v3 offset:2048
    v_mfma_f32_16x16x32_bf16 v[68:71], v[32:35], v[116:119], 0
    ds_read_b64_tr_b16 v[26:27], v3 offset:2560
    v_mfma_f32_16x16x32_bf16 v[60:63], v[36:39], v[112:115], 0
    ds_read_b64_tr_b16 v[28:29], v3 offset:10240
    v_mfma_f32_16x16x32_bf16 v[76:79], v[36:39], v[116:119], 0
    ds_read_b64_tr_b16 v[30:31], v3 offset:10752
    s_waitcnt lgkmcnt(4)
    v_mfma_f32_16x16x32_bf16 v[48:51], v[40:43], v[120:123], v[48:51]
    ds_read_b64_tr_b16 v[32:33], v2 offset:16384
    v_mfma_f32_16x16x32_bf16 v[64:67], v[40:43], v[124:127], v[64:67]
    ds_read_b64_tr_b16 v[34:35], v2 offset:16896
    v_mfma_f32_16x16x32_bf16 v[56:59], v[44:47], v[120:123], v[56:59]
    buffer_load_dwordx4 v6, s[20:23], s45 offen offset:1024 lds
    ds_read_b64_tr_b16 v[36:37], v2 offset:24576
    v_mfma_f32_16x16x32_bf16 v[72:75], v[44:47], v[124:127], v[72:75]
    ds_read_b64_tr_b16 v[38:39], v2 offset:25088
    s_waitcnt lgkmcnt(4)
    v_mfma_f32_16x16x32_bf16 v[52:55], v[24:27], v[120:123], v[52:55]
    ds_read_b64_tr_b16 v[40:41], v3 offset:16384
    v_mfma_f32_16x16x32_bf16 v[68:71], v[24:27], v[124:127], v[68:71]
    ds_read_b64_tr_b16 v[42:43], v3 offset:16896
    v_mfma_f32_16x16x32_bf16 v[60:63], v[28:31], v[120:123], v[60:63]
    ds_read_b64_tr_b16 v[44:45], v3 offset:24576
    v_mfma_f32_16x16x32_bf16 v[76:79], v[28:31], v[124:127], v[76:79]
    ds_read_b64_tr_b16 v[46:47], v3 offset:25088
    s_waitcnt lgkmcnt(4)
    v_mfma_f32_16x16x32_bf16 v[48:51], v[32:35], v[128:131], v[48:51]
    ds_read_b64_tr_b16 v[24:25], v2 offset:18432
    v_mfma_f32_16x16x32_bf16 v[64:67], v[32:35], v[132:135], v[64:67]
    ds_read_b64_tr_b16 v[26:27], v2 offset:18944
    v_mfma_f32_16x16x32_bf16 v[56:59], v[36:39], v[128:131], v[56:59]
    buffer_load_dwordx4 v6, s[20:23], s46 offen offset:2048 lds
    ds_read_b64_tr_b16 v[28:29], v2 offset:26624
    v_mfma_f32_16x16x32_bf16 v[72:75], v[36:39], v[132:135], v[72:75]
    ds_read_b64_tr_b16 v[30:31], v2 offset:27136
    s_waitcnt lgkmcnt(4)
    v_mfma_f32_16x16x32_bf16 v[52:55], v[40:43], v[128:131], v[52:55]
    ds_read_b64_tr_b16 v[32:33], v3 offset:18432
    v_mfma_f32_16x16x32_bf16 v[68:71], v[40:43], v[132:135], v[68:71]
    ds_read_b64_tr_b16 v[34:35], v3 offset:18944
    v_mfma_f32_16x16x32_bf16 v[60:63], v[44:47], v[128:131], v[60:63]
    ds_read_b64_tr_b16 v[36:37], v3 offset:26624
    v_mfma_f32_16x16x32_bf16 v[76:79], v[44:47], v[132:135], v[76:79]
    ds_read_b64_tr_b16 v[38:39], v3 offset:27136
    s_waitcnt lgkmcnt(4)
    v_mfma_f32_16x16x32_bf16 v[48:51], v[24:27], v[136:139], v[48:51]
    ds_read_b64_tr_b16 v[40:41], v2 offset:32768
    v_mfma_f32_16x16x32_bf16 v[64:67], v[24:27], v[140:143], v[64:67]
    ds_read_b64_tr_b16 v[42:43], v2 offset:33280
    v_mfma_f32_16x16x32_bf16 v[56:59], v[28:31], v[136:139], v[56:59]
    buffer_load_dwordx4 v6, s[20:23], s47 offen offset:3072 lds
    ds_read_b64_tr_b16 v[44:45], v2 offset:40960
    v_mfma_f32_16x16x32_bf16 v[72:75], v[28:31], v[140:143], v[72:75]
    ds_read_b64_tr_b16 v[46:47], v2 offset:41472
    s_waitcnt lgkmcnt(4)
    v_mfma_f32_16x16x32_bf16 v[52:55], v[32:35], v[136:139], v[52:55]
    ds_read_b32 v14, v12
    ds_read_b64_tr_b16 v[24:25], v3 offset:32768
    v_mfma_f32_16x16x32_bf16 v[68:71], v[32:35], v[140:143], v[68:71]
    ds_read_b64_tr_b16 v[26:27], v3 offset:33280
    v_mfma_f32_16x16x32_bf16 v[60:63], v[36:39], v[136:139], v[60:63]
    ds_read_b64_tr_b16 v[28:29], v3 offset:40960
    v_mfma_f32_16x16x32_bf16 v[76:79], v[36:39], v[140:143], v[76:79]
    ds_read_b64_tr_b16 v[30:31], v3 offset:41472
    s_waitcnt lgkmcnt(4)
    v_cmp_gt_u32 vcc, s64, v14
    s_cbranch_vccnz gm_phr0
gm_phr0b:
    s_add_u32 m0, s60, 98304
    v_mfma_f32_16x16x32_bf16 v[48:51], v[40:43], v[144:147], v[48:51]
    ds_read_b64_tr_b16 v[32:33], v2 offset:34816
    v_mfma_f32_16x16x32_bf16 v[64:67], v[40:43], v[148:151], v[64:67]
    ds_read_b64_tr_b16 v[34:35], v2 offset:35328
    v_mfma_f32_16x16x32_bf16 v[56:59], v[44:47], v[144:147], v[56:59]
    buffer_load_dwordx4 v6, s[20:23], s50 offen offset:0 lds
    ds_read_b64_tr_b16 v[36:37], v2 offset:43008
    v_mfma_f32_16x16x32_bf16 v[72:75], v[44:47], v[148:151], v[72:75]
    ds_read_b64_tr_b16 v[38:39], v2 offset:43520
    s_waitcnt lgkmcnt(4)
    v_mfma_f32_16x16x32_bf16 v[52:55], v[24:27], v[144:147], v[52:55]
    ds_read_b64_tr_b16 v[40:41], v3 offset:34816
    v_mfma_f32_16x16x32_bf16 v[68:71], v[24:27], v[148:151], v[68:71]
    ds_read_b64_tr_b16 v[42:43], v3 offset:35328
    v_mfma_f32_16x16x32_bf16 v[60:63], v[28:31], v[144:147], v[60:63]
    buffer_load_dwordx4 v6, s[20:23], s51 offen offset:1024 lds
    ds_read_b64_tr_b16 v[44:45], v3 offset:43008
    v_mfma_f32_16x16x32_bf16 v[76:79], v[28:31], v[148:151], v[76:79]
    ds_read_b64_tr_b16 v[46:47], v3 offset:43520
    s_add_u32 s64, s64, 1
    s_waitcnt lgkmcnt(4)
    v_add_u32 v2, 49152, v2
    v_add_u32 v3, 49152, v3
    v_mfma_f32_16x16x32_bf16 v[48:51], v[32:35], v[152:155], v[48:51]
    ds_read_b64_tr_b16 v[24:25], v2 offset:0
    v_mfma_f32_16x16x32_bf16 v[64:67], v[32:35], v[156:159], v[64:67]
    ds_read_b64_tr_b16 v[26:27], v2 offset:512
    v_mfma_f32_16x16x32_bf16 v[56:59], v[36:39], v[152:155], v[56:59]
    buffer_load_dwordx4 v6, s[20:23], s52 offen offset:2048 lds
    ds_read_b64_tr_b16 v[28:29], v2 offset:8192
    v_mfma_f32_16x16x32_bf16 v[72:75], v[36:39], v[156:159], v[72:75]
    ds_read_b64_tr_b16 v[30:31], v2 offset:8704
    s_waitcnt lgkmcnt(4)
    v_mfma_f32_16x16x32_bf16 v[52:55], v[40:43], v[152:155], v[52:55]
    ds_read_b64_tr_b16 v[32:33], v3 offset:0
    v_mfma_f32_16x16x32_bf16 v[68:71], v[40:43], v[156:159], v[68:71]
    ds_read_b64_tr_b16 v[34:35], v3 offset:512
    v_mfma_f32_16x16x32_bf16 v[60:63], v[44:47], v[152:155], v[60:63]
    buffer_load_dwordx4 v6, s[20:23], s53 offen offset:3072 lds
    ds_read_b64_tr_b16 v[36:37], v3 offset:8192
    v_mfma_f32_16x16x32_bf16 v[76:79], v[44:47], v[156:159], v[76:79]
    ds_read_b64_tr_b16 v[38:39], v3 offset:8704
    s_waitcnt vmcnt(8) lgkmcnt(4)
    s_add_u32 m0, s60, 114688
    v_mfma_f32_16x16x32_bf16 v[48:51], v[24:27], v[160:163], v[48:51]
    ds_add_u32 v11, v13
    ds_read_b64_tr_b16 v[40:41], v2 offset:2048
    v_mfma_f32_16x16x32_bf16 v[64:67], v[24:27], v[164:167], v[64:67]
    ds_read_b64_tr_b16 v[42:43], v2 offset:2560
    v_mfma_f32_16x16x32_bf16 v[56:59], v[28:31], v[160:163], v[56:59]
    buffer_load_dwordx4 v6, s[20:23], s54 offen offset:0 lds
    ds_read_b64_tr_b16 v[44:45], v2 offset:10240
    v_mfma_f32_16x16x32_bf16 v[72:75], v[28:31], v[164:167], v[72:75]
    ds_read_b64_tr_b16 v[46:47], v2 offset:10752
    s_waitcnt lgkmcnt(4)
    v_mfma_f32_16x16x32_bf16 v[52:55], v[32:35], v[160:163], v[52:55]
    ds_read_b64_tr_b16 v[24:25], v3 offset:2048
    v_mfma_f32_16x16x32_bf16 v[68:71], v[32:35], v[164:167], v[68:71]
    ds_read_b64_tr_b16 v[26:27], v3 offset:2560
    v_mfma_f32_16x16x32_bf16 v[60:63], v[36:39], v[160:163], v[60:63]
    buffer_load_dwordx4 v6, s[20:23], s55 offen offset:1024 lds
    ds_read_b64_tr_b16 v[28:29], v3 offset:10240
    v_mfma_f32_16x16x32_bf16 v[76:79], v[36:39], v[164:167], v[76:79]
    ds_read_b64_tr_b16 v[30:31], v3 offset:10752
    s_waitcnt lgkmcnt(4)
    v_mfma_f32_16x16x32_bf16 v[48:51], v[40:43], v[168:171], v[48:51]
    ds_read_b64_tr_b16 v[32:33], v2 offset:16384
    v_mfma_f32_16x16x32_bf16 v[64:67], v[40:43], v[172:175], v[64:67]
    ds_read_b64_tr_b16 v[34:35], v2 offset:16896
    v_mfma_f32_16x16x32_bf16 v[56:59], v[44:47], v[168:171], v[56:59]
    ds_read_b64_tr_b16 v[36:37], v2 offset:24576
    v_mfma_f32_16x16x32_bf16 v[72:75], v[44:47], v[172:175], v[72:75]
    ds_read_b64_tr_b16 v[38:39], v2 offset:25088
    s_waitcnt lgkmcnt(4)
    v_mfma_f32_16x16x32_bf16 v[52:55], v[24:27], v[168:171], v[52:55]
    ds_read_b64_tr_b16 v[40:41], v3 offset:16384
    v_mfma_f32_16x16x32_bf16 v[68:71], v[24:27], v[172:175], v[68:71]
    ds_read_b64_tr_b16 v[42:43], v3 offset:16896
    v_mfma_f32_16x16x32_bf16 v[60:63], v[28:31], v[168:171], v[60:63]
    buffer_load_dwordx4 v6, s[20:23], s74 offen offset:2048 lds
    ds_read_b64_tr_b16 v[44:45], v3 offset:24576
    v_mfma_f32_16x16x32_bf16 v[76:79], v[28:31], v[172:175], v[76:79]
    ds_read_b64_tr_b16 v[46:47], v3 offset:25088
    s_waitcnt lgkmcnt(4)
    v_mfma_f32_16x16x32_bf16 v[48:51], v[32:35], v[176:179], v[48:51]
    ds_read_b64_tr_b16 v[24:25], v4 offset:0
    v_mfma_f32_16x16x32_bf16 v[64:67], v[32:35], v[180:183], v[64:67]
    ds_read_b64_tr_b16 v[26:27], v4 offset:512
    v_mfma_f32_16x16x32_bf16 v[56:59], v[36:39], v[176:179], v[56:59]
    buffer_load_dwordx4 v6, s[20:23], s75 offen offset:3072 lds
    ds_read_b64_tr_b16 v[28:29], v4 offset:8192
    v_mfma_f32_16x16x32_bf16 v[72:75], v[36:39], v[180:183], v[72:75]
    ds_read_b64_tr_b16 v[30:31], v4 offset:8704
    s_waitcnt lgkmcnt(4)
    v_mfma_f32_16x16x32_bf16 v[52:55], v[40:43], v[176:179], v[52:55]
    ds_read_b64_tr_b16 v[32:33], v5 offset:0
    v_mfma_f32_16x16x32_bf16 v[68:71], v[40:43], v[180:183], v[68:71]
    ds_read_b64_tr_b16 v[34:35], v5 offset:512
    v_mfma_f32_16x16x32_bf16 v[60:63], v[44:47], v[176:179], v[60:63]
    ds_read_b64_tr_b16 v[36:37], v5 offset:8192
    v_mfma_f32_16x16x32_bf16 v[76:79], v[44:47], v[180:183], v[76:79]
    ds_read_b64_tr_b16 v[38:39], v5 offset:8704
    s_branch gm_s18
gm_loop:
    s_waitcnt vmcnt(4) lgkmcnt(4)
    s_add_u32 m0, s60, 81920
    v_mfma_f32_16x16x32_bf16 v[48:51], v[24:27], v[112:115], 0
    ds_add_u32 v11, v13
    ds_read_b64_tr_b16 v[40:41], v2 offset:2048
    v_mfma_f32_16x16x32_bf16 v[64:67], v[24:27], v[116:119], 0
    ds_read_b64_tr_b16 v[42:43], v2 offset:2560
    v_mfma_f32_16x16x32_bf16 v[56:59], v[28:31], v[112:115], 0
    buffer_load_dwordx4 v6, s[20:23], s44 offen offset:0 lds
    ds_read_b64_tr_b16 v[44:45], v2 offset:10240
    v_mfma_f32_16x16x32_bf16 v[72:75], v[28:31], v[116:119], 0
    ds_read_b64_tr_b16 v[46:47], v2 offset:10752
    s_waitcnt lgkmcnt(4)
    v_mfma_f32_16x16x32_bf16 v[52:55], v[32:35], v[112:115], 0
    ds_read_b64_tr_b16 v[24:25], v3 offset:2048
    v_mfma_f32_16x16x32_bf16 v[68:71], v[32:35], v[116:119], 0
    ds_read_b64_tr_b16 v[26:27], v3 offset:2560
    v_mfma_f32_16x16x32_bf16 v[60:63], v[36:39], v[112:115], 0
    ds_read_b64_tr_b16 v[28:29], v3 offset:10240
    v_mfma_f32_16x16x32_bf16 v[76:79], v[36:39], v[116:119], 0
    ds_read_b64_tr_b16 v[30:31], v3 offset:10752
    v_mul_f32 v88, v80, v88
    v_mul_f32 v89, v81, v89
    s_waitcnt lgkmcnt(4)
    v_mfma_f32_16x16x32_bf16 v[48:51], v[40:43], v[120:123], v[48:51]
    ds_read_b64_tr_b16 v[32:33], v2 offset:16384
    v_mul_f32 v90, v82, v90
    v_mfma_f32_16x16x32_bf16 v[64:67], v[40:43], v[124:127], v[64:67]
    ds_read_b64_tr_b16 v[34:35], v2 offset:16896
    v_exp_f32 v80, -v80
    v_mul_f32 v91, v83, v91
    v_mfma_f32_16x16x32_bf16 v[56:59], v[44:47], v[120:123], v[56:59]
    buffer_load_dwordx4 v6, s[20:23], s45 offen offset:1024 lds
    ds_read_b64_tr_b16 v[36:37], v2 offset:24576
    v_exp_f32 v81, -v81
    v_mfma_f32_16x16x32_bf16 v[72:75], v[44:47], v[124:127], v[72:75]
    ds_read_b64_tr_b16 v[38:39], v2 offset:25088
    v_mul_f32 v92, v84, v92
    s_waitcnt lgkmcnt(4)
    v_mfma_f32_16x16x32_bf16 v[52:55], v[24:27], v[120:123], v[52:55]
    ds_read_b64_tr_b16 v[40:41], v3 offset:16384
    v_exp_f32 v82, -v82
    v_fma_f32 v80, v80, v9, v9
    v_mfma_f32_16x16x32_bf16 v[68:71], v[24:27], v[124:127], v[68:71]
    ds_read_b64_tr_b16 v[42:43], v3 offset:16896
    v_mul_f32 v93, v85, v93
    v_mfma_f32_16x16x32_bf16 v[60:63], v[28:31], v[120:123], v[60:63]
    ds_read_b64_tr_b16 v[44:45], v3 offset:24576
    v_exp_f32 v83, -v83
    v_fma_f32 v81, v81, v9, v9
    v_mfma_f32_16x16x32_bf16 v[76:79], v[28:31], v[124:127], v[76:79]
    ds_read_b64_tr_b16 v[46:47], v3 offset:25088
    v_mul_f32 v94, v86, v94
    s_waitcnt lgkmcnt(4)
    v_mfma_f32_16x16x32_bf16 v[48:51], v[32:35], v[128:131], v[48:51]
    ds_read_b64_tr_b16 v[24:25], v2 offset:18432
    v_exp_f32 v84, -v84
    v_mfma_f32_16x16x32_bf16 v[64:67], v[32:35], v[132:135], v[64:67]
    ds_read_b64_tr_b16 v[26:27], v2 offset:18944
    v_fma_f32 v82, v82, v9, v9
    v_rcp_f32 v80, v80
    v_mfma_f32_16x16x32_bf16 v[56:59], v[36:39], v[128:131], v[56:59]
    buffer_load_dwordx4 v6, s[20:23], s46 offen offset:2048 lds
    ds_read_b64_tr_b16 v[28:29], v2 offset:26624
    v_mul_f32 v95, v87, v95
    v_mfma_f32_16x16x32_bf16 v[72:75], v[36:39], v[132:135], v[72:75]
    ds_read_b64_tr_b16 v[30:31], v2 offset:27136
    v_exp_f32 v85, -v85
    v_fma_f32 v83, v83, v9, v9
    s_waitcnt lgkmcnt(4)
    v_mfma_f32_16x16x32_bf16 v[52:55], v[40:43], v[128:131], v[52:55]
    ds_read_b64_tr_b16 v[32:33], v3 offset:18432
    v_rcp_f32 v81, v81
    v_mfma_f32_16x16x32_bf16 v[68:71], v[40:43], v[132:135], v[68:71]
    ds_read_b64_tr_b16 v[34:35], v3 offset:18944
    v_exp_f32 v86, -v86
    v_mfma_f32_16x16x32_bf16 v[60:63], v[44:47], v[128:131], v[60:63]
    ds_read_b64_tr_b16 v[36:37], v3 offset:26624
    v_fma_f32 v84, v84, v9, v9
    v_rcp_f32 v82, v82
    v_mfma_f32_16x16x32_bf16 v[76:79], v[44:47], v[132:135], v[76:79]
    ds_read_b64_tr_b16 v[38:39], v3 offset:27136
    v_mul_f32 v88, v88, v80
    s_waitcnt lgkmcnt(4)
    v_mfma_f32_16x16x32_bf16 v[48:51], v[24:27], v[136:139], v[48:51]
    ds_read_b64_tr_b16 v[40:41], v2 offset:32768
    v_exp_f32 v87, -v87
    v_fma_f32 v85, v85, v9, v9
    v_mfma_f32_16x16x32_bf16 v[64:67], v[24:27], v[140:143], v[64:67]
    ds_read_b64_tr_b16 v[42:43], v2 offset:33280
    v_rcp_f32 v83, v83
    v_mfma_f32_16x16x32_bf16 v[56:59], v[28:31], v[136:139], v[56:59]
    buffer_load_dwordx4 v6, s[20:23], s47 offen offset:3072 lds
    ds_read_b64_tr_b16 v[44:45], v2 offset:40960
    v_mul_f32 v89, v89, v81
    v_mfma_f32_16x16x32_bf16 v[72:75], v[28:31], v[140:143], v[72:75]
    ds_read_b64_tr_b16 v[46:47], v2 offset:41472
    v_fma_f32 v86, v86, v9, v9
    v_rcp_f32 v84, v84
    s_waitcnt lgkmcnt(4)
    v_mfma_f32_16x16x32_bf16 v[52:55], v[32:35], v[136:139], v[52:55]
    ds_read_b32 v14, v12
    ds_read_b64_tr_b16 v[24:25], v3 offset:32768
    v_mul_f32 v90, v90, v82
    v_mfma_f32_16x16x32_bf16 v[68:71], v[32:35], v[140:143], v[68:71]
    ds_read_b64_tr_b16 v[26:27], v3 offset:33280
    v_fma_f32 v87, v87, v9, v9
    v_rcp_f32 v85, v85
    v_mfma_f32_16x16x32_bf16 v[60:63], v[36:39], v[136:139], v[60:63]
    ds_read_b64_tr_b16 v[28:29], v3 offset:40960
    v_mul_f32 v91, v91, v83
    v_mfma_f32_16x16x32_bf16 v[76:79], v[36:39], v[140:143], v[76:79]
    ds_read_b64_tr_b16 v[30:31], v3 offset:41472
    v_rcp_f32 v86, v86
    s_waitcnt lgkmcnt(4)
    v_cmp_gt_u32 vcc, s64, v14
    s_cbranch_vccnz gm_plr0
gm_plr0b:
    s_add_u32 m0, s60, 98304
    v_mfma_f32_16x16x32_bf16 v[48:51], v[40:43], v[144:147], v[48:51]
    ds_read_b64_tr_b16 v[32:33], v2 offset:34816
    v_mul_f32 v92, v92, v84
    v_rcp_f32 v87, v87
    v_mfma_f32_16x16x32_bf16 v[64:67], v[40:43], v[148:151], v[64:67]
    ds_read_b64_tr_b16 v[34:35], v2 offset:35328
    v_mul_f32 v93, v93, v85
    v_mfma_f32_16x16x32_bf16 v[56:59], v[44:47], v[144:147], v[56:59]
    buffer_load_dwordx4 v6, s[20:23], s50 offen offset:0 lds
    ds_read_b64_tr_b16 v[36:37], v2 offset:43008
    v_mul_f32 v94, v94, v86
    v_mul_f32 v95, v95, v87
    v_mfma_f32_16x16x32_bf16 v[72:75], v[44:47], v[148:151], v[72:75]
    ds_read_b64_tr_b16 v[38:39], v2 offset:43520
    v_cvt_pk_bf16_f32 v80, v88, v89
    s_waitcnt lgkmcnt(4)
    v_mfma_f32_16x16x32_bf16 v[52:55], v[24:27], v[144:147], v[52:55]
    ds_read_b64_tr_b16 v[40:41], v3 offset:34816
    v_cvt_pk_bf16_f32 v81, v90, v91
    v_mfma_f32_16x16x32_bf16 v[68:71], v[24:27], v[148:151], v[68:71]
    ds_read_b64_tr_b16 v[42:43], v3 offset:35328
    v_cvt_pk_bf16_f32 v82, v92, v93
    v_cvt_pk_bf16_f32 v83, v94, v95
    v_mfma_f32_16x16x32_bf16 v[60:63], v[28:31], v[144:147], v[60:63]
    buffer_load_dwordx4 v6, s[20:23], s51 offen offset:1024 lds
    ds_read_b64_tr_b16 v[44:45], v3 offset:43008
    buffer_store_dwordx4 v[80:83], v7, s[24:27], s65 offen offset:0 sc1
    v_mfma_f32_16x16x32_bf16 v[76:79], v[28:31], v[148:151], v[76:79]
    ds_read_b64_tr_b16 v[46:47], v3 offset:43520
    s_add_u32 s64, s64, 1
    v_mul_f32 v104, v96, v104
    v_mul_f32 v105, v97, v105
    s_waitcnt lgkmcnt(4)
    v_add_u32 v2, 49152, v2
    v_add_u32 v3, 49152, v3
    v_mfma_f32_16x16x32_bf16 v[48:51], v[32:35], v[152:155], v[48:51]
    ds_read_b64_tr_b16 v[24:25], v2 offset:0
    v_mul_f32 v106, v98, v106
    v_mfma_f32_16x16x32_bf16 v[64:67], v[32:35], v[156:159], v[64:67]
    ds_read_b64_tr_b16 v[26:27], v2 offset:512
    v_exp_f32 v96, -v96
    v_mfma_f32_16x16x32_bf16 v[56:59], v[36:39], v[152:155], v[56:59]
    buffer_load_dwordx4 v6, s[20:23], s52 offen offset:2048 lds
    ds_read_b64_tr_b16 v[28:29], v2 offset:8192
    v_mul_f32 v107, v99, v107
    v_exp_f32 v97, -v97
    v_mfma_f32_16x16x32_bf16 v[72:75], v[36:39], v[156:159], v[72:75]
    ds_read_b64_tr_b16 v[30:31], v2 offset:8704
    v_mul_f32 v108, v100, v108
    s_waitcnt lgkmcnt(4)
    v_mfma_f32_16x16x32_bf16 v[52:55], v[40:43], v[152:155], v[52:55]
    ds_read_b64_tr_b16 v[32:33], v3 offset:0
    v_exp_f32 v98, -v98
    v_fma_f32 v96, v96, v8, v8
    v_mfma_f32_16x16x32_bf16 v[68:71], v[40:43], v[156:159], v[68:71]
    ds_read_b64_tr_b16 v[34:35], v3 offset:512
    v_mul_f32 v109, v101, v109
    v_mfma_f32_16x16x32_bf16 v[60:63], v[44:47], v[152:155], v[60:63]
    buffer_load_dwordx4 v6, s[20:23], s53 offen offset:3072 lds
    ds_read_b64_tr_b16 v[36:37], v3 offset:8192
    v_exp_f32 v99, -v99
    v_mfma_f32_16x16x32_bf16 v[76:79], v[44:47], v[156:159], v[76:79]
    ds_read_b64_tr_b16 v[38:39], v3 offset:8704
    v_fma_f32 v97, v97, v8, v8
    v_mul_f32 v110, v102, v110
    s_waitcnt vmcnt(13) lgkmcnt(4)
    s_add_u32 m0, s60, 114688
    v_mfma_f32_16x16x32_bf16 v[48:51], v[24:27], v[160:163], v[48:51]
    ds_add_u32 v11, v13
    ds_read_b64_tr_b16 v[40:41], v2 offset:2048
    v_exp_f32 v100, -v100
    v_mfma_f32_16x16x32_bf16 v[64:67], v[24:27], v[164:167], v[64:67]
    ds_read_b64_tr_b16 v[42:43], v2 offset:2560
    v_fma_f32 v98, v98, v8, v8
    v_rcp_f32 v96, v96
    v_mfma_f32_16x16x32_bf16 v[56:59], v[28:31], v[160:163], v[56:59]
    buffer_load_dwordx4 v6, s[20:23], s54 offen offset:0 lds
    ds_read_b64_tr_b16 v[44:45], v2 offset:10240
    v_mul_f32 v111, v103, v111
    v_mfma_f32_16x16x32_bf16 v[72:75], v[28:31], v[164:167], v[72:75]
    ds_read_b64_tr_b16 v[46:47], v2 offset:10752
    v_exp_f32 v101, -v101
    s_waitcnt lgkmcnt(4)
    v_mfma_f32_16x16x32_bf16 v[52:55], v[32:35], v[160:163], v[52:55]
    ds_read_b64_tr_b16 v[24:25], v3 offset:2048
    v_fma_f32 v99, v99, v8, v8
    v_rcp_f32 v97, v97
    v_mfma_f32_16x16x32_bf16 v[68:71], v[32:35], v[164:167], v[68:71]
    ds_read_b64_tr_b16 v[26:27], v3 offset:2560
    v_exp_f32 v102, -v102
    v_mfma_f32_16x16x32_bf16 v[60:63], v[36:39], v[160:163], v[60:63]
    buffer_load_dwordx4 v6, s[20:23], s55 offen offset:1024 lds
    ds_read_b64_tr_b16 v[28:29], v3 offset:10240
    v_fma_f32 v100, v100, v8, v8
    v_rcp_f32 v98, v98
    v_mfma_f32_16x16x32_bf16 v[76:79], v[36:39], v[164:167], v[76:79]
    ds_read_b64_tr_b16 v[30:31], v3 offset:10752
    v_mul_f32 v104, v104, v96
    s_waitcnt lgkmcnt(4)
    v_mfma_f32_16x16x32_bf16 v[48:51], v[40:43], v[168:171], v[48:51]
    ds_read_b64_tr_b16 v[32:33], v2 offset:16384
    v_exp_f32 v103, -v103
    v_mfma_f32_16x16x32_bf16 v[64:67], v[40:43], v[172:175], v[64:67]
    ds_read_b64_tr_b16 v[34:35], v2 offset:16896
    v_fma_f32 v101, v101, v8, v8
    v_rcp_f32 v99, v99
    v_mfma_f32_16x16x32_bf16 v[56:59], v[44:47], v[168:171], v[56:59]
    ds_read_b64_tr_b16 v[36:37], v2 offset:24576
    v_mul_f32 v105, v105, v97
    v_mfma_f32_16x16x32_bf16 v[72:75], v[44:47], v[172:175], v[72:75]
    ds_read_b64_tr_b16 v[38:39], v2 offset:25088
    v_fma_f32 v102, v102, v8, v8
    v_rcp_f32 v100, v100
    s_waitcnt lgkmcnt(4)
    v_mfma_f32_16x16x32_bf16 v[52:55], v[24:27], v[168:171], v[52:55]
    ds_read_b64_tr_b16 v[40:41], v3 offset:16384
    v_mul_f32 v106, v106, v98
    v_mfma_f32_16x16x32_bf16 v[68:71], v[24:27], v[172:175], v[68:71]
    ds_read_b64_tr_b16 v[42:43], v3 offset:16896
    v_fma_f32 v103, v103, v8, v8
    v_mfma_f32_16x16x32_bf16 v[60:63], v[28:31], v[168:171], v[60:63]
    buffer_load_dwordx4 v6, s[20:23], s74 offen offset:2048 lds
    ds_read_b64_tr_b16 v[44:45], v3 offset:24576
    v_rcp_f32 v101, v101
    v_mul_f32 v107, v107, v99
    v_mfma_f32_16x16x32_bf16 v[76:79], v[28:31], v[172:175], v[76:79]
    ds_read_b64_tr_b16 v[46:47], v3 offset:25088
    v_rcp_f32 v102, v102
    s_waitcnt lgkmcnt(4)
    v_mfma_f32_16x16x32_bf16 v[48:51], v[32:35], v[176:179], v[48:51]
    ds_read_b64_tr_b16 v[24:25], v4 offset:0
    v_mul_f32 v108, v108, v100
    v_rcp_f32 v103, v103
    v_mfma_f32_16x16x32_bf16 v[64:67], v[32:35], v[180:183], v[64:67]
    ds_read_b64_tr_b16 v[26:27], v4 offset:512
    v_mul_f32 v109, v109, v101
    v_mfma_f32_16x16x32_bf16 v[56:59], v[36:39], v[176:179], v[56:59]
    buffer_load_dwordx4 v6, s[20:23], s75 offen offset:3072 lds
    ds_read_b64_tr_b16 v[28:29], v4 offset:8192
    v_mul_f32 v110, v110, v102
    v_mfma_f32_16x16x32_bf16 v[72:75], v[36:39], v[180:183], v[72:75]
    ds_read_b64_tr_b16 v[30:31], v4 offset:8704
    v_mul_f32 v111, v111, v103
    v_cvt_pk_bf16_f32 v96, v104, v105
    s_waitcnt lgkmcnt(4)
    v_mfma_f32_16x16x32_bf16 v[52:55], v[40:43], v[176:179], v[52:55]
    ds_read_b64_tr_b16 v[32:33], v5 offset:0
    v_cvt_pk_bf16_f32 v97, v106, v107
    v_mfma_f32_16x16x32_bf16 v[68:71], v[40:43], v[180:183], v[68:71]
    ds_read_b64_tr_b16 v[34:35], v5 offset:512
    v_cvt_pk_bf16_f32 v98, v108, v109
    v_cvt_pk_bf16_f32 v99, v110, v111
    v_mfma_f32_16x16x32_bf16 v[60:63], v[44:47], v[176:179], v[60:63]
    ds_read_b64_tr_b16 v[36:37], v5 offset:8192
    buffer_store_dwordx4 v[96:99], v7, s[24:27], s65 offen offset:1024 sc1
    v_mfma_f32_16x16x32_bf16 v[76:79], v[44:47], v[180:183], v[76:79]
    ds_read_b64_tr_b16 v[38:39], v5 offset:8704
    s_mov_b32 s65, s73
gm_s18:
    s_waitcnt lgkmcnt(4)
    s_add_u32 m0, s60, 131072
    v_mfma_f32_16x16x32_bf16 v[80:83], v[24:27], v[112:115], 0
    ds_read_b64_tr_b16 v[40:41], v4 offset:2048
    v_mfma_f32_16x16x32_bf16 v[96:99], v[24:27], v[116:119], 0
    ds_read_b64_tr_b16 v[42:43], v4 offset:2560
    v_mfma_f32_16x16x32_bf16 v[88:91], v[28:31], v[112:115], 0
    buffer_load_dwordx4 v6, s[20:23], s76 offen offset:0 lds
    ds_read_b64_tr_b16 v[44:45], v4 offset:10240
    v_mfma_f32_16x16x32_bf16 v[104:107], v[28:31], v[116:119], 0
    ds_read_b64_tr_b16 v[46:47], v4 offset:10752
    s_waitcnt lgkmcnt(4)
    v_mfma_f32_16x16x32_bf16 v[84:87], v[32:35], v[112:115], 0
    ds_read_b32 v14, v12
    ds_read_b64_tr_b16 v[24:25], v5 offset:2048
    v_mfma_f32_16x16x32_bf16 v[100:103], v[32:35], v[116:119], 0
    ds_read_b64_tr_b16 v[26:27], v5 offset:2560
    v_mfma_f32_16x16x32_bf16 v[92:95], v[36:39], v[112:115], 0
    buffer_load_dwordx4 v6, s[20:23], s77 offen offset:1024 lds
    ds_read_b64_tr_b16 v[28:29], v5 offset:10240
    v_mfma_f32_16x16x32_bf16 v[108:111], v[36:39], v[116:119], 0
    ds_read_b64_tr_b16 v[30:31], v5 offset:10752
    s_waitcnt lgkmcnt(4)
    v_cmp_gt_u32 vcc, s64, v14
    s_cbranch_vccnz gm_plr1
gm_plr1b:
    v_mfma_f32_16x16x32_bf16 v[80:83], v[40:43], v[120:123], v[80:83]
    ds_read_b64_tr_b16 v[32:33], v4 offset:16384
    v_mfma_f32_16x16x32_bf16 v[96:99], v[40:43], v[124:127], v[96:99]
    ds_read_b64_tr_b16 v[34:35], v4 offset:16896
    v_mfma_f32_16x16x32_bf16 v[88:91], v[44:47], v[120:123], v[88:91]
    ds_read_b64_tr_b16 v[36:37], v4 offset:24576
    v_mfma_f32_16x16x32_bf16 v[104:107], v[44:47], v[124:127], v[104:107]
    ds_read_b64_tr_b16 v[38:39], v4 offset:25088
    s_waitcnt lgkmcnt(4)
    v_mfma_f32_16x16x32_bf16 v[84:87], v[24:27], v[120:123], v[84:87]
    buffer_load_dword v19, off, s[28:31], 0 sc1
    ds_read_b64_tr_b16 v[40:41], v5 offset:16384
    v_mfma_f32_16x16x32_bf16 v[100:103], v[24:27], v[124:127], v[100:103]
    ds_read_b64_tr_b16 v[42:43], v5 offset:16896
    v_mfma_f32_16x16x32_bf16 v[92:95], v[28:31], v[120:123], v[92:95]
    buffer_load_dwordx4 v6, s[20:23], s78 offen offset:2048 lds
    ds_read_b64_tr_b16 v[44:45], v5 offset:24576
    v_mfma_f32_16x16x32_bf16 v[108:111], v[28:31], v[124:127], v[108:111]
    ds_read_b64_tr_b16 v[46:47], v5 offset:25088
    s_add_u32 s64, s64, 1
    s_waitcnt lgkmcnt(4)
    v_mfma_f32_16x16x32_bf16 v[80:83], v[32:35], v[128:131], v[80:83]
    ds_read_b64_tr_b16 v[24:25], v4 offset:18432
    v_mfma_f32_16x16x32_bf16 v[96:99], v[32:35], v[132:135], v[96:99]
    ds_read_b64_tr_b16 v[26:27], v4 offset:18944
    v_mfma_f32_16x16x32_bf16 v[88:91], v[36:39], v[128:131], v[88:91]
    buffer_load_dwordx4 v6, s[20:23], s61 offen offset:3072 lds
    ds_read_b64_tr_b16 v[28:29], v4 offset:26624
    v_mfma_f32_16x16x32_bf16 v[104:107], v[36:39], v[132:135], v[104:107]
    ds_read_b64_tr_b16 v[30:31], v4 offset:27136
    s_waitcnt lgkmcnt(4)
    v_mfma_f32_16x16x32_bf16 v[84:87], v[40:43], v[128:131], v[84:87]
    ds_read_b64_tr_b16 v[32:33], v5 offset:18432
    v_mfma_f32_16x16x32_bf16 v[100:103], v[40:43], v[132:135], v[100:103]
    ds_read_b64_tr_b16 v[34:35], v5 offset:18944
    v_mfma_f32_16x16x32_bf16 v[92:95], v[44:47], v[128:131], v[92:95]
    ds_read_b64_tr_b16 v[36:37], v5 offset:26624
    v_mfma_f32_16x16x32_bf16 v[108:111], v[44:47], v[132:135], v[108:111]
    ds_read_b64_tr_b16 v[38:39], v5 offset:27136
    s_waitcnt vmcnt(9) lgkmcnt(4)
    v_mfma_f32_16x16x32_bf16 v[80:83], v[24:27], v[136:139], v[80:83]
    ds_add_u32 v11, v13
    ds_read_b64_tr_b16 v[40:41], v4 offset:32768
    v_mfma_f32_16x16x32_bf16 v[96:99], v[24:27], v[140:143], v[96:99]
    ds_read_b64_tr_b16 v[42:43], v4 offset:33280
    v_mfma_f32_16x16x32_bf16 v[88:91], v[28:31], v[136:139], v[88:91]
    ds_read_b64_tr_b16 v[44:45], v4 offset:40960
    v_mfma_f32_16x16x32_bf16 v[104:107], v[28:31], v[140:143], v[104:107]
    ds_read_b64_tr_b16 v[46:47], v4 offset:41472
    s_waitcnt lgkmcnt(4)
    v_mfma_f32_16x16x32_bf16 v[84:87], v[32:35], v[136:139], v[84:87]
    ds_read_b64_tr_b16 v[24:25], v5 offset:32768
    v_mfma_f32_16x16x32_bf16 v[100:103], v[32:35], v[140:143], v[100:103]
    ds_read_b64_tr_b16 v[26:27], v5 offset:33280
    v_mfma_f32_16x16x32_bf16 v[92:95], v[36:39], v[136:139], v[92:95]
    ds_read_b64_tr_b16 v[28:29], v5 offset:40960
    v_mfma_f32_16x16x32_bf16 v[108:111], v[36:39], v[140:143], v[108:111]
    ds_read_b64_tr_b16 v[30:31], v5 offset:41472
    s_waitcnt lgkmcnt(4)
    v_mfma_f32_16x16x32_bf16 v[80:83], v[40:43], v[144:147], v[80:83]
    ds_read_b64_tr_b16 v[32:33], v4 offset:34816
    v_mfma_f32_16x16x32_bf16 v[96:99], v[40:43], v[148:151], v[96:99]
    ds_read_b64_tr_b16 v[34:35], v4 offset:35328
    v_mfma_f32_16x16x32_bf16 v[88:91], v[44:47], v[144:147], v[88:91]
    ds_read_b64_tr_b16 v[36:37], v4 offset:43008
    v_mfma_f32_16x16x32_bf16 v[104:107], v[44:47], v[148:151], v[104:107]
    ds_read_b64_tr_b16 v[38:39], v4 offset:43520
    s_waitcnt lgkmcnt(4)
    v_mfma_f32_16x16x32_bf16 v[84:87], v[24:27], v[144:147], v[84:87]
    ds_read_b64_tr_b16 v[40:41], v5 offset:34816
    v_mfma_f32_16x16x32_bf16 v[100:103], v[24:27], v[148:151], v[100:103]
    ds_read_b64_tr_b16 v[42:43], v5 offset:35328
    v_mfma_f32_16x16x32_bf16 v[92:95], v[28:31], v[144:147], v[92:95]
    ds_read_b64_tr_b16 v[44:45], v5 offset:43008
    v_mfma_f32_16x16x32_bf16 v[108:111], v[28:31], v[148:151], v[108:111]
    ds_read_b64_tr_b16 v[46:47], v5 offset:43520
    s_waitcnt lgkmcnt(4)
    v_add_u32 v4, 49152, v4
    v_add_u32 v5, 49152, v5
    v_mfma_f32_16x16x32_bf16 v[80:83], v[32:35], v[152:155], v[80:83]
    ds_read_b64_tr_b16 v[24:25], v4 offset:0
    v_mfma_f32_16x16x32_bf16 v[96:99], v[32:35], v[156:159], v[96:99]
    ds_read_b64_tr_b16 v[26:27], v4 offset:512
    v_mfma_f32_16x16x32_bf16 v[88:91], v[36:39], v[152:155], v[88:91]
    ds_read_b64_tr_b16 v[28:29], v4 offset:8192
    v_mfma_f32_16x16x32_bf16 v[104:107], v[36:39], v[156:159], v[104:107]
    ds_read_b64_tr_b16 v[30:31], v4 offset:8704
    s_waitcnt lgkmcnt(4)
    v_mfma_f32_16x16x32_bf16 v[84:87], v[40:43], v[152:155], v[84:87]
    ds_read_b64_tr_b16 v[32:33], v5 offset:0
    v_mfma_f32_16x16x32_bf16 v[100:103], v[40:43], v[156:159], v[100:103]
    ds_read_b64_tr_b16 v[34:35], v5 offset:512
    v_mfma_f32_16x16x32_bf16 v[92:95], v[44:47], v[152:155], v[92:95]
    ds_read_b64_tr_b16 v[36:37], v5 offset:8192
    v_mfma_f32_16x16x32_bf16 v[108:111], v[44:47], v[156:159], v[108:111]
    ds_read_b64_tr_b16 v[38:39], v5 offset:8704
    s_waitcnt lgkmcnt(4)
    v_mfma_f32_16x16x32_bf16 v[80:83], v[24:27], v[160:163], v[80:83]
    ds_read_b64_tr_b16 v[40:41], v4 offset:2048
    v_mfma_f32_16x16x32_bf16 v[96:99], v[24:27], v[164:167], v[96:99]
    ds_read_b64_tr_b16 v[42:43], v4 offset:2560
    v_mfma_f32_16x16x32_bf16 v[88:91], v[28:31], v[160:163], v[88:91]
    ds_read_b64_tr_b16 v[44:45], v4 offset:10240
    v_mfma_f32_16x16x32_bf16 v[104:107], v[28:31], v[164:167], v[104:107]
    ds_read_b64_tr_b16 v[46:47], v4 offset:10752
    s_waitcnt lgkmcnt(4)
    v_mfma_f32_16x16x32_bf16 v[84:87], v[32:35], v[160:163], v[84:87]
    ds_read_b32 v14, v12
    ds_read_b64_tr_b16 v[24:25], v5 offset:2048
    v_mfma_f32_16x16x32_bf16 v[100:103], v[32:35], v[164:167], v[100:103]
    ds_read_b64_tr_b16 v[26:27], v5 offset:2560
    v_mfma_f32_16x16x32_bf16 v[92:95], v[36:39], v[160:163], v[92:95]
    ds_read_b64_tr_b16 v[28:29], v5 offset:10240
    v_mfma_f32_16x16x32_bf16 v[108:111], v[36:39], v[164:167], v[108:111]
    ds_read_b64_tr_b16 v[30:31], v5 offset:10752
    s_cmp_eq_u32 s66, 4
    s_cbranch_scc1 gm_ptail
    s_waitcnt lgkmcnt(4)
    v_cmp_gt_u32 vcc, s64, v14
    s_cbranch_vccnz gm_plr2
gm_plr2b:
    v_add_u32 v6, 128, v6
    s_add_u32 m0, s60, 0
    v_mfma_f32_16x16x32_bf16 v[80:83], v[40:43], v[168:171], v[80:83]
    ds_read_b64_tr_b16 v[32:33], v4 offset:16384
    v_mfma_f32_16x16x32_bf16 v[96:99], v[40:43], v[172:175], v[96:99]
    ds_read_b64_tr_b16 v[34:35], v4 offset:16896
    v_mfma_f32_16x16x32_bf16 v[88:91], v[44:47], v[168:171], v[88:91]
    buffer_load_dwordx4 v6, s[20:23], s12 offen offset:0 lds
    ds_read_b64_tr_b16 v[36:37], v4 offset:24576
    v_mfma_f32_16x16x32_bf16 v[104:107], v[44:47], v[172:175], v[104:107]
    ds_read_b64_tr_b16 v[38:39], v4 offset:25088
    s_waitcnt lgkmcnt(4)
    v_mfma_f32_16x16x32_bf16 v[84:87], v[24:27], v[168:171], v[84:87]
    ds_read_b64_tr_b16 v[40:41], v5 offset:16384
    v_mfma_f32_16x16x32_bf16 v[100:103], v[24:27], v[172:175], v[100:103]
    ds_read_b64_tr_b16 v[42:43], v5 offset:16896
    v_mfma_f32_16x16x32_bf16 v[92:95], v[28:31], v[168:171], v[92:95]
    ds_read_b64_tr_b16 v[44:45], v5 offset:24576
    v_mfma_f32_16x16x32_bf16 v[108:111], v[28:31], v[172:175], v[108:111]
    ds_read_b64_tr_b16 v[46:47], v5 offset:25088
    s_add_u32 s64, s64, 1
    s_waitcnt lgkmcnt(4)
    v_mfma_f32_16x16x32_bf16 v[80:83], v[32:35], v[176:179], v[80:83]
    ds_read_b64_tr_b16 v[24:25], v2 offset:18432
    v_mfma_f32_16x16x32_bf16 v[96:99], v[32:35], v[180:183], v[96:99]
    ds_read_b64_tr_b16 v[26:27], v2 offset:18944
    v_mfma_f32_16x16x32_bf16 v[88:91], v[36:39], v[176:179], v[88:91]
    buffer_load_dwordx4 v6, s[20:23], s13 offen offset:1024 lds
    ds_read_b64_tr_b16 v[28:29], v2 offset:26624
    v_mfma_f32_16x16x32_bf16 v[104:107], v[36:39], v[180:183], v[104:107]
    ds_read_b64_tr_b16 v[30:31], v2 offset:27136
    s_waitcnt lgkmcnt(4)
    v_mfma_f32_16x16x32_bf16 v[84:87], v[40:43], v[176:179], v[84:87]
    ds_read_b64_tr_b16 v[32:33], v3 offset:18432
    v_mfma_f32_16x16x32_bf16 v[100:103], v[40:43], v[180:183], v[100:103]
    ds_read_b64_tr_b16 v[34:35], v3 offset:18944
    v_mfma_f32_16x16x32_bf16 v[92:95], v[44:47], v[176:179], v[92:95]
    ds_read_b64_tr_b16 v[36:37], v3 offset:26624
    v_mfma_f32_16x16x32_bf16 v[108:111], v[44:47], v[180:183], v[108:111]
    ds_read_b64_tr_b16 v[38:39], v3 offset:27136
    s_waitcnt vmcnt(2) lgkmcnt(4)
    v_cmp_eq_u32 vcc, 0, v19
    s_cbranch_vccnz gm_ini2
gm_ini2b:
    v_mfma_f32_16x16x32_bf16 v[48:51], v[24:27], v[184:187], v[48:51]
    ds_add_u32 v11, v13
    v_add_u32 v22, 2, v22
    buffer_store_dword v22, v23, s[24:27], s90 offen sc1
    ds_read_b64_tr_b16 v[40:41], v2 offset:32768
    v_mfma_f32_16x16x32_bf16 v[64:67], v[24:27], v[188:191], v[64:67]
    ds_read_b64_tr_b16 v[42:43], v2 offset:33280
    v_mfma_f32_16x16x32_bf16 v[56:59], v[28:31], v[184:187], v[56:59]
    buffer_load_dwordx4 v6, s[20:23], s14 offen offset:2048 lds
    ds_read_b64_tr_b16 v[44:45], v2 offset:40960
    v_mfma_f32_16x16x32_bf16 v[72:75], v[28:31], v[188:191], v[72:75]
    ds_read_b64_tr_b16 v[46:47], v2 offset:41472
    s_waitcnt lgkmcnt(4)
    v_mfma_f32_16x16x32_bf16 v[52:55], v[32:35], v[184:187], v[52:55]
    ds_read_b64_tr_b16 v[24:25], v3 offset:32768
    v_mfma_f32_16x16x32_bf16 v[68:71], v[32:35], v[188:191], v[68:71]
    ds_read_b64_tr_b16 v[26:27], v3 offset:33280
    v_mfma_f32_16x16x32_bf16 v[60:63], v[36:39], v[184:187], v[60:63]
    ds_read_b64_tr_b16 v[28:29], v3 offset:40960
    v_mfma_f32_16x16x32_bf16 v[76:79], v[36:39], v[188:191], v[76:79]
    ds_read_b64_tr_b16 v[30:31], v3 offset:41472
    s_waitcnt lgkmcnt(4)
    v_mfma_f32_16x16x32_bf16 v[48:51], v[40:43], v[192:195], v[48:51]
    ds_read_b64_tr_b16 v[32:33], v2 offset:34816
    v_mfma_f32_16x16x32_bf16 v[64:67], v[40:43], v[196:199], v[64:67]
    ds_read_b64_tr_b16 v[34:35], v2 offset:35328
    v_mfma_f32_16x16x32_bf16 v[56:59], v[44:47], v[192:195], v[56:59]
    buffer_load_dwordx4 v6, s[20:23], s15 offen offset:3072 lds
    ds_read_b64_tr_b16 v[36:37], v2 offset:43008
    v_mfma_f32_16x16x32_bf16 v[72:75], v[44:47], v[196:199], v[72:75]
    ds_read_b64_tr_b16 v[38:39], v2 offset:43520
    s_waitcnt lgkmcnt(4)
    v_mfma_f32_16x16x32_bf16 v[52:55], v[24:27], v[192:195], v[52:55]
    ds_read_b64_tr_b16 v[40:41], v3 offset:34816
    v_mfma_f32_16x16x32_bf16 v[68:71], v[24:27], v[196:199], v[68:71]
    ds_read_b64_tr_b16 v[42:43], v3 offset:35328
    v_mfma_f32_16x16x32_bf16 v[60:63], v[28:31], v[192:195], v[60:63]
    ds_read_b64_tr_b16 v[44:45], v3 offset:43008
    v_mfma_f32_16x16x32_bf16 v[76:79], v[28:31], v[196:199], v[76:79]
    ds_read_b64_tr_b16 v[46:47], v3 offset:43520
    s_waitcnt lgkmcnt(4)
    v_add_u32 v2, 49152, v2
    v_add_u32 v3, 49152, v3
    s_add_u32 m0, s60, 16384
    v_mfma_f32_16x16x32_bf16 v[48:51], v[32:35], v[200:203], v[48:51]
    ds_read_b64_tr_b16 v[24:25], v2 offset:0
    v_mfma_f32_16x16x32_bf16 v[64:67], v[32:35], v[204:207], v[64:67]
    ds_read_b64_tr_b16 v[26:27], v2 offset:512
    v_mfma_f32_16x16x32_bf16 v[56:59], v[36:39], v[200:203], v[56:59]
    buffer_load_dwordx4 v6, s[20:23], s16 offen offset:0 lds
    ds_read_b64_tr_b16 v[28:29], v2 offset:8192
    v_mfma_f32_16x16x32_bf16 v[72:75], v[36:39], v[204:207], v[72:75]
    ds_read_b64_tr_b16 v[30:31], v2 offset:8704
    s_waitcnt lgkmcnt(4)
    v_mfma_f32_16x16x32_bf16 v[52:55], v[40:43], v[200:203], v[52:55]
    ds_read_b64_tr_b16 v[32:33], v3 offset:0
    v_mfma_f32_16x16x32_bf16 v[68:71], v[40:43], v[204:207], v[68:71]
    ds_read_b64_tr_b16 v[34:35], v3 offset:512
    v_mfma_f32_16x16x32_bf16 v[60:63], v[44:47], v[200:203], v[60:63]
    ds_read_b64_tr_b16 v[36:37], v3 offset:8192
    v_mfma_f32_16x16x32_bf16 v[76:79], v[44:47], v[204:207], v[76:79]
    ds_read_b64_tr_b16 v[38:39], v3 offset:8704
    s_waitcnt lgkmcnt(4)
    v_mfma_f32_16x16x32_bf16 v[48:51], v[24:27], v[208:211], v[48:51]
    ds_read_b64_tr_b16 v[40:41], v2 offset:2048
    v_mfma_f32_16x16x32_bf16 v[64:67], v[24:27], v[212:215], v[64:67]
    ds_read_b64_tr_b16 v[42:43], v2 offset:2560
    v_mfma_f32_16x16x32_bf16 v[56:59], v[28:31], v[208:211], v[56:59]
    buffer_load_dwordx4 v6, s[20:23], s17 offen offset:1024 lds
    ds_read_b64_tr_b16 v[44:45], v2 offset:10240
    v_mfma_f32_16x16x32_bf16 v[72:75], v[28:31], v[212:215], v[72:75]
    ds_read_b64_tr_b16 v[46:47], v2 offset:10752
    s_waitcnt lgkmcnt(4)
    v_mfma_f32_16x16x32_bf16 v[52:55], v[32:35], v[208:211], v[52:55]
    ds_read_b32 v14, v12
    ds_read_b64_tr_b16 v[24:25], v3 offset:2048
    v_mfma_f32_16x16x32_bf16 v[68:71], v[32:35], v[212:215], v[68:71]
    ds_read_b64_tr_b16 v[26:27], v3 offset:2560
    v_mfma_f32_16x16x32_bf16 v[60:63], v[36:39], v[208:211], v[60:63]
    ds_read_b64_tr_b16 v[28:29], v3 offset:10240
    v_mfma_f32_16x16x32_bf16 v[76:79], v[36:39], v[212:215], v[76:79]
    ds_read_b64_tr_b16 v[30:31], v3 offset:10752
    s_waitcnt lgkmcnt(4)
    v_cmp_gt_u32 vcc, s64, v14
    s_cbranch_vccnz gm_plr3
gm_plr3b:
    v_mfma_f32_16x16x32_bf16 v[48:51], v[40:43], v[216:219], v[48:51]
    ds_read_b64_tr_b16 v[32:33], v2 offset:16384
    v_mfma_f32_16x16x32_bf16 v[64:67], v[40:43], v[220:223], v[64:67]
    ds_read_b64_tr_b16 v[34:35], v2 offset:16896
    v_mfma_f32_16x16x32_bf16 v[56:59], v[44:47], v[216:219], v[56:59]
    buffer_load_dwordx4 v6, s[20:23], s18 offen offset:2048 lds
    ds_read_b64_tr_b16 v[36:37], v2 offset:24576
    v_mfma_f32_16x16x32_bf16 v[72:75], v[44:47], v[220:223], v[72:75]
    ds_read_b64_tr_b16 v[38:39], v2 offset:25088
    s_waitcnt lgkmcnt(4)
    v_mfma_f32_16x16x32_bf16 v[52:55], v[24:27], v[216:219], v[52:55]
    ds_read_b64_tr_b16 v[40:41], v3 offset:16384
    v_mfma_f32_16x16x32_bf16 v[68:71], v[24:27], v[220:223], v[68:71]
    ds_read_b64_tr_b16 v[42:43], v3 offset:16896
    v_mfma_f32_16x16x32_bf16 v[60:63], v[28:31], v[216:219], v[60:63]
    buffer_load_dwordx4 v6, s[20:23], s19 offen offset:3072 lds
    ds_read_b64_tr_b16 v[44:45], v3 offset:24576
    v_mfma_f32_16x16x32_bf16 v[76:79], v[28:31], v[220:223], v[76:79]
    ds_read_b64_tr_b16 v[46:47], v3 offset:25088
    s_add_u32 s64, s64, 1
    s_waitcnt lgkmcnt(4)
    s_add_u32 m0, s60, 32768
    v_mfma_f32_16x16x32_bf16 v[48:51], v[32:35], v[224:227], v[48:51]
    ds_read_b64_tr_b16 v[24:25], v2 offset:18432
    v_mfma_f32_16x16x32_bf16 v[64:67], v[32:35], v[228:231], v[64:67]
    ds_read_b64_tr_b16 v[26:27], v2 offset:18944
    v_mfma_f32_16x16x32_bf16 v[56:59], v[36:39], v[224:227], v[56:59]
    buffer_load_dwordx4 v6, s[20:23], s32 offen offset:0 lds
    ds_read_b64_tr_b16 v[28:29], v2 offset:26624
    v_mfma_f32_16x16x32_bf16 v[72:75], v[36:39], v[228:231], v[72:75]
    ds_read_b64_tr_b16 v[30:31], v2 offset:27136
    s_waitcnt lgkmcnt(4)
    v_mfma_f32_16x16x32_bf16 v[52:55], v[40:43], v[224:227], v[52:55]
    ds_read_b64_tr_b16 v[32:33], v3 offset:18432
    v_mfma_f32_16x16x32_bf16 v[68:71], v[40:43], v[228:231], v[68:71]
    ds_read_b64_tr_b16 v[34:35], v3 offset:18944
    v_mfma_f32_16x16x32_bf16 v[60:63], v[44:47], v[224:227], v[60:63]
    buffer_load_dwordx4 v6, s[20:23], s33 offen offset:1024 lds
    ds_read_b64_tr_b16 v[36:37], v3 offset:26624
    v_mfma_f32_16x16x32_bf16 v[76:79], v[44:47], v[228:231], v[76:79]
    ds_read_b64_tr_b16 v[38:39], v3 offset:27136
    s_waitcnt vmcnt(11) lgkmcnt(4)
    v_mfma_f32_16x16x32_bf16 v[48:51], v[24:27], v[232:235], v[48:51]
    ds_add_u32 v11, v13
    ds_read_b64_tr_b16 v[40:41], v2 offset:32768
    v_mfma_f32_16x16x32_bf16 v[64:67], v[24:27], v[236:239], v[64:67]
    ds_read_b64_tr_b16 v[42:43], v2 offset:33280
    v_mfma_f32_16x16x32_bf16 v[56:59], v[28:31], v[232:235], v[56:59]
    buffer_load_dwordx4 v6, s[20:23], s34 offen offset:2048 lds
    ds_read_b64_tr_b16 v[44:45], v2 offset:40960
    v_mfma_f32_16x16x32_bf16 v[72:75], v[28:31], v[236:239], v[72:75]
    ds_read_b64_tr_b16 v[46:47], v2 offset:41472
    s_waitcnt lgkmcnt(4)
    v_mfma_f32_16x16x32_bf16 v[52:55], v[32:35], v[232:235], v[52:55]
    ds_read_b64_tr_b16 v[24:25], v3 offset:32768
    v_mfma_f32_16x16x32_bf16 v[68:71], v[32:35], v[236:239], v[68:71]
    ds_read_b64_tr_b16 v[26:27], v3 offset:33280
    v_mfma_f32_16x16x32_bf16 v[60:63], v[36:39], v[232:235], v[60:63]
    buffer_load_dwordx4 v6, s[20:23], s35 offen offset:3072 lds
    ds_read_b64_tr_b16 v[28:29], v3 offset:40960
    v_mfma_f32_16x16x32_bf16 v[76:79], v[36:39], v[236:239], v[76:79]
    ds_read_b64_tr_b16 v[30:31], v3 offset:41472
    s_waitcnt lgkmcnt(4)
    v_mfma_f32_16x16x32_bf16 v[48:51], v[40:43], v[240:243], v[48:51]
    ds_read_b64_tr_b16 v[32:33], v2 offset:34816
    v_mfma_f32_16x16x32_bf16 v[64:67], v[40:43], v[244:247], v[64:67]
    ds_read_b64_tr_b16 v[34:35], v2 offset:35328
    v_mfma_f32_16x16x32_bf16 v[56:59], v[44:47], v[240:243], v[56:59]
    ds_read_b64_tr_b16 v[36:37], v2 offset:43008
    v_mfma_f32_16x16x32_bf16 v[72:75], v[44:47], v[244:247], v[72:75]
    ds_read_b64_tr_b16 v[38:39], v2 offset:43520
    s_waitcnt lgkmcnt(4)
    s_add_u32 m0, s60, 49152
    v_mfma_f32_16x16x32_bf16 v[52:55], v[24:27], v[240:243], v[52:55]
    ds_read_b64_tr_b16 v[40:41], v3 offset:34816
    v_mfma_f32_16x16x32_bf16 v[68:71], v[24:27], v[244:247], v[68:71]
    ds_read_b64_tr_b16 v[42:43], v3 offset:35328
    v_mfma_f32_16x16x32_bf16 v[60:63], v[28:31], v[240:243], v[60:63]
    buffer_load_dwordx4 v6, s[20:23], s36 offen offset:0 lds
    ds_read_b64_tr_b16 v[44:45], v3 offset:43008
    v_mfma_f32_16x16x32_bf16 v[76:79], v[28:31], v[244:247], v[76:79]
    ds_read_b64_tr_b16 v[46:47], v3 offset:43520
    v_subrev_u32 v2, 98304, v2
    v_subrev_u32 v3, 98304, v3
    s_waitcnt lgkmcnt(4)
    v_mfma_f32_16x16x32_bf16 v[48:51], v[32:35], v[248:251], v[48:51]
    ds_read_b64_tr_b16 v[24:25], v4 offset:18432
    v_mfma_f32_16x16x32_bf16 v[64:67], v[32:35], v[252:255], v[64:67]
    ds_read_b64_tr_b16 v[26:27], v4 offset:18944
    v_mfma_f32_16x16x32_bf16 v[56:59], v[36:39], v[248:251], v[56:59]
    buffer_load_dwordx4 v6, s[20:23], s37 offen offset:1024 lds
    ds_read_b64_tr_b16 v[28:29], v4 offset:26624
    v_mfma_f32_16x16x32_bf16 v[72:75], v[36:39], v[252:255], v[72:75]
    ds_read_b64_tr_b16 v[30:31], v4 offset:27136
    s_waitcnt lgkmcnt(4)
    v_mfma_f32_16x16x32_bf16 v[52:55], v[40:43], v[248:251], v[52:55]
    ds_read_b64_tr_b16 v[32:33], v5 offset:18432
    v_mfma_f32_16x16x32_bf16 v[68:71], v[40:43], v[252:255], v[68:71]
    ds_read_b64_tr_b16 v[34:35], v5 offset:18944
    v_mfma_f32_16x16x32_bf16 v[60:63], v[44:47], v[248:251], v[60:63]
    ds_read_b64_tr_b16 v[36:37], v5 offset:26624
    v_mfma_f32_16x16x32_bf16 v[76:79], v[44:47], v[252:255], v[76:79]
    ds_read_b64_tr_b16 v[38:39], v5 offset:27136
    s_waitcnt lgkmcnt(4)
    v_mfma_f32_16x16x32_bf16 v[80:83], v[24:27], v[184:187], v[80:83]
    ds_read_b64_tr_b16 v[40:41], v4 offset:32768
    v_mfma_f32_16x16x32_bf16 v[96:99], v[24:27], v[188:191], v[96:99]
    ds_read_b64_tr_b16 v[42:43], v4 offset:33280
    v_mfma_f32_16x16x32_bf16 v[88:91], v[28:31], v[184:187], v[88:91]
    buffer_load_dwordx4 v6, s[20:23], s38 offen offset:2048 lds
    ds_read_b64_tr_b16 v[44:45], v4 offset:40960
    v_mfma_f32_16x16x32_bf16 v[104:107], v[28:31], v[188:191], v[104:107]
    ds_read_b64_tr_b16 v[46:47], v4 offset:41472
    s_waitcnt lgkmcnt(4)
    v_mfma_f32_16x16x32_bf16 v[84:87], v[32:35], v[184:187], v[84:87]
    ds_read_b32 v14, v12
    ds_read_b64_tr_b16 v[24:25], v5 offset:32768
    v_mfma_f32_16x16x32_bf16 v[100:103], v[32:35], v[188:191], v[100:103]
    ds_read_b64_tr_b16 v[26:27], v5 offset:33280
    v_mfma_f32_16x16x32_bf16 v[92:95], v[36:39], v[184:187], v[92:95]
    buffer_load_dwordx4 v6, s[20:23], s39 offen offset:3072 lds
    ds_read_b64_tr_b16 v[28:29], v5 offset:40960
    v_mfma_f32_16x16x32_bf16 v[108:111], v[36:39], v[188:191], v[108:111]
    ds_read_b64_tr_b16 v[30:31], v5 offset:41472
    v_mul_f32 v56, v48, v56
    v_mul_f32 v57, v49, v57
    s_waitcnt lgkmcnt(4)
    v_cmp_gt_u32 vcc, s64, v14
    s_cbranch_vccnz gm_plr4
gm_plr4b:
    v_mfma_f32_16x16x32_bf16 v[80:83], v[40:43], v[192:195], v[80:83]
    ds_read_b64_tr_b16 v[32:33], v4 offset:34816
    v_mul_f32 v58, v50, v58
    v_mfma_f32_16x16x32_bf16 v[96:99], v[40:43], v[196:199], v[96:99]
    ds_read_b64_tr_b16 v[34:35], v4 offset:35328
    v_exp_f32 v48, -v48
    v_mul_f32 v59, v51, v59
    v_mfma_f32_16x16x32_bf16 v[88:91], v[44:47], v[192:195], v[88:91]
    ds_read_b64_tr_b16 v[36:37], v4 offset:43008
    v_exp_f32 v49, -v49
    v_mfma_f32_16x16x32_bf16 v[104:107], v[44:47], v[196:199], v[104:107]
    ds_read_b64_tr_b16 v[38:39], v4 offset:43520
    v_mul_f32 v60, v52, v60
    s_waitcnt lgkmcnt(4)
    s_add_u32 m0, s60, 65536
    v_mfma_f32_16x16x32_bf16 v[84:87], v[24:27], v[192:195], v[84:87]
    ds_read_b64_tr_b16 v[40:41], v5 offset:34816
    v_exp_f32 v50, -v50
    v_fma_f32 v48, v48, v9, v9
    v_mfma_f32_16x16x32_bf16 v[100:103], v[24:27], v[196:199], v[100:103]
    ds_read_b64_tr_b16 v[42:43], v5 offset:35328
    v_mul_f32 v61, v53, v61
    v_mfma_f32_16x16x32_bf16 v[92:95], v[28:31], v[192:195], v[92:95]
    buffer_load_dwordx4 v6, s[20:23], s40 offen offset:0 lds
    ds_read_b64_tr_b16 v[44:45], v5 offset:43008
    v_exp_f32 v51, -v51
    v_fma_f32 v49, v49, v9, v9
    v_mfma_f32_16x16x32_bf16 v[108:111], v[28:31], v[196:199], v[108:111]
    ds_read_b64_tr_b16 v[46:47], v5 offset:43520
    s_add_u32 s64, s64, 1
    v_mul_f32 v62, v54, v62
    s_waitcnt lgkmcnt(4)
    v_add_u32 v4, 49152, v4
    v_add_u32 v5, 49152, v5
    v_mfma_f32_16x16x32_bf16 v[80:83], v[32:35], v[200:203], v[80:83]
    ds_read_b64_tr_b16 v[24:25], v4 offset:0
    v_exp_f32 v52, -v52
    v_mfma_f32_16x16x32_bf16 v[96:99], v[32:35], v[204:207], v[96:99]
    ds_read_b64_tr_b16 v[26:27], v4 offset:512
    v_fma_f32 v50, v50, v9, v9
    v_rcp_f32 v48, v48
    v_mfma_f32_16x16x32_bf16 v[88:91], v[36:39], v[200:203], v[88:91]
    buffer_load_dwordx4 v6, s[20:23], s41 offen offset:1024 lds
    ds_read_b64_tr_b16 v[28:29], v4 offset:8192
    v_mul_f32 v63, v55, v63
    v_mfma_f32_16x16x32_bf16 v[104:107], v[36:39], v[204:207], v[104:107]
    ds_read_b64_tr_b16 v[30:31], v4 offset:8704
    v_exp_f32 v53, -v53
    v_fma_f32 v51, v51, v9, v9
    s_waitcnt lgkmcnt(4)
    v_mfma_f32_16x16x32_bf16 v[84:87], v[40:43], v[200:203], v[84:87]
    ds_read_b64_tr_b16 v[32:33], v5 offset:0
    v_rcp_f32 v49, v49
    v_mfma_f32_16x16x32_bf16 v[100:103], v[40:43], v[204:207], v[100:103]
    ds_read_b64_tr_b16 v[34:35], v5 offset:512
    v_exp_f32 v54, -v54
    v_mfma_f32_16x16x32_bf16 v[92:95], v[44:47], v[200:203], v[92:95]
    ds_read_b64_tr_b16 v[36:37], v5 offset:8192
    v_fma_f32 v52, v52, v9, v9
    v_rcp_f32 v50, v50
    v_mfma_f32_16x16x32_bf16 v[108:111], v[44:47], v[204:207], v[108:111]
    ds_read_b64_tr_b16 v[38:39], v5 offset:8704
    v_mul_f32 v56, v56, v48
    s_waitcnt vmcnt(8) lgkmcnt(4)
    v_mfma_f32_16x16x32_bf16 v[80:83], v[24:27], v[208:211], v[80:83]
    ds_add_u32 v11, v13
    ds_read_b64_tr_b16 v[40:41], v4 offset:2048
    v_exp_f32 v55, -v55
    v_fma_f32 v53, v53, v9, v9
    v_mfma_f32_16x16x32_bf16 v[96:99], v[24:27], v[212:215], v[96:99]
    ds_read_b64_tr_b16 v[42:43], v4 offset:2560
    v_rcp_f32 v51, v51
    v_mfma_f32_16x16x32_bf16 v[88:91], v[28:31], v[208:211], v[88:91]
    ds_read_b64_tr_b16 v[44:45], v4 offset:10240
    v_mul_f32 v57, v57, v49
    v_mfma_f32_16x16x32_bf16 v[104:107], v[28:31], v[212:215], v[104:107]
    ds_read_b64_tr_b16 v[46:47], v4 offset:10752
    v_fma_f32 v54, v54, v9, v9
    v_rcp_f32 v52, v52
    s_waitcnt lgkmcnt(4)
    v_mfma_f32_16x16x32_bf16 v[84:87], v[32:35], v[208:211], v[84:87]
    ds_read_b64_tr_b16 v[24:25], v5 offset:2048
    v_mul_f32 v58, v58, v50
    v_mfma_f32_16x16x32_bf16 v[100:103], v[32:35], v[212:215], v[100:103]
    ds_read_b64_tr_b16 v[26:27], v5 offset:2560
    v_fma_f32 v55, v55, v9, v9
    v_rcp_f32 v53, v53
    v_mfma_f32_16x16x32_bf16 v[92:95], v[36:39], v[208:211], v[92:95]
    ds_read_b64_tr_b16 v[28:29], v5 offset:10240
    v_mul_f32 v59, v59, v51
    v_mfma_f32_16x16x32_bf16 v[108:111], v[36:39], v[212:215], v[108:111]
    ds_read_b64_tr_b16 v[30:31], v5 offset:10752
    v_rcp_f32 v54, v54
    s_waitcnt lgkmcnt(4)
    v_mfma_f32_16x16x32_bf16 v[80:83], v[40:43], v[216:219], v[80:83]
    ds_read_b64_tr_b16 v[32:33], v4 offset:16384
    v_mul_f32 v60, v60, v52
    v_rcp_f32 v55, v55
    v_mfma_f32_16x16x32_bf16 v[96:99], v[40:43], v[220:223], v[96:99]
    ds_read_b64_tr_b16 v[34:35], v4 offset:16896
    v_mul_f32 v61, v61, v53
    v_mfma_f32_16x16x32_bf16 v[88:91], v[44:47], v[216:219], v[88:91]
    ds_read_b64_tr_b16 v[36:37], v4 offset:24576
    v_mul_f32 v62, v62, v54
    v_mul_f32 v63, v63, v55
    v_mfma_f32_16x16x32_bf16 v[104:107], v[44:47], v[220:223], v[104:107]
    ds_read_b64_tr_b16 v[38:39], v4 offset:25088
    v_cvt_pk_bf16_f32 v48, v56, v57
    s_waitcnt lgkmcnt(4)
    v_mfma_f32_16x16x32_bf16 v[84:87], v[24:27], v[216:219], v[84:87]
    ds_read_b64_tr_b16 v[40:41], v5 offset:16384
    v_cvt_pk_bf16_f32 v49, v58, v59
    v_mfma_f32_16x16x32_bf16 v[100:103], v[24:27], v[220:223], v[100:103]
    ds_read_b64_tr_b16 v[42:43], v5 offset:16896
    v_cvt_pk_bf16_f32 v50, v60, v61
    v_cvt_pk_bf16_f32 v51, v62, v63
    v_mfma_f32_16x16x32_bf16 v[92:95], v[28:31], v[216:219], v[92:95]
    ds_read_b64_tr_b16 v[44:45], v5 offset:24576
    buffer_store_dwordx4 v[48:51], v7, s[24:27], s65 offen offset:0 sc1
    v_mfma_f32_16x16x32_bf16 v[108:111], v[28:31], v[220:223], v[108:111]
    ds_read_b64_tr_b16 v[46:47], v5 offset:25088
    v_mul_f32 v72, v64, v72
    v_mul_f32 v73, v65, v73
    s_waitcnt lgkmcnt(4)
    v_mfma_f32_16x16x32_bf16 v[80:83], v[32:35], v[224:227], v[80:83]
    ds_read_b64_tr_b16 v[24:25], v4 offset:18432
    v_mul_f32 v74, v66, v74
    v_mfma_f32_16x16x32_bf16 v[96:99], v[32:35], v[228:231], v[96:99]
    ds_read_b64_tr_b16 v[26:27], v4 offset:18944
    v_exp_f32 v64, -v64
    v_mfma_f32_16x16x32_bf16 v[88:91], v[36:39], v[224:227], v[88:91]
    ds_read_b64_tr_b16 v[28:29], v4 offset:26624
    v_mul_f32 v75, v67, v75
    v_exp_f32 v65, -v65
    v_mfma_f32_16x16x32_bf16 v[104:107], v[36:39], v[228:231], v[104:107]
    ds_read_b64_tr_b16 v[30:31], v4 offset:27136
    v_mul_f32 v76, v68, v76
    s_waitcnt lgkmcnt(4)
    v_mfma_f32_16x16x32_bf16 v[84:87], v[40:43], v[224:227], v[84:87]
    ds_read_b64_tr_b16 v[32:33], v5 offset:18432
    v_exp_f32 v66, -v66
    v_fma_f32 v64, v64, v8, v8
    v_mfma_f32_16x16x32_bf16 v[100:103], v[40:43], v[228:231], v[100:103]
    ds_read_b64_tr_b16 v[34:35], v5 offset:18944
    v_mul_f32 v77, v69, v77
    v_mfma_f32_16x16x32_bf16 v[92:95], v[44:47], v[224:227], v[92:95]
    ds_read_b64_tr_b16 v[36:37], v5 offset:26624
    v_exp_f32 v67, -v67
    v_mfma_f32_16x16x32_bf16 v[108:111], v[44:47], v[228:231], v[108:111]
    ds_read_b64_tr_b16 v[38:39], v5 offset:27136
    v_fma_f32 v65, v65, v8, v8
    v_mul_f32 v78, v70, v78
    s_waitcnt lgkmcnt(4)
    v_mfma_f32_16x16x32_bf16 v[80:83], v[24:27], v[232:235], v[80:83]
    ds_read_b64_tr_b16 v[40:41], v4 offset:32768
    v_exp_f32 v68, -v68
    v_mfma_f32_16x16x32_bf16 v[96:99], v[24:27], v[236:239], v[96:99]
    ds_read_b64_tr_b16 v[42:43], v4 offset:33280
    v_fma_f32 v66, v66, v8, v8
    v_rcp_f32 v64, v64
    v_mfma_f32_16x16x32_bf16 v[88:91], v[28:31], v[232:235], v[88:91]
    ds_read_b64_tr_b16 v[44:45], v4 offset:40960
    v_mul_f32 v79, v71, v79
    v_mfma_f32_16x16x32_bf16 v[104:107], v[28:31], v[236:239], v[104:107]
    ds_read_b64_tr_b16 v[46:47], v4 offset:41472
    v_exp_f32 v69, -v69
    s_waitcnt lgkmcnt(4)
    v_mfma_f32_16x16x32_bf16 v[84:87], v[32:35], v[232:235], v[84:87]
    ds_read_b32 v14, v12
    ds_read_b64_tr_b16 v[24:25], v5 offset:32768
    v_fma_f32 v67, v67, v8, v8
    v_rcp_f32 v65, v65
    v_mfma_f32_16x16x32_bf16 v[100:103], v[32:35], v[236:239], v[100:103]
    ds_read_b64_tr_b16 v[26:27], v5 offset:33280
    v_exp_f32 v70, -v70
    v_mfma_f32_16x16x32_bf16 v[92:95], v[36:39], v[232:235], v[92:95]
    ds_read_b64_tr_b16 v[28:29], v5 offset:40960
    v_fma_f32 v68, v68, v8, v8
    v_rcp_f32 v66, v66
    v_mfma_f32_16x16x32_bf16 v[108:111], v[36:39], v[236:239], v[108:111]
    ds_read_b64_tr_b16 v[30:31], v5 offset:41472
    v_mul_f32 v72, v72, v64
    s_waitcnt lgkmcnt(4)
    v_cmp_gt_u32 vcc, s64, v14
    s_cbranch_vccnz gm_plr5
gm_plr5b:
    v_mfma_f32_16x16x32_bf16 v[80:83], v[40:43], v[240:243], v[80:83]
    ds_read_b64_tr_b16 v[32:33], v4 offset:34816
    v_exp_f32 v71, -v71
    v_mfma_f32_16x16x32_bf16 v[96:99], v[40:43], v[244:247], v[96:99]
    ds_read_b64_tr_b16 v[34:35], v4 offset:35328
    v_fma_f32 v69, v69, v8, v8
    v_rcp_f32 v67, v67
    v_mfma_f32_16x16x32_bf16 v[88:91], v[44:47], v[240:243], v[88:91]
    buffer_load_dwordx4 v6, s[20:23], s42 offen offset:2048 lds
    ds_read_b64_tr_b16 v[36:37], v4 offset:43008
    v_mul_f32 v73, v73, v65
    v_mfma_f32_16x16x32_bf16 v[104:107], v[44:47], v[244:247], v[104:107]
    ds_read_b64_tr_b16 v[38:39], v4 offset:43520
    v_fma_f32 v70, v70, v8, v8
    v_rcp_f32 v68, v68
    s_waitcnt lgkmcnt(4)
    v_mfma_f32_16x16x32_bf16 v[84:87], v[24:27], v[240:243], v[84:87]
    ds_read_b64_tr_b16 v[40:41], v5 offset:34816
    v_mul_f32 v74, v74, v66
    v_mfma_f32_16x16x32_bf16 v[100:103], v[24:27], v[244:247], v[100:103]
    ds_read_b64_tr_b16 v[42:43], v5 offset:35328
    v_fma_f32 v71, v71, v8, v8
    v_mfma_f32_16x16x32_bf16 v[92:95], v[28:31], v[240:243], v[92:95]
    ds_read_b64_tr_b16 v[44:45], v5 offset:43008
    v_rcp_f32 v69, v69
    v_mul_f32 v75, v75, v67
    v_mfma_f32_16x16x32_bf16 v[108:111], v[28:31], v[244:247], v[108:111]
    ds_read_b64_tr_b16 v[46:47], v5 offset:43520
    v_subrev_u32 v4, 98304, v4
    v_subrev_u32 v5, 98304, v5
    s_add_u32 s64, s64, 1
    v_rcp_f32 v70, v70
    s_waitcnt lgkmcnt(4)
    v_mfma_f32_16x16x32_bf16 v[80:83], v[32:35], v[248:251], v[80:83]
    ds_read_b64_tr_b16 v[24:25], v2 offset:0
    v_mul_f32 v76, v76, v68
    v_rcp_f32 v71, v71
    v_mfma_f32_16x16x32_bf16 v[96:99], v[32:35], v[252:255], v[96:99]
    ds_read_b64_tr_b16 v[26:27], v2 offset:512
    v_mul_f32 v77, v77, v69
    v_mfma_f32_16x16x32_bf16 v[88:91], v[36:39], v[248:251], v[88:91]
    buffer_load_dwordx4 v6, s[20:23], s43 offen offset:3072 lds
    ds_read_b64_tr_b16 v[28:29], v2 offset:8192
    v_mul_f32 v78, v78, v70
    v_mfma_f32_16x16x32_bf16 v[104:107], v[36:39], v[252:255], v[104:107]
    ds_read_b64_tr_b16 v[30:31], v2 offset:8704
    v_mul_f32 v79, v79, v71
    v_cvt_pk_bf16_f32 v64, v72, v73
    s_waitcnt lgkmcnt(4)
    v_mfma_f32_16x16x32_bf16 v[84:87], v[40:43], v[248:251], v[84:87]
    ds_read_b64_tr_b16 v[32:33], v3 offset:0
    v_cvt_pk_bf16_f32 v65, v74, v75
    v_mfma_f32_16x16x32_bf16 v[100:103], v[40:43], v[252:255], v[100:103]
    ds_read_b64_tr_b16 v[34:35], v3 offset:512
    v_cvt_pk_bf16_f32 v66, v76, v77
    v_cvt_pk_bf16_f32 v67, v78, v79
    v_mfma_f32_16x16x32_bf16 v[92:95], v[44:47], v[248:251], v[92:95]
    ds_read_b64_tr_b16 v[36:37], v3 offset:8192
    buffer_store_dwordx4 v[64:67], v7, s[24:27], s65 offen offset:1024 sc1
    v_mfma_f32_16x16x32_bf16 v[108:111], v[44:47], v[252:255], v[108:111]
    ds_read_b64_tr_b16 v[38:39], v3 offset:8704
    s_add_u32 s65, s73, 2048
    s_add_u32 s73, s73, 4096
    s_add_u32 s66, s66, 1
    s_branch gm_loop
gm_ptail:
    s_mul_i32 s60, s3, 4608
    s_waitcnt lgkmcnt(4)
    v_cmp_gt_u32 vcc, s64, v14
    s_cbranch_vccnz gm_ptr2
gm_ptr2b:
    v_mfma_f32_16x16x32_bf16 v[80:83], v[40:43], v[168:171], v[80:83]
    ds_read_b64_tr_b16 v[32:33], v4 offset:16384
    v_mfma_f32_16x16x32_bf16 v[96:99], v[40:43], v[172:175], v[96:99]
    ds_read_b64_tr_b16 v[34:35], v4 offset:16896
    v_mfma_f32_16x16x32_bf16 v[88:91], v[44:47], v[168:171], v[88:91]
    ds_read_b64_tr_b16 v[36:37], v4 offset:24576
    v_mfma_f32_16x16x32_bf16 v[104:107], v[44:47], v[172:175], v[104:107]
    ds_read_b64_tr_b16 v[38:39], v4 offset:25088
    s_waitcnt lgkmcnt(4)
    v_mfma_f32_16x16x32_bf16 v[84:87], v[24:27], v[168:171], v[84:87]
    ds_read_b64_tr_b16 v[40:41], v5 offset:16384
    v_mfma_f32_16x16x32_bf16 v[100:103], v[24:27], v[172:175], v[100:103]
    ds_read_b64_tr_b16 v[42:43], v5 offset:16896
    v_mfma_f32_16x16x32_bf16 v[92:95], v[28:31], v[168:171], v[92:95]
    ds_read_b64_tr_b16 v[44:45], v5 offset:24576
    v_mfma_f32_16x16x32_bf16 v[108:111], v[28:31], v[172:175], v[108:111]
    ds_read_b64_tr_b16 v[46:47], v5 offset:25088
    s_add_u32 s64, s64, 1
    s_waitcnt lgkmcnt(4)
    v_mfma_f32_16x16x32_bf16 v[80:83], v[32:35], v[176:179], v[80:83]
    ds_read_b64_tr_b16 v[24:25], v2 offset:18432
    v_mfma_f32_16x16x32_bf16 v[96:99], v[32:35], v[180:183], v[96:99]
    ds_read_b64_tr_b16 v[26:27], v2 offset:18944
    v_mfma_f32_16x16x32_bf16 v[88:91], v[36:39], v[176:179], v[88:91]
    ds_read_b64_tr_b16 v[28:29], v2 offset:26624
    v_mfma_f32_16x16x32_bf16 v[104:107], v[36:39], v[180:183], v[104:107]
    ds_read_b64_tr_b16 v[30:31], v2 offset:27136
    s_waitcnt lgkmcnt(4)
    v_mfma_f32_16x16x32_bf16 v[84:87], v[40:43], v[176:179], v[84:87]
    ds_read_b64_tr_b16 v[32:33], v3 offset:18432
    v_mfma_f32_16x16x32_bf16 v[100:103], v[40:43], v[180:183], v[100:103]
    ds_read_b64_tr_b16 v[34:35], v3 offset:18944
    v_mfma_f32_16x16x32_bf16 v[92:95], v[44:47], v[176:179], v[92:95]
    ds_read_b64_tr_b16 v[36:37], v3 offset:26624
    v_mfma_f32_16x16x32_bf16 v[108:111], v[44:47], v[180:183], v[108:111]
    ds_read_b64_tr_b16 v[38:39], v3 offset:27136
    s_waitcnt vmcnt(0) lgkmcnt(4)
    v_mfma_f32_16x16x32_bf16 v[48:51], v[24:27], v[184:187], v[48:51]
    ds_add_u32 v11, v13
    v_add_u32 v22, 2, v22
    buffer_store_dword v22, v23, s[24:27], s90 offen sc1
    ds_read_b64_tr_b16 v[40:41], v2 offset:32768
    v_mfma_f32_16x16x32_bf16 v[64:67], v[24:27], v[188:191], v[64:67]
    ds_read_b64_tr_b16 v[42:43], v2 offset:33280
    v_mfma_f32_16x16x32_bf16 v[56:59], v[28:31], v[184:187], v[56:59]
    ds_read_b64_tr_b16 v[44:45], v2 offset:40960
    v_mfma_f32_16x16x32_bf16 v[72:75], v[28:31], v[188:191], v[72:75]
    ds_read_b64_tr_b16 v[46:47], v2 offset:41472
    s_waitcnt lgkmcnt(4)
    v_mfma_f32_16x16x32_bf16 v[52:55], v[32:35], v[184:187], v[52:55]
    ds_read_b64_tr_b16 v[24:25], v3 offset:32768
    v_mfma_f32_16x16x32_bf16 v[68:71], v[32:35], v[188:191], v[68:71]
    ds_read_b64_tr_b16 v[26:27], v3 offset:33280
    v_mfma_f32_16x16x32_bf16 v[60:63], v[36:39], v[184:187], v[60:63]
    ds_read_b64_tr_b16 v[28:29], v3 offset:40960
    v_mfma_f32_16x16x32_bf16 v[76:79], v[36:39], v[188:191], v[76:79]
    ds_read_b64_tr_b16 v[30:31], v3 offset:41472
    s_waitcnt lgkmcnt(4)
    v_mfma_f32_16x16x32_bf16 v[48:51], v[40:43], v[192:195], v[48:51]
    ds_read_b64_tr_b16 v[32:33], v2 offset:34816
    v_mfma_f32_16x16x32_bf16 v[64:67], v[40:43], v[196:199], v[64:67]
    ds_read_b64_tr_b16 v[34:35], v2 offset:35328
    v_mfma_f32_16x16x32_bf16 v[56:59], v[44:47], v[192:195], v[56:59]
    ds_read_b64_tr_b16 v[36:37], v2 offset:43008
    v_mfma_f32_16x16x32_bf16 v[72:75], v[44:47], v[196:199], v[72:75]
    ds_read_b64_tr_b16 v[38:39], v2 offset:43520
    s_waitcnt lgkmcnt(4)
    v_mfma_f32_16x16x32_bf16 v[52:55], v[24:27], v[192:195], v[52:55]
    ds_read_b64_tr_b16 v[40:41], v3 offset:34816
    v_mfma_f32_16x16x32_bf16 v[68:71], v[24:27], v[196:199], v[68:71]
    ds_read_b64_tr_b16 v[42:43], v3 offset:35328
    v_mfma_f32_16x16x32_bf16 v[60:63], v[28:31], v[192:195], v[60:63]
    ds_read_b64_tr_b16 v[44:45], v3 offset:43008
    v_mfma_f32_16x16x32_bf16 v[76:79], v[28:31], v[196:199], v[76:79]
    ds_read_b64_tr_b16 v[46:47], v3 offset:43520
    s_waitcnt lgkmcnt(4)
    v_add_u32 v2, 49152, v2
    v_add_u32 v3, 49152, v3
    v_mfma_f32_16x16x32_bf16 v[48:51], v[32:35], v[200:203], v[48:51]
    ds_read_b64_tr_b16 v[24:25], v2 offset:0
    v_mfma_f32_16x16x32_bf16 v[64:67], v[32:35], v[204:207], v[64:67]
    ds_read_b64_tr_b16 v[26:27], v2 offset:512
    v_mfma_f32_16x16x32_bf16 v[56:59], v[36:39], v[200:203], v[56:59]
    ds_read_b64_tr_b16 v[28:29], v2 offset:8192
    v_mfma_f32_16x16x32_bf16 v[72:75], v[36:39], v[204:207], v[72:75]
    ds_read_b64_tr_b16 v[30:31], v2 offset:8704
    s_waitcnt lgkmcnt(4)
    v_mfma_f32_16x16x32_bf16 v[52:55], v[40:43], v[200:203], v[52:55]
    ds_read_b64_tr_b16 v[32:33], v3 offset:0
    v_mfma_f32_16x16x32_bf16 v[68:71], v[40:43], v[204:207], v[68:71]
    ds_read_b64_tr_b16 v[34:35], v3 offset:512
    v_mfma_f32_16x16x32_bf16 v[60:63], v[44:47], v[200:203], v[60:63]
    ds_read_b64_tr_b16 v[36:37], v3 offset:8192
    v_mfma_f32_16x16x32_bf16 v[76:79], v[44:47], v[204:207], v[76:79]
    ds_read_b64_tr_b16 v[38:39], v3 offset:8704
    s_waitcnt lgkmcnt(4)
    v_mfma_f32_16x16x32_bf16 v[48:51], v[24:27], v[208:211], v[48:51]
    ds_read_b64_tr_b16 v[40:41], v2 offset:2048
    v_mfma_f32_16x16x32_bf16 v[64:67], v[24:27], v[212:215], v[64:67]
    ds_read_b64_tr_b16 v[42:43], v2 offset:2560
    v_mfma_f32_16x16x32_bf16 v[56:59], v[28:31], v[208:211], v[56:59]
    ds_read_b64_tr_b16 v[44:45], v2 offset:10240
    v_mfma_f32_16x16x32_bf16 v[72:75], v[28:31], v[212:215], v[72:75]
    ds_read_b64_tr_b16 v[46:47], v2 offset:10752
    s_waitcnt lgkmcnt(4)
    v_mfma_f32_16x16x32_bf16 v[52:55], v[32:35], v[208:211], v[52:55]
    ds_read_b32 v14, v12
    ds_read_b64_tr_b16 v[24:25], v3 offset:2048
    v_mfma_f32_16x16x32_bf16 v[68:71], v[32:35], v[212:215], v[68:71]
    ds_read_b64_tr_b16 v[26:27], v3 offset:2560
    v_mfma_f32_16x16x32_bf16 v[60:63], v[36:39], v[208:211], v[60:63]
    ds_read_b64_tr_b16 v[28:29], v3 offset:10240
    v_mfma_f32_16x16x32_bf16 v[76:79], v[36:39], v[212:215], v[76:79]
    ds_read_b64_tr_b16 v[30:31], v3 offset:10752
    s_waitcnt lgkmcnt(4)
    v_cmp_gt_u32 vcc, s64, v14
    s_cbranch_vccnz gm_ptr3
gm_ptr3b:
    v_mfma_f32_16x16x32_bf16 v[48:51], v[40:43], v[216:219], v[48:51]
    ds_read_b64_tr_b16 v[32:33], v2 offset:16384
    v_mfma_f32_16x16x32_bf16 v[64:67], v[40:43], v[220:223], v[64:67]
    ds_read_b64_tr_b16 v[34:35], v2 offset:16896
    v_mfma_f32_16x16x32_bf16 v[56:59], v[44:47], v[216:219], v[56:59]
    ds_read_b64_tr_b16 v[36:37], v2 offset:24576
    v_mfma_f32_16x16x32_bf16 v[72:75], v[44:47], v[220:223], v[72:75]
    ds_read_b64_tr_b16 v[38:39], v2 offset:25088
    s_waitcnt lgkmcnt(4)
    v_mfma_f32_16x16x32_bf16 v[52:55], v[24:27], v[216:219], v[52:55]
    ds_read_b64_tr_b16 v[40:41], v3 offset:16384
    v_readlane_b32 s70, v21, 0
    s_add_u32 m0, s60, 0
    v_mfma_f32_16x16x32_bf16 v[68:71], v[24:27], v[220:223], v[68:71]
    ds_read_b64_tr_b16 v[42:43], v3 offset:16896
    v_mfma_f32_16x16x32_bf16 v[60:63], v[28:31], v[216:219], v[60:63]
    ds_read_b64_tr_b16 v[44:45], v3 offset:24576
    v_mfma_f32_16x16x32_bf16 v[76:79], v[28:31], v[220:223], v[76:79]
    ds_read_b64_tr_b16 v[46:47], v3 offset:25088
    s_add_u32 s64, s64, 1
    buffer_load_dwordx4 v15, s[8:11], s70 offen offset:0 lds
    s_waitcnt lgkmcnt(4)
    v_mfma_f32_16x16x32_bf16 v[48:51], v[32:35], v[224:227], v[48:51]
    ds_read_b64_tr_b16 v[24:25], v2 offset:18432
    v_mfma_f32_16x16x32_bf16 v[64:67], v[32:35], v[228:231], v[64:67]
    ds_read_b64_tr_b16 v[26:27], v2 offset:18944
    v_mfma_f32_16x16x32_bf16 v[56:59], v[36:39], v[224:227], v[56:59]
    ds_read_b64_tr_b16 v[28:29], v2 offset:26624
    buffer_load_dwordx4 v16, s[8:11], s70 offen offset:1024 lds
    v_mfma_f32_16x16x32_bf16 v[72:75], v[36:39], v[228:231], v[72:75]
    ds_read_b64_tr_b16 v[30:31], v2 offset:27136
    s_waitcnt lgkmcnt(4)
    v_mfma_f32_16x16x32_bf16 v[52:55], v[40:43], v[224:227], v[52:55]
    ds_read_b64_tr_b16 v[32:33], v3 offset:18432
    v_mfma_f32_16x16x32_bf16 v[68:71], v[40:43], v[228:231], v[68:71]
    ds_read_b64_tr_b16 v[34:35], v3 offset:18944
    buffer_load_dwordx4 v17, s[8:11], s70 offen offset:2048 lds
    v_mfma_f32_16x16x32_bf16 v[60:63], v[44:47], v[224:227], v[60:63]
    ds_read_b64_tr_b16 v[36:37], v3 offset:26624
    v_mfma_f32_16x16x32_bf16 v[76:79], v[44:47], v[228:231], v[76:79]
    ds_read_b64_tr_b16 v[38:39], v3 offset:27136
    s_waitcnt vmcnt(4) lgkmcnt(4)
    v_mfma_f32_16x16x32_bf16 v[48:51], v[24:27], v[232:235], v[48:51]
    ds_add_u32 v11, v13
    ds_read_b64_tr_b16 v[40:41], v2 offset:32768
    buffer_load_dwordx4 v18, s[8:11], s70 offen offset:3072 lds
    v_mfma_f32_16x16x32_bf16 v[64:67], v[24:27], v[236:239], v[64:67]
    ds_read_b64_tr_b16 v[42:43], v2 offset:33280
    v_mfma_f32_16x16x32_bf16 v[56:59], v[28:31], v[232:235], v[56:59]
    ds_read_b64_tr_b16 v[44:45], v2 offset:40960
    v_mfma_f32_16x16x32_bf16 v[72:75], v[28:31], v[236:239], v[72:75]
    ds_read_b64_tr_b16 v[46:47], v2 offset:41472
    buffer_load_dwordx4 v20, s[8:11], s70 offen offset:3584 lds
    s_waitcnt lgkmcnt(4)
    v_mfma_f32_16x16x32_bf16 v[52:55], v[32:35], v[232:235], v[52:55]
    ds_read_b64_tr_b16 v[24:25], v3 offset:32768
    v_mfma_f32_16x16x32_bf16 v[68:71], v[32:35], v[236:239], v[68:71]
    ds_read_b64_tr_b16 v[26:27], v3 offset:33280
    v_mfma_f32_16x16x32_bf16 v[60:63], v[36:39], v[232:235], v[60:63]
    ds_read_b64_tr_b16 v[28:29], v3 offset:40960
    v_readlane_b32 s70, v21, 1
    s_add_u32 m0, s60, 18432
    v_mfma_f32_16x16x32_bf16 v[76:79], v[36:39], v[236:239], v[76:79]
    ds_read_b64_tr_b16 v[30:31], v3 offset:41472
    s_waitcnt lgkmcnt(4)
    v_mfma_f32_16x16x32_bf16 v[48:51], v[40:43], v[240:243], v[48:51]
    ds_read_b64_tr_b16 v[32:33], v2 offset:34816
    v_mfma_f32_16x16x32_bf16 v[64:67], v[40:43], v[244:247], v[64:67]
    ds_read_b64_tr_b16 v[34:35], v2 offset:35328
    buffer_load_dwordx4 v15, s[8:11], s70 offen offset:0 lds
    v_mfma_f32_16x16x32_bf16 v[56:59], v[44:47], v[240:243], v[56:59]
    ds_read_b64_tr_b16 v[36:37], v2 offset:43008
    v_mfma_f32_16x16x32_bf16 v[72:75], v[44:47], v[244:247], v[72:75]
    ds_read_b64_tr_b16 v[38:39], v2 offset:43520
    s_waitcnt lgkmcnt(4)
    v_mfma_f32_16x16x32_bf16 v[52:55], v[24:27], v[240:243], v[52:55]
    ds_read_b64_tr_b16 v[40:41], v3 offset:34816
    buffer_load_dwordx4 v16, s[8:11], s70 offen offset:1024 lds
    v_mfma_f32_16x16x32_bf16 v[68:71], v[24:27], v[244:247], v[68:71]
    ds_read_b64_tr_b16 v[42:43], v3 offset:35328
    v_mfma_f32_16x16x32_bf16 v[60:63], v[28:31], v[240:243], v[60:63]
    ds_read_b64_tr_b16 v[44:45], v3 offset:43008
    v_mfma_f32_16x16x32_bf16 v[76:79], v[28:31], v[244:247], v[76:79]
    ds_read_b64_tr_b16 v[46:47], v3 offset:43520
    v_subrev_u32 v2, 98304, v2
    v_subrev_u32 v3, 98304, v3
    buffer_load_dwordx4 v17, s[8:11], s70 offen offset:2048 lds
    s_waitcnt lgkmcnt(4)
    v_mfma_f32_16x16x32_bf16 v[48:51], v[32:35], v[248:251], v[48:51]
    ds_read_b64_tr_b16 v[24:25], v4 offset:18432
    v_mfma_f32_16x16x32_bf16 v[64:67], v[32:35], v[252:255], v[64:67]
    ds_read_b64_tr_b16 v[26:27], v4 offset:18944
    v_mfma_f32_16x16x32_bf16 v[56:59], v[36:39], v[248:251], v[56:59]
    ds_read_b64_tr_b16 v[28:29], v4 offset:26624
    buffer_load_dwordx4 v18, s[8:11], s70 offen offset:3072 lds
    v_mfma_f32_16x16x32_bf16 v[72:75], v[36:39], v[252:255], v[72:75]
    ds_read_b64_tr_b16 v[30:31], v4 offset:27136
    s_waitcnt lgkmcnt(4)
    v_mfma_f32_16x16x32_bf16 v[52:55], v[40:43], v[248:251], v[52:55]
    ds_read_b64_tr_b16 v[32:33], v5 offset:18432
    v_mfma_f32_16x16x32_bf16 v[68:71], v[40:43], v[252:255], v[68:71]
    ds_read_b64_tr_b16 v[34:35], v5 offset:18944
    buffer_load_dwordx4 v20, s[8:11], s70 offen offset:3584 lds
    v_mfma_f32_16x16x32_bf16 v[60:63], v[44:47], v[248:251], v[60:63]
    ds_read_b64_tr_b16 v[36:37], v5 offset:26624
    v_mfma_f32_16x16x32_bf16 v[76:79], v[44:47], v[252:255], v[76:79]
    ds_read_b64_tr_b16 v[38:39], v5 offset:27136
    s_waitcnt lgkmcnt(4)
    v_mfma_f32_16x16x32_bf16 v[80:83], v[24:27], v[184:187], v[80:83]
    ds_read_b64_tr_b16 v[40:41], v4 offset:32768
    v_readlane_b32 s67, v0, 0
    v_mfma_f32_16x16x32_bf16 v[96:99], v[24:27], v[188:191], v[96:99]
    ds_read_b64_tr_b16 v[42:43], v4 offset:33280
    v_mfma_f32_16x16x32_bf16 v[88:91], v[28:31], v[184:187], v[88:91]
    ds_read_b64_tr_b16 v[44:45], v4 offset:40960
    v_mfma_f32_16x16x32_bf16 v[104:107], v[28:31], v[188:191], v[104:107]
    ds_read_b64_tr_b16 v[46:47], v4 offset:41472
    buffer_load_dwordx4 v[112:115], v7, s[24:27], s67 offen offset:0 sc1
    s_waitcnt lgkmcnt(4)
    v_mfma_f32_16x16x32_bf16 v[84:87], v[32:35], v[184:187], v[84:87]
    ds_read_b32 v14, v12
    ds_read_b64_tr_b16 v[24:25], v5 offset:32768
    v_mfma_f32_16x16x32_bf16 v[100:103], v[32:35], v[188:191], v[100:103]
    ds_read_b64_tr_b16 v[26:27], v5 offset:33280
    v_mfma_f32_16x16x32_bf16 v[92:95], v[36:39], v[184:187], v[92:95]
    ds_read_b64_tr_b16 v[28:29], v5 offset:40960
    buffer_load_dwordx4 v[116:119], v7, s[24:27], s67 offen offset:1024 sc1
    v_mfma_f32_16x16x32_bf16 v[108:111], v[36:39], v[188:191], v[108:111]
    ds_read_b64_tr_b16 v[30:31], v5 offset:41472
    v_mul_f32 v56, v48, v56
    v_mul_f32 v57, v49, v57
    s_waitcnt lgkmcnt(4)
    v_cmp_gt_u32 vcc, s64, v14
    s_cbranch_vccnz gm_ptr4
gm_ptr4b:
    v_mfma_f32_16x16x32_bf16 v[80:83], v[40:43], v[192:195], v[80:83]
    ds_read_b64_tr_b16 v[32:33], v4 offset:34816
    v_mul_f32 v58, v50, v58
    v_mfma_f32_16x16x32_bf16 v[96:99], v[40:43], v[196:199], v[96:99]
    ds_read_b64_tr_b16 v[34:35], v4 offset:35328
    buffer_load_dwordx4 v[120:123], v7, s[24:27], s67 offen offset:2048 sc1
    v_exp_f32 v48, -v48
    v_mul_f32 v59, v51, v59
    v_mfma_f32_16x16x32_bf16 v[88:91], v[44:47], v[192:195], v[88:91]
    ds_read_b64_tr_b16 v[36:37], v4 offset:43008
    v_exp_f32 v49, -v49
    v_mfma_f32_16x16x32_bf16 v[104:107], v[44:47], v[196:199], v[104:107]
    ds_read_b64_tr_b16 v[38:39], v4 offset:43520
    v_mul_f32 v60, v52, v60
    s_waitcnt lgkmcnt(4)
    v_mfma_f32_16x16x32_bf16 v[84:87], v[24:27], v[192:195], v[84:87]
    ds_read_b64_tr_b16 v[40:41], v5 offset:34816
    buffer_load_dwordx4 v[124:127], v7, s[24:27], s67 offen offset:3072 sc1
    v_exp_f32 v50, -v50
    v_fma_f32 v48, v48, v9, v9
    v_mfma_f32_16x16x32_bf16 v[100:103], v[24:27], v[196:199], v[100:103]
    ds_read_b64_tr_b16 v[42:43], v5 offset:35328
    v_mul_f32 v61, v53, v61
    v_mfma_f32_16x16x32_bf16 v[92:95], v[28:31], v[192:195], v[92:95]
    ds_read_b64_tr_b16 v[44:45], v5 offset:43008
    v_exp_f32 v51, -v51
    v_fma_f32 v49, v49, v9, v9
    v_mfma_f32_16x16x32_bf16 v[108:111], v[28:31], v[196:199], v[108:111]
    ds_read_b64_tr_b16 v[46:47], v5 offset:43520
    s_add_u32 s64, s64, 1
    v_readlane_b32 s70, v21, 2
    s_add_u32 m0, s60, 36864
    v_mul_f32 v62, v54, v62
    s_waitcnt lgkmcnt(4)
    v_add_u32 v4, 49152, v4
    v_add_u32 v5, 49152, v5
    v_mfma_f32_16x16x32_bf16 v[80:83], v[32:35], v[200:203], v[80:83]
    ds_read_b64_tr_b16 v[24:25], v4 offset:0
    v_exp_f32 v52, -v52
    v_mfma_f32_16x16x32_bf16 v[96:99], v[32:35], v[204:207], v[96:99]
    ds_read_b64_tr_b16 v[26:27], v4 offset:512
    v_fma_f32 v50, v50, v9, v9
    v_rcp_f32 v48, v48
    v_mfma_f32_16x16x32_bf16 v[88:91], v[36:39], v[200:203], v[88:91]
    ds_read_b64_tr_b16 v[28:29], v4 offset:8192
    buffer_load_dwordx4 v15, s[8:11], s70 offen offset:0 lds
    v_mul_f32 v63, v55, v63
    v_mfma_f32_16x16x32_bf16 v[104:107], v[36:39], v[204:207], v[104:107]
    ds_read_b64_tr_b16 v[30:31], v4 offset:8704
    v_exp_f32 v53, -v53
    v_fma_f32 v51, v51, v9, v9
    s_waitcnt lgkmcnt(4)
    v_mfma_f32_16x16x32_bf16 v[84:87], v[40:43], v[200:203], v[84:87]
    ds_read_b64_tr_b16 v[32:33], v5 offset:0
    v_rcp_f32 v49, v49
    v_mfma_f32_16x16x32_bf16 v[100:103], v[40:43], v[204:207], v[100:103]
    ds_read_b64_tr_b16 v[34:35], v5 offset:512
    buffer_load_dwordx4 v16, s[8:11], s70 offen offset:1024 lds
    v_exp_f32 v54, -v54
    v_mfma_f32_16x16x32_bf16 v[92:95], v[44:47], v[200:203], v[92:95]
    ds_read_b64_tr_b16 v[36:37], v5 offset:8192
    v_fma_f32 v52, v52, v9, v9
    v_rcp_f32 v50, v50
    v_mfma_f32_16x16x32_bf16 v[108:111], v[44:47], v[204:207], v[108:111]
    ds_read_b64_tr_b16 v[38:39], v5 offset:8704
    v_mul_f32 v56, v56, v48
    s_waitcnt vmcnt(17) lgkmcnt(4)
    v_mfma_f32_16x16x32_bf16 v[80:83], v[24:27], v[208:211], v[80:83]
    ds_add_u32 v11, v13
    ds_read_b64_tr_b16 v[40:41], v4 offset:2048
    buffer_load_dwordx4 v17, s[8:11], s70 offen offset:2048 lds
    v_exp_f32 v55, -v55
    v_fma_f32 v53, v53, v9, v9
    v_mfma_f32_16x16x32_bf16 v[96:99], v[24:27], v[212:215], v[96:99]
    ds_read_b64_tr_b16 v[42:43], v4 offset:2560
    v_rcp_f32 v51, v51
    v_mfma_f32_16x16x32_bf16 v[88:91], v[28:31], v[208:211], v[88:91]
    ds_read_b64_tr_b16 v[44:45], v4 offset:10240
    v_mul_f32 v57, v57, v49
    v_mfma_f32_16x16x32_bf16 v[104:107], v[28:31], v[212:215], v[104:107]
    ds_read_b64_tr_b16 v[46:47], v4 offset:10752
    buffer_load_dwordx4 v18, s[8:11], s70 offen offset:3072 lds
    v_fma_f32 v54, v54, v9, v9
    v_rcp_f32 v52, v52
    s_waitcnt lgkmcnt(4)
    v_mfma_f32_16x16x32_bf16 v[84:87], v[32:35], v[208:211], v[84:87]
    ds_read_b64_tr_b16 v[24:25], v5 offset:2048
    v_mul_f32 v58, v58, v50
    v_mfma_f32_16x16x32_bf16 v[100:103], v[32:35], v[212:215], v[100:103]
    ds_read_b64_tr_b16 v[26:27], v5 offset:2560
    v_fma_f32 v55, v55, v9, v9
    v_rcp_f32 v53, v53
    v_mfma_f32_16x16x32_bf16 v[92:95], v[36:39], v[208:211], v[92:95]
    ds_read_b64_tr_b16 v[28:29], v5 offset:10240
    buffer_load_dwordx4 v20, s[8:11], s70 offen offset:3584 lds
    v_mul_f32 v59, v59, v51
    v_mfma_f32_16x16x32_bf16 v[108:111], v[36:39], v[212:215], v[108:111]
    ds_read_b64_tr_b16 v[30:31], v5 offset:10752
    v_rcp_f32 v54, v54
    s_waitcnt lgkmcnt(4)
    v_mfma_f32_16x16x32_bf16 v[80:83], v[40:43], v[216:219], v[80:83]
    ds_read_b64_tr_b16 v[32:33], v4 offset:16384
    v_mul_f32 v60, v60, v52
    v_rcp_f32 v55, v55
    v_mfma_f32_16x16x32_bf16 v[96:99], v[40:43], v[220:223], v[96:99]
    ds_read_b64_tr_b16 v[34:35], v4 offset:16896
    v_readlane_b32 s67, v0, 1
    v_mul_f32 v61, v61, v53
    v_mfma_f32_16x16x32_bf16 v[88:91], v[44:47], v[216:219], v[88:91]
    ds_read_b64_tr_b16 v[36:37], v4 offset:24576
    v_mul_f32 v62, v62, v54
    v_mul_f32 v63, v63, v55
    v_mfma_f32_16x16x32_bf16 v[104:107], v[44:47], v[220:223], v[104:107]
    ds_read_b64_tr_b16 v[38:39], v4 offset:25088
    v_cvt_pk_bf16_f32 v48, v56, v57
    s_waitcnt lgkmcnt(4)
    v_mfma_f32_16x16x32_bf16 v[84:87], v[24:27], v[216:219], v[84:87]
    ds_read_b64_tr_b16 v[40:41], v5 offset:16384
    buffer_load_dwordx4 v[128:131], v7, s[24:27], s67 offen offset:0 sc1
    v_cvt_pk_bf16_f32 v49, v58, v59
    v_mfma_f32_16x16x32_bf16 v[100:103], v[24:27], v[220:223], v[100:103]
    ds_read_b64_tr_b16 v[42:43], v5 offset:16896
    v_cvt_pk_bf16_f32 v50, v60, v61
    v_cvt_pk_bf16_f32 v51, v62, v63
    v_mfma_f32_16x16x32_bf16 v[92:95], v[28:31], v[216:219], v[92:95]
    ds_read_b64_tr_b16 v[44:45], v5 offset:24576
    buffer_store_dwordx4 v[48:51], v7, s[24:27], s65 offen offset:0 sc1
    v_mfma_f32_16x16x32_bf16 v[108:111], v[28:31], v[220:223], v[108:111]
    ds_read_b64_tr_b16 v[46:47], v5 offset:25088
    buffer_load_dwordx4 v[132:135], v7, s[24:27], s67 offen offset:1024 sc1
    v_mul_f32 v72, v64, v72
    v_mul_f32 v73, v65, v73
    s_waitcnt lgkmcnt(4)
    v_mfma_f32_16x16x32_bf16 v[80:83], v[32:35], v[224:227], v[80:83]
    ds_read_b64_tr_b16 v[24:25], v4 offset:18432
    v_mul_f32 v74, v66, v74
    v_mfma_f32_16x16x32_bf16 v[96:99], v[32:35], v[228:231], v[96:99]
    ds_read_b64_tr_b16 v[26:27], v4 offset:18944
    v_exp_f32 v64, -v64
    v_mfma_f32_16x16x32_bf16 v[88:91], v[36:39], v[224:227], v[88:91]
    ds_read_b64_tr_b16 v[28:29], v4 offset:26624
    buffer_load_dwordx4 v[136:139], v7, s[24:27], s67 offen offset:2048 sc1
    v_mul_f32 v75, v67, v75
    v_exp_f32 v65, -v65
    v_mfma_f32_16x16x32_bf16 v[104:107], v[36:39], v[228:231], v[104:107]
    ds_read_b64_tr_b16 v[30:31], v4 offset:27136
    v_mul_f32 v76, v68, v76
    s_waitcnt lgkmcnt(4)
    v_mfma_f32_16x16x32_bf16 v[84:87], v[40:43], v[224:227], v[84:87]
    ds_read_b64_tr_b16 v[32:33], v5 offset:18432
    v_exp_f32 v66, -v66
    v_fma_f32 v64, v64, v8, v8
    v_mfma_f32_16x16x32_bf16 v[100:103], v[40:43], v[228:231], v[100:103]
    ds_read_b64_tr_b16 v[34:35], v5 offset:18944
    buffer_load_dwordx4 v[140:143], v7, s[24:27], s67 offen offset:3072 sc1
    v_mul_f32 v77, v69, v77
    v_mfma_f32_16x16x32_bf16 v[92:95], v[44:47], v[224:227], v[92:95]
    ds_read_b64_tr_b16 v[36:37], v5 offset:26624
    v_exp_f32 v67, -v67
    v_mfma_f32_16x16x32_bf16 v[108:111], v[44:47], v[228:231], v[108:111]
    ds_read_b64_tr_b16 v[38:39], v5 offset:27136
    v_fma_f32 v65, v65, v8, v8
    v_mul_f32 v78, v70, v78
    s_waitcnt lgkmcnt(4)
    v_mfma_f32_16x16x32_bf16 v[80:83], v[24:27], v[232:235], v[80:83]
    ds_read_b64_tr_b16 v[40:41], v4 offset:32768
    v_readlane_b32 s67, v0, 2
    v_exp_f32 v68, -v68
    v_mfma_f32_16x16x32_bf16 v[96:99], v[24:27], v[236:239], v[96:99]
    ds_read_b64_tr_b16 v[42:43], v4 offset:33280
    v_fma_f32 v66, v66, v8, v8
    v_rcp_f32 v64, v64
    v_mfma_f32_16x16x32_bf16 v[88:91], v[28:31], v[232:235], v[88:91]
    ds_read_b64_tr_b16 v[44:45], v4 offset:40960
    v_mul_f32 v79, v71, v79
    v_mfma_f32_16x16x32_bf16 v[104:107], v[28:31], v[236:239], v[104:107]
    ds_read_b64_tr_b16 v[46:47], v4 offset:41472
    buffer_load_dwordx4 v[144:147], v7, s[24:27], s67 offen offset:0 sc1
    v_exp_f32 v69, -v69
    s_waitcnt lgkmcnt(4)
    v_mfma_f32_16x16x32_bf16 v[84:87], v[32:35], v[232:235], v[84:87]
    ds_read_b32 v14, v12
    ds_read_b64_tr_b16 v[24:25], v5 offset:32768
    v_fma_f32 v67, v67, v8, v8
    v_rcp_f32 v65, v65
    v_mfma_f32_16x16x32_bf16 v[100:103], v[32:35], v[236:239], v[100:103]
    ds_read_b64_tr_b16 v[26:27], v5 offset:33280
    v_exp_f32 v70, -v70
    v_mfma_f32_16x16x32_bf16 v[92:95], v[36:39], v[232:235], v[92:95]
    ds_read_b64_tr_b16 v[28:29], v5 offset:40960
    buffer_load_dwordx4 v[148:151], v7, s[24:27], s67 offen offset:1024 sc1
    v_fma_f32 v68, v68, v8, v8
    v_rcp_f32 v66, v66
    v_mfma_f32_16x16x32_bf16 v[108:111], v[36:39], v[236:239], v[108:111]
    ds_read_b64_tr_b16 v[30:31], v5 offset:41472
    v_mul_f32 v72, v72, v64
    s_waitcnt lgkmcnt(4)
    v_cmp_gt_u32 vcc, s64, v14
    s_cbranch_vccnz gm_ptr5
gm_ptr5b:
    v_mfma_f32_16x16x32_bf16 v[80:83], v[40:43], v[240:243], v[80:83]
    ds_read_b64_tr_b16 v[32:33], v4 offset:34816
    v_exp_f32 v71, -v71
    v_mfma_f32_16x16x32_bf16 v[96:99], v[40:43], v[244:247], v[96:99]
    ds_read_b64_tr_b16 v[34:35], v4 offset:35328
    buffer_load_dwordx4 v[152:155], v7, s[24:27], s67 offen offset:2048 sc1
    v_fma_f32 v69, v69, v8, v8
    v_rcp_f32 v67, v67
    v_mfma_f32_16x16x32_bf16 v[88:91], v[44:47], v[240:243], v[88:91]
    ds_read_b64_tr_b16 v[36:37], v4 offset:43008
    v_mul_f32 v73, v73, v65
    v_mfma_f32_16x16x32_bf16 v[104:107], v[44:47], v[244:247], v[104:107]
    ds_read_b64_tr_b16 v[38:39], v4 offset:43520
    v_fma_f32 v70, v70, v8, v8
    v_rcp_f32 v68, v68
    s_waitcnt lgkmcnt(4)
    v_mfma_f32_16x16x32_bf16 v[84:87], v[24:27], v[240:243], v[84:87]
    ds_read_b64_tr_b16 v[40:41], v5 offset:34816
    buffer_load_dwordx4 v[156:159], v7, s[24:27], s67 offen offset:3072 sc1
    v_mul_f32 v74, v74, v66
    v_mfma_f32_16x16x32_bf16 v[100:103], v[24:27], v[244:247], v[100:103]
    ds_read_b64_tr_b16 v[42:43], v5 offset:35328
    v_fma_f32 v71, v71, v8, v8
    v_mfma_f32_16x16x32_bf16 v[92:95], v[28:31], v[240:243], v[92:95]
    ds_read_b64_tr_b16 v[44:45], v5 offset:43008
    v_rcp_f32 v69, v69
    v_mul_f32 v75, v75, v67
    v_mfma_f32_16x16x32_bf16 v[108:111], v[28:31], v[244:247], v[108:111]
    ds_read_b64_tr_b16 v[46:47], v5 offset:43520
    v_subrev_u32 v4, 98304, v4
    v_subrev_u32 v5, 98304, v5
    s_add_u32 s64, s64, 1
    buffer_load_dword v176, v10, s[24:27], s63 offen sc1
    v_rcp_f32 v70, v70
    s_waitcnt lgkmcnt(4)
    v_mfma_f32_16x16x32_bf16 v[80:83], v[32:35], v[248:251], v[80:83]
    v_mul_f32 v76, v76, v68
    v_rcp_f32 v71, v71
    v_mfma_f32_16x16x32_bf16 v[96:99], v[32:35], v[252:255], v[96:99]
    v_mul_f32 v77, v77, v69
    v_mfma_f32_16x16x32_bf16 v[88:91], v[36:39], v[248:251], v[88:91]
    v_mul_f32 v78, v78, v70
    v_mfma_f32_16x16x32_bf16 v[104:107], v[36:39], v[252:255], v[104:107]
    v_mul_f32 v79, v79, v71
    v_cvt_pk_bf16_f32 v64, v72, v73
    s_waitcnt lgkmcnt(0)
    v_mfma_f32_16x16x32_bf16 v[84:87], v[40:43], v[248:251], v[84:87]
    v_cvt_pk_bf16_f32 v65, v74, v75
    v_mfma_f32_16x16x32_bf16 v[100:103], v[40:43], v[252:255], v[100:103]
    v_cvt_pk_bf16_f32 v66, v76, v77
    v_cvt_pk_bf16_f32 v67, v78, v79
    v_mfma_f32_16x16x32_bf16 v[92:95], v[44:47], v[248:251], v[92:95]
    buffer_store_dwordx4 v[64:67], v7, s[24:27], s65 offen offset:1024 sc1
    v_mfma_f32_16x16x32_bf16 v[108:111], v[44:47], v[252:255], v[108:111]
    s_add_u32 s65, s73, 2048
    s_add_u32 s73, s73, 4096
    s_setprio 2
    v_readlane_b32 s70, v21, 3
    s_nop 3
    s_add_u32 m0, s60, 55296
    s_nop 0
    buffer_load_dwordx4 v15, s[8:11], s70 offen offset:0 lds
    buffer_load_dwordx4 v16, s[8:11], s70 offen offset:1024 lds
    buffer_load_dwordx4 v17, s[8:11], s70 offen offset:2048 lds
    buffer_load_dwordx4 v18, s[8:11], s70 offen offset:3072 lds
    buffer_load_dwordx4 v20, s[8:11], s70 offen offset:3584 lds
    v_and_b32 v4, 3, v1
    v_lshrrev_b32 v2, 2, v1
    v_mul_u32_u24 v2, 288, v2
    v_lshl_add_u32 v2, v4, 3, v2
    v_add_u32 v3, 55296, v2
    s_waitcnt vmcnt(30) lgkmcnt(0)
    ds_add_u32 v11, v13
    v_mul_f32 v88, v80, v88
    v_mul_f32 v89, v81, v89
    v_mul_f32 v90, v82, v90
    v_exp_f32 v80, -v80
    v_mul_f32 v91, v83, v91
    v_exp_f32 v81, -v81
    v_mul_f32 v92, v84, v92
    v_exp_f32 v82, -v82
    v_fma_f32 v80, v80, v9, v9
    v_mul_f32 v93, v85, v93
    v_exp_f32 v83, -v83
    v_fma_f32 v81, v81, v9, v9
    v_mul_f32 v94, v86, v94
    v_exp_f32 v84, -v84
    v_fma_f32 v82, v82, v9, v9
    v_rcp_f32 v80, v80
    v_mul_f32 v95, v87, v95
    v_exp_f32 v85, -v85
    v_fma_f32 v83, v83, v9, v9
    v_rcp_f32 v81, v81
    v_exp_f32 v86, -v86
    v_fma_f32 v84, v84, v9, v9
    v_rcp_f32 v82, v82
    v_mul_f32 v88, v88, v80
    v_exp_f32 v87, -v87
    v_fma_f32 v85, v85, v9, v9
    v_rcp_f32 v83, v83
    v_mul_f32 v89, v89, v81
    v_fma_f32 v86, v86, v9, v9
    v_rcp_f32 v84, v84
    v_mul_f32 v90, v90, v82
    v_fma_f32 v87, v87, v9, v9
    v_rcp_f32 v85, v85
    v_mul_f32 v91, v91, v83
    v_rcp_f32 v86, v86
    v_mul_f32 v92, v92, v84
    v_rcp_f32 v87, v87
    v_mul_f32 v93, v93, v85
    v_mul_f32 v94, v94, v86
    v_mul_f32 v95, v95, v87
    v_cvt_pk_bf16_f32 v80, v88, v89
    v_cvt_pk_bf16_f32 v81, v90, v91
    v_cvt_pk_bf16_f32 v82, v92, v93
    v_cvt_pk_bf16_f32 v83, v94, v95
    buffer_store_dwordx4 v[80:83], v7, s[24:27], s65 offen offset:0 sc1
    v_mul_f32 v104, v96, v104
    v_mul_f32 v105, v97, v105
    v_mul_f32 v106, v98, v106
    v_exp_f32 v96, -v96
    v_mul_f32 v107, v99, v107
    v_exp_f32 v97, -v97
    v_mul_f32 v108, v100, v108
    v_exp_f32 v98, -v98
    v_fma_f32 v96, v96, v8, v8
    v_mul_f32 v109, v101, v109
    v_exp_f32 v99, -v99
    v_fma_f32 v97, v97, v8, v8
    v_mul_f32 v110, v102, v110
    v_exp_f32 v100, -v100
    v_fma_f32 v98, v98, v8, v8
    v_rcp_f32 v96, v96
    v_mul_f32 v111, v103, v111
    v_exp_f32 v101, -v101
    v_fma_f32 v99, v99, v8, v8
    v_rcp_f32 v97, v97
    v_exp_f32 v102, -v102
    v_fma_f32 v100, v100, v8, v8
    v_rcp_f32 v98, v98
    v_mul_f32 v104, v104, v96
    v_exp_f32 v103, -v103
    v_fma_f32 v101, v101, v8, v8
    v_rcp_f32 v99, v99
    v_mul_f32 v105, v105, v97
    v_fma_f32 v102, v102, v8, v8
    v_rcp_f32 v100, v100
    v_mul_f32 v106, v106, v98
    v_fma_f32 v103, v103, v8, v8
    v_rcp_f32 v101, v101
    v_mul_f32 v107, v107, v99
    v_rcp_f32 v102, v102
    v_mul_f32 v108, v108, v100
    v_rcp_f32 v103, v103
    v_mul_f32 v109, v109, v101
    v_mul_f32 v110, v110, v102
    v_mul_f32 v111, v111, v103
    v_cvt_pk_bf16_f32 v96, v104, v105
    v_cvt_pk_bf16_f32 v97, v106, v107
    v_cvt_pk_bf16_f32 v98, v108, v109
    v_cvt_pk_bf16_f32 v99, v110, v111
    buffer_store_dwordx4 v[96:99], v7, s[24:27], s65 offen offset:1024 sc1
    s_waitcnt vmcnt(8)
    v_cmp_gt_i32 vcc, 7, v176
    s_cbranch_vccz gm_h7ok
gm_h7:
    buffer_load_dword v176, v10, s[24:27], s63 offen sc1
    s_sub_u32 s91, s91, 16
    s_cmp_lt_i32 s91, 0
    s_cbranch_scc1 gm_h7x
    s_waitcnt vmcnt(0)
    v_cmp_gt_i32 vcc, 7, v176
    s_cbranch_vccz gm_h7x
    s_sleep 8
    s_branch gm_h7
gm_h7x:
gm_h7ok:
    v_readlane_b32 s67, v0, 3
    s_nop 4
    buffer_load_dwordx4 v[160:163], v7, s[24:27], s67 offen offset:0 sc1
    buffer_load_dwordx4 v[164:167], v7, s[24:27], s67 offen offset:1024 sc1
    buffer_load_dwordx4 v[168:171], v7, s[24:27], s67 offen offset:2048 sc1
    buffer_load_dwordx4 v[172:175], v7, s[24:27], s67 offen offset:3072 sc1
    s_mov_b32 s64, 32
gm_g2w0:
    ds_read_b32 v4, v12
    s_sub_u32 s91, s91, 1
    s_cmp_lt_i32 s91, 0
    s_cbranch_scc1 gm_g2w0x
    s_waitcnt lgkmcnt(0)
    v_cmp_gt_u32 vcc, s64, v4
    s_cbranch_vccnz gm_g2w0
gm_g2w0x:
    s_waitcnt lgkmcnt(0)
    s_add_u32 s64, s64, 1
    s_mov_b32 s66, 0
    ds_read_b64_tr_b16 v[24:25], v2 offset:0
    ds_read_b64_tr_b16 v[26:27], v2 offset:4608
    ds_read_b64_tr_b16 v[28:29], v2 offset:32
    ds_read_b64_tr_b16 v[30:31], v2 offset:4640
    ds_read_b64_tr_b16 v[32:33], v2 offset:64
    ds_read_b64_tr_b16 v[34:35], v2 offset:4672
    ds_read_b64_tr_b16 v[36:37], v2 offset:96
    ds_read_b64_tr_b16 v[38:39], v2 offset:4704
    ds_read_b64_tr_b16 v[40:41], v2 offset:128
    ds_read_b64_tr_b16 v[42:43], v2 offset:4736
    ds_read_b64_tr_b16 v[44:45], v2 offset:160
    ds_read_b64_tr_b16 v[46:47], v2 offset:4768
    s_setprio 0
    s_setprio 0
    s_waitcnt lgkmcnt(6) vmcnt(19)
    v_mfma_f32_16x16x32_bf16 v[184:187], v[24:27], v[112:115], 0
    ds_add_u32 v11, v13
    ds_read_b64_tr_b16 v[180:181], v2 offset:192
    v_mfma_f32_16x16x32_bf16 v[220:223], v[24:27], v[116:119], 0
    ds_read_b64_tr_b16 v[182:183], v2 offset:4800
    v_mfma_f32_16x16x32_bf16 v[188:191], v[28:31], v[112:115], 0
    ds_read_b64_tr_b16 v[104:105], v2 offset:224
    v_mfma_f32_16x16x32_bf16 v[224:227], v[28:31], v[116:119], 0
    ds_read_b64_tr_b16 v[106:107], v2 offset:4832
    v_readlane_b32 s67, v0, s68
    v_mfma_f32_16x16x32_bf16 v[192:195], v[32:35], v[112:115], 0
    ds_read_b64_tr_b16 v[108:109], v2 offset:256
    v_mfma_f32_16x16x32_bf16 v[228:231], v[32:35], v[116:119], 0
    ds_read_b64_tr_b16 v[110:111], v2 offset:4864
    v_readlane_b32 s70, v21, s68
    s_add_u32 s68, s68, 1
    s_waitcnt lgkmcnt(6)
    v_mfma_f32_16x16x32_bf16 v[196:199], v[36:39], v[112:115], 0
    ds_read_b64_tr_b16 v[24:25], v2 offset:9216
    v_mfma_f32_16x16x32_bf16 v[232:235], v[36:39], v[116:119], 0
    ds_read_b64_tr_b16 v[26:27], v2 offset:13824
    s_add_u32 m0, s60, 73728
    v_mfma_f32_16x16x32_bf16 v[200:203], v[40:43], v[112:115], 0
    ds_read_b64_tr_b16 v[28:29], v2 offset:9248
    v_mfma_f32_16x16x32_bf16 v[236:239], v[40:43], v[116:119], 0
    ds_read_b64_tr_b16 v[30:31], v2 offset:13856
    buffer_load_dwordx4 v15, s[8:11], s70 offen offset:0 lds
    v_mfma_f32_16x16x32_bf16 v[204:207], v[44:47], v[112:115], 0
    ds_read_b64_tr_b16 v[32:33], v2 offset:9280
    v_mfma_f32_16x16x32_bf16 v[240:243], v[44:47], v[116:119], 0
    ds_read_b64_tr_b16 v[34:35], v2 offset:13888
    buffer_load_dwordx4 v[48:51], v7, s[24:27], s67 offen offset:0 sc1
    s_waitcnt lgkmcnt(6)
    v_mfma_f32_16x16x32_bf16 v[208:211], v[180:183], v[112:115], 0
    ds_read_b64_tr_b16 v[36:37], v2 offset:9312
    v_mfma_f32_16x16x32_bf16 v[244:247], v[180:183], v[116:119], 0
    ds_read_b64_tr_b16 v[38:39], v2 offset:13920
    v_mfma_f32_16x16x32_bf16 v[212:215], v[104:107], v[112:115], 0
    ds_read_b64_tr_b16 v[40:41], v2 offset:9344
    v_mfma_f32_16x16x32_bf16 v[248:251], v[104:107], v[116:119], 0
    ds_read_b64_tr_b16 v[42:43], v2 offset:13952
    buffer_load_dwordx4 v[52:55], v7, s[24:27], s67 offen offset:1024 sc1
    v_mfma_f32_16x16x32_bf16 v[216:219], v[108:111], v[112:115], 0
    ds_read_b64_tr_b16 v[44:45], v2 offset:9376
    v_mfma_f32_16x16x32_bf16 v[252:255], v[108:111], v[116:119], 0
    ds_read_b64_tr_b16 v[46:47], v2 offset:13984
    buffer_load_dwordx4 v16, s[8:11], s70 offen offset:1024 lds
    s_branch gm_g2k1
gm_g2loop:
    s_setprio 0
    s_waitcnt lgkmcnt(6) vmcnt(19)
    v_mfma_f32_16x16x32_bf16 v[184:187], v[24:27], v[112:115], v[184:187]
    ds_add_u32 v11, v13
    ds_read_b64_tr_b16 v[180:181], v2 offset:192
    v_mfma_f32_16x16x32_bf16 v[220:223], v[24:27], v[116:119], v[220:223]
    ds_read_b64_tr_b16 v[182:183], v2 offset:4800
    v_mfma_f32_16x16x32_bf16 v[188:191], v[28:31], v[112:115], v[188:191]
    ds_read_b64_tr_b16 v[104:105], v2 offset:224
    v_mfma_f32_16x16x32_bf16 v[224:227], v[28:31], v[116:119], v[224:227]
    ds_read_b64_tr_b16 v[106:107], v2 offset:4832
    v_readlane_b32 s67, v0, s68
    v_mfma_f32_16x16x32_bf16 v[192:195], v[32:35], v[112:115], v[192:195]
    ds_read_b64_tr_b16 v[108:109], v2 offset:256
    v_mfma_f32_16x16x32_bf16 v[228:231], v[32:35], v[116:119], v[228:231]
    ds_read_b64_tr_b16 v[110:111], v2 offset:4864
    v_readlane_b32 s70, v21, s68
    s_add_u32 s68, s68, 1
    s_waitcnt lgkmcnt(6)
    v_mfma_f32_16x16x32_bf16 v[196:199], v[36:39], v[112:115], v[196:199]
    ds_read_b64_tr_b16 v[24:25], v2 offset:9216
    v_mfma_f32_16x16x32_bf16 v[232:235], v[36:39], v[116:119], v[232:235]
    ds_read_b64_tr_b16 v[26:27], v2 offset:13824
    s_add_u32 m0, s60, 73728
    v_mfma_f32_16x16x32_bf16 v[200:203], v[40:43], v[112:115], v[200:203]
    ds_read_b64_tr_b16 v[28:29], v2 offset:9248
    v_mfma_f32_16x16x32_bf16 v[236:239], v[40:43], v[116:119], v[236:239]
    ds_read_b64_tr_b16 v[30:31], v2 offset:13856
    buffer_load_dwordx4 v15, s[8:11], s70 offen offset:0 lds
    v_mfma_f32_16x16x32_bf16 v[204:207], v[44:47], v[112:115], v[204:207]
    ds_read_b64_tr_b16 v[32:33], v2 offset:9280
    v_mfma_f32_16x16x32_bf16 v[240:243], v[44:47], v[116:119], v[240:243]
    ds_read_b64_tr_b16 v[34:35], v2 offset:13888
    buffer_load_dwordx4 v[48:51], v7, s[24:27], s67 offen offset:0 sc1
    s_waitcnt lgkmcnt(6)
    v_mfma_f32_16x16x32_bf16 v[208:211], v[180:183], v[112:115], v[208:211]
    ds_read_b64_tr_b16 v[36:37], v2 offset:9312
    v_mfma_f32_16x16x32_bf16 v[244:247], v[180:183], v[116:119], v[244:247]
    ds_read_b64_tr_b16 v[38:39], v2 offset:13920
    v_mfma_f32_16x16x32_bf16 v[212:215], v[104:107], v[112:115], v[212:215]
    ds_read_b64_tr_b16 v[40:41], v2 offset:9344
    v_mfma_f32_16x16x32_bf16 v[248:251], v[104:107], v[116:119], v[248:251]
    ds_read_b64_tr_b16 v[42:43], v2 offset:13952
    buffer_load_dwordx4 v[52:55], v7, s[24:27], s67 offen offset:1024 sc1
    v_mfma_f32_16x16x32_bf16 v[216:219], v[108:111], v[112:115], v[216:219]
    ds_read_b64_tr_b16 v[44:45], v2 offset:9376
    v_mfma_f32_16x16x32_bf16 v[252:255], v[108:111], v[116:119], v[252:255]
    ds_read_b64_tr_b16 v[46:47], v2 offset:13984
    buffer_load_dwordx4 v16, s[8:11], s70 offen offset:1024 lds
gm_g2k1:
    s_waitcnt lgkmcnt(6) vmcnt(31)
    v_mfma_f32_16x16x32_bf16 v[184:187], v[24:27], v[120:123], v[184:187]
    ds_read_b32 v4, v12
    ds_read_b64_tr_b16 v[180:181], v2 offset:9408
    v_mfma_f32_16x16x32_bf16 v[220:223], v[24:27], v[124:127], v[220:223]
    ds_read_b64_tr_b16 v[182:183], v2 offset:14016
    v_mfma_f32_16x16x32_bf16 v[188:191], v[28:31], v[120:123], v[188:191]
    ds_read_b64_tr_b16 v[104:105], v2 offset:9440
    v_mfma_f32_16x16x32_bf16 v[224:227], v[28:31], v[124:127], v[224:227]
    ds_read_b64_tr_b16 v[106:107], v2 offset:14048
    buffer_load_dwordx4 v[56:59], v7, s[24:27], s67 offen offset:2048 sc1
    v_mfma_f32_16x16x32_bf16 v[192:195], v[32:35], v[120:123], v[192:195]
    ds_read_b64_tr_b16 v[108:109], v2 offset:9472
    v_mfma_f32_16x16x32_bf16 v[228:231], v[32:35], v[124:127], v[228:231]
    ds_read_b64_tr_b16 v[110:111], v2 offset:14080
    buffer_load_dwordx4 v17, s[8:11], s70 offen offset:2048 lds
    s_waitcnt lgkmcnt(6)
    v_cmp_gt_u32 vcc, s64, v4
    s_cbranch_vccnz gm_g2r0
gm_g2r0b:
    s_add_u32 s64, s64, 1
    v_mfma_f32_16x16x32_bf16 v[196:199], v[36:39], v[120:123], v[196:199]
    ds_read_b64_tr_b16 v[24:25], v2 offset:18432
    v_mfma_f32_16x16x32_bf16 v[232:235], v[36:39], v[124:127], v[232:235]
    ds_read_b64_tr_b16 v[26:27], v2 offset:23040
    v_mfma_f32_16x16x32_bf16 v[200:203], v[40:43], v[120:123], v[200:203]
    ds_read_b64_tr_b16 v[28:29], v2 offset:18464
    v_mfma_f32_16x16x32_bf16 v[236:239], v[40:43], v[124:127], v[236:239]
    ds_read_b64_tr_b16 v[30:31], v2 offset:23072
    buffer_load_dwordx4 v[60:63], v7, s[24:27], s67 offen offset:3072 sc1
    v_mfma_f32_16x16x32_bf16 v[204:207], v[44:47], v[120:123], v[204:207]
    ds_read_b64_tr_b16 v[32:33], v2 offset:18496
    v_mfma_f32_16x16x32_bf16 v[240:243], v[44:47], v[124:127], v[240:243]
    ds_read_b64_tr_b16 v[34:35], v2 offset:23104
    buffer_load_dwordx4 v18, s[8:11], s70 offen offset:3072 lds
    s_waitcnt lgkmcnt(6)
    v_mfma_f32_16x16x32_bf16 v[208:211], v[180:183], v[120:123], v[208:211]
    ds_read_b64_tr_b16 v[36:37], v2 offset:18528
    v_mfma_f32_16x16x32_bf16 v[244:247], v[180:183], v[124:127], v[244:247]
    ds_read_b64_tr_b16 v[38:39], v2 offset:23136
    v_mfma_f32_16x16x32_bf16 v[212:215], v[104:107], v[120:123], v[212:215]
    ds_read_b64_tr_b16 v[40:41], v2 offset:18560
    v_mfma_f32_16x16x32_bf16 v[248:251], v[104:107], v[124:127], v[248:251]
    ds_read_b64_tr_b16 v[42:43], v2 offset:23168
    v_mfma_f32_16x16x32_bf16 v[216:219], v[108:111], v[120:123], v[216:219]
    ds_read_b64_tr_b16 v[44:45], v2 offset:18592
    v_mfma_f32_16x16x32_bf16 v[252:255], v[108:111], v[124:127], v[252:255]
    ds_read_b64_tr_b16 v[46:47], v2 offset:23200
    buffer_load_dwordx4 v20, s[8:11], s70 offen offset:3584 lds
    s_waitcnt lgkmcnt(6) vmcnt(18)
    v_mfma_f32_16x16x32_bf16 v[184:187], v[24:27], v[128:131], v[184:187]
    ds_add_u32 v11, v13
    ds_read_b64_tr_b16 v[180:181], v2 offset:18624
    v_mfma_f32_16x16x32_bf16 v[220:223], v[24:27], v[132:135], v[220:223]
    ds_read_b64_tr_b16 v[182:183], v2 offset:23232
    buffer_load_dword v176, v10, s[24:27], s63 offen sc1
    v_mfma_f32_16x16x32_bf16 v[188:191], v[28:31], v[128:131], v[188:191]
    ds_read_b64_tr_b16 v[104:105], v2 offset:18656
    v_mfma_f32_16x16x32_bf16 v[224:227], v[28:31], v[132:135], v[224:227]
    ds_read_b64_tr_b16 v[106:107], v2 offset:23264
    v_readlane_b32 s67, v0, s68
    v_mfma_f32_16x16x32_bf16 v[192:195], v[32:35], v[128:131], v[192:195]
    ds_read_b64_tr_b16 v[108:109], v2 offset:18688
    v_mfma_f32_16x16x32_bf16 v[228:231], v[32:35], v[132:135], v[228:231]
    ds_read_b64_tr_b16 v[110:111], v2 offset:23296
    v_readlane_b32 s70, v21, s68
    s_add_u32 s68, s68, 1
    s_waitcnt lgkmcnt(6)
    v_mfma_f32_16x16x32_bf16 v[196:199], v[36:39], v[128:131], v[196:199]
    ds_read_b64_tr_b16 v[24:25], v2 offset:27648
    v_mfma_f32_16x16x32_bf16 v[232:235], v[36:39], v[132:135], v[232:235]
    ds_read_b64_tr_b16 v[26:27], v2 offset:32256
    s_add_u32 m0, s60, 92160
    v_mfma_f32_16x16x32_bf16 v[200:203], v[40:43], v[128:131], v[200:203]
    ds_read_b64_tr_b16 v[28:29], v2 offset:27680
    v_mfma_f32_16x16x32_bf16 v[236:239], v[40:43], v[132:135], v[236:239]
    ds_read_b64_tr_b16 v[30:31], v2 offset:32288
    buffer_load_dwordx4 v15, s[8:11], s70 offen offset:0 lds
    v_mfma_f32_16x16x32_bf16 v[204:207], v[44:47], v[128:131], v[204:207]
    ds_read_b64_tr_b16 v[32:33], v2 offset:27712
    v_mfma_f32_16x16x32_bf16 v[240:243], v[44:47], v[132:135], v[240:243]
    ds_read_b64_tr_b16 v[34:35], v2 offset:32320
    buffer_load_dwordx4 v[64:67], v7, s[24:27], s67 offen offset:0 sc1
    s_waitcnt lgkmcnt(6)
    v_mfma_f32_16x16x32_bf16 v[208:211], v[180:183], v[128:131], v[208:211]
    ds_read_b64_tr_b16 v[36:37], v2 offset:27744
    v_mfma_f32_16x16x32_bf16 v[244:247], v[180:183], v[132:135], v[244:247]
    ds_read_b64_tr_b16 v[38:39], v2 offset:32352
    v_mfma_f32_16x16x32_bf16 v[212:215], v[104:107], v[128:131], v[212:215]
    ds_read_b64_tr_b16 v[40:41], v2 offset:27776
    v_mfma_f32_16x16x32_bf16 v[248:251], v[104:107], v[132:135], v[248:251]
    ds_read_b64_tr_b16 v[42:43], v2 offset:32384
    buffer_load_dwordx4 v[68:71], v7, s[24:27], s67 offen offset:1024 sc1
    v_mfma_f32_16x16x32_bf16 v[216:219], v[108:111], v[128:131], v[216:219]
    ds_read_b64_tr_b16 v[44:45], v2 offset:27808
    v_mfma_f32_16x16x32_bf16 v[252:255], v[108:111], v[132:135], v[252:255]
    ds_read_b64_tr_b16 v[46:47], v2 offset:32416
    buffer_load_dwordx4 v16, s[8:11], s70 offen offset:1024 lds
    s_waitcnt lgkmcnt(6) vmcnt(31)
    v_mfma_f32_16x16x32_bf16 v[184:187], v[24:27], v[136:139], v[184:187]
    ds_read_b32 v4, v12
    ds_read_b64_tr_b16 v[180:181], v2 offset:27840
    v_mfma_f32_16x16x32_bf16 v[220:223], v[24:27], v[140:143], v[220:223]
    ds_read_b64_tr_b16 v[182:183], v2 offset:32448
    v_mfma_f32_16x16x32_bf16 v[188:191], v[28:31], v[136:139], v[188:191]
    ds_read_b64_tr_b16 v[104:105], v2 offset:27872
    v_mfma_f32_16x16x32_bf16 v[224:227], v[28:31], v[140:143], v[224:227]
    ds_read_b64_tr_b16 v[106:107], v2 offset:32480
    buffer_load_dwordx4 v[72:75], v7, s[24:27], s67 offen offset:2048 sc1
    v_mfma_f32_16x16x32_bf16 v[192:195], v[32:35], v[136:139], v[192:195]
    ds_read_b64_tr_b16 v[108:109], v2 offset:27904
    v_mfma_f32_16x16x32_bf16 v[228:231], v[32:35], v[140:143], v[228:231]
    ds_read_b64_tr_b16 v[110:111], v2 offset:32512
    buffer_load_dwordx4 v17, s[8:11], s70 offen offset:2048 lds
    s_waitcnt lgkmcnt(6)
    v_cmp_gt_u32 vcc, s64, v4
    s_cbranch_vccnz gm_g2r1
gm_g2r1b:
    s_add_u32 s64, s64, 1
    v_mfma_f32_16x16x32_bf16 v[196:199], v[36:39], v[136:139], v[196:199]
    ds_read_b64_tr_b16 v[24:25], v2 offset:36864
    v_mfma_f32_16x16x32_bf16 v[232:235], v[36:39], v[140:143], v[232:235]
    ds_read_b64_tr_b16 v[26:27], v2 offset:41472
    v_mfma_f32_16x16x32_bf16 v[200:203], v[40:43], v[136:139], v[200:203]
    ds_read_b64_tr_b16 v[28:29], v2 offset:36896
    v_mfma_f32_16x16x32_bf16 v[236:239], v[40:43], v[140:143], v[236:239]
    ds_read_b64_tr_b16 v[30:31], v2 offset:41504
    buffer_load_dwordx4 v[76:79], v7, s[24:27], s67 offen offset:3072 sc1
    v_mfma_f32_16x16x32_bf16 v[204:207], v[44:47], v[136:139], v[204:207]
    ds_read_b64_tr_b16 v[32:33], v2 offset:36928
    v_mfma_f32_16x16x32_bf16 v[240:243], v[44:47], v[140:143], v[240:243]
    ds_read_b64_tr_b16 v[34:35], v2 offset:41536
    buffer_load_dwordx4 v18, s[8:11], s70 offen offset:3072 lds
    s_waitcnt lgkmcnt(6)
    v_mfma_f32_16x16x32_bf16 v[208:211], v[180:183], v[136:139], v[208:211]
    ds_read_b64_tr_b16 v[36:37], v2 offset:36960
    v_mfma_f32_16x16x32_bf16 v[244:247], v[180:183], v[140:143], v[244:247]
    ds_read_b64_tr_b16 v[38:39], v2 offset:41568
    v_mfma_f32_16x16x32_bf16 v[212:215], v[104:107], v[136:139], v[212:215]
    ds_read_b64_tr_b16 v[40:41], v2 offset:36992
    v_mfma_f32_16x16x32_bf16 v[248:251], v[104:107], v[140:143], v[248:251]
    ds_read_b64_tr_b16 v[42:43], v2 offset:41600
    v_mfma_f32_16x16x32_bf16 v[216:219], v[108:111], v[136:139], v[216:219]
    ds_read_b64_tr_b16 v[44:45], v2 offset:37024
    v_mfma_f32_16x16x32_bf16 v[252:255], v[108:111], v[140:143], v[252:255]
    ds_read_b64_tr_b16 v[46:47], v2 offset:41632
    buffer_load_dwordx4 v20, s[8:11], s70 offen offset:3584 lds
    s_cmp_eq_u32 s66, 2
    s_cbranch_scc1 gm_g2tail
    s_waitcnt lgkmcnt(6) vmcnt(19)
    v_mfma_f32_16x16x32_bf16 v[184:187], v[24:27], v[144:147], v[184:187]
    ds_add_u32 v11, v13
    ds_read_b64_tr_b16 v[180:181], v2 offset:37056
    v_mfma_f32_16x16x32_bf16 v[220:223], v[24:27], v[148:151], v[220:223]
    ds_read_b64_tr_b16 v[182:183], v2 offset:41664
    v_mfma_f32_16x16x32_bf16 v[188:191], v[28:31], v[144:147], v[188:191]
    ds_read_b64_tr_b16 v[104:105], v2 offset:37088
    v_mfma_f32_16x16x32_bf16 v[224:227], v[28:31], v[148:151], v[224:227]
    ds_read_b64_tr_b16 v[106:107], v2 offset:41696
    v_readlane_b32 s67, v0, s68
    v_mfma_f32_16x16x32_bf16 v[192:195], v[32:35], v[144:147], v[192:195]
    ds_read_b64_tr_b16 v[108:109], v2 offset:37120
    v_mfma_f32_16x16x32_bf16 v[228:231], v[32:35], v[148:151], v[228:231]
    ds_read_b64_tr_b16 v[110:111], v2 offset:41728
    v_readlane_b32 s70, v21, s68
    s_add_u32 s68, s68, 1
    s_waitcnt lgkmcnt(6)
    v_mfma_f32_16x16x32_bf16 v[196:199], v[36:39], v[144:147], v[196:199]
    ds_read_b64_tr_b16 v[24:25], v2 offset:46080
    v_mfma_f32_16x16x32_bf16 v[232:235], v[36:39], v[148:151], v[232:235]
    ds_read_b64_tr_b16 v[26:27], v2 offset:50688
    s_add_u32 m0, s60, 0
    v_mfma_f32_16x16x32_bf16 v[200:203], v[40:43], v[144:147], v[200:203]
    ds_read_b64_tr_b16 v[28:29], v2 offset:46112
    v_mfma_f32_16x16x32_bf16 v[236:239], v[40:43], v[148:151], v[236:239]
    ds_read_b64_tr_b16 v[30:31], v2 offset:50720
    buffer_load_dwordx4 v15, s[8:11], s70 offen offset:0 lds
    v_mfma_f32_16x16x32_bf16 v[204:207], v[44:47], v[144:147], v[204:207]
    ds_read_b64_tr_b16 v[32:33], v2 offset:46144
    v_mfma_f32_16x16x32_bf16 v[240:243], v[44:47], v[148:151], v[240:243]
    ds_read_b64_tr_b16 v[34:35], v2 offset:50752
    buffer_load_dwordx4 v[112:115], v7, s[24:27], s67 offen offset:0 sc1
    s_waitcnt lgkmcnt(6)
    v_mfma_f32_16x16x32_bf16 v[208:211], v[180:183], v[144:147], v[208:211]
    ds_read_b64_tr_b16 v[36:37], v2 offset:46176
    v_mfma_f32_16x16x32_bf16 v[244:247], v[180:183], v[148:151], v[244:247]
    ds_read_b64_tr_b16 v[38:39], v2 offset:50784
    v_mfma_f32_16x16x32_bf16 v[212:215], v[104:107], v[144:147], v[212:215]
    ds_read_b64_tr_b16 v[40:41], v2 offset:46208
    v_mfma_f32_16x16x32_bf16 v[248:251], v[104:107], v[148:151], v[248:251]
    ds_read_b64_tr_b16 v[42:43], v2 offset:50816
    buffer_load_dwordx4 v[116:119], v7, s[24:27], s67 offen offset:1024 sc1
    v_mfma_f32_16x16x32_bf16 v[216:219], v[108:111], v[144:147], v[216:219]
    ds_read_b64_tr_b16 v[44:45], v2 offset:46240
    v_mfma_f32_16x16x32_bf16 v[252:255], v[108:111], v[148:151], v[252:255]
    ds_read_b64_tr_b16 v[46:47], v2 offset:50848
    buffer_load_dwordx4 v16, s[8:11], s70 offen offset:1024 lds
    s_waitcnt lgkmcnt(6) vmcnt(34)
    v_mfma_f32_16x16x32_bf16 v[184:187], v[24:27], v[152:155], v[184:187]
    ds_read_b32 v4, v12
    ds_read_b64_tr_b16 v[180:181], v2 offset:46272
    v_mfma_f32_16x16x32_bf16 v[220:223], v[24:27], v[156:159], v[220:223]
    ds_read_b64_tr_b16 v[182:183], v2 offset:50880
    v_mfma_f32_16x16x32_bf16 v[188:191], v[28:31], v[152:155], v[188:191]
    ds_read_b64_tr_b16 v[104:105], v2 offset:46304
    v_mfma_f32_16x16x32_bf16 v[224:227], v[28:31], v[156:159], v[224:227]
    ds_read_b64_tr_b16 v[106:107], v2 offset:50912
    buffer_load_dwordx4 v[120:123], v7, s[24:27], s67 offen offset:2048 sc1
    v_mfma_f32_16x16x32_bf16 v[192:195], v[32:35], v[152:155], v[192:195]
    ds_read_b64_tr_b16 v[108:109], v2 offset:46336
    v_mfma_f32_16x16x32_bf16 v[228:231], v[32:35], v[156:159], v[228:231]
    ds_read_b64_tr_b16 v[110:111], v2 offset:50944
    buffer_load_dwordx4 v17, s[8:11], s70 offen offset:2048 lds
    s_waitcnt lgkmcnt(6)
    v_cmp_gt_u32 vcc, s64, v4
    s_cbranch_vccnz gm_g2r2
gm_g2r2b:
    s_add_u32 s64, s64, 1
    v_mfma_f32_16x16x32_bf16 v[196:199], v[36:39], v[152:155], v[196:199]
    ds_read_b64_tr_b16 v[24:25], v3 offset:0
    v_mfma_f32_16x16x32_bf16 v[232:235], v[36:39], v[156:159], v[232:235]
    ds_read_b64_tr_b16 v[26:27], v3 offset:4608
    v_mfma_f32_16x16x32_bf16 v[200:203], v[40:43], v[152:155], v[200:203]
    ds_read_b64_tr_b16 v[28:29], v3 offset:32
    v_mfma_f32_16x16x32_bf16 v[236:239], v[40:43], v[156:159], v[236:239]
    ds_read_b64_tr_b16 v[30:31], v3 offset:4640
    buffer_load_dwordx4 v[124:127], v7, s[24:27], s67 offen offset:3072 sc1
    v_mfma_f32_16x16x32_bf16 v[204:207], v[44:47], v[152:155], v[204:207]
    ds_read_b64_tr_b16 v[32:33], v3 offset:64
    v_mfma_f32_16x16x32_bf16 v[240:243], v[44:47], v[156:159], v[240:243]
    ds_read_b64_tr_b16 v[34:35], v3 offset:4672
    buffer_load_dwordx4 v18, s[8:11], s70 offen offset:3072 lds
    s_waitcnt lgkmcnt(6)
    v_mfma_f32_16x16x32_bf16 v[208:211], v[180:183], v[152:155], v[208:211]
    ds_read_b64_tr_b16 v[36:37], v3 offset:96
    v_mfma_f32_16x16x32_bf16 v[244:247], v[180:183], v[156:159], v[244:247]
    ds_read_b64_tr_b16 v[38:39], v3 offset:4704
    v_mfma_f32_16x16x32_bf16 v[212:215], v[104:107], v[152:155], v[212:215]
    ds_read_b64_tr_b16 v[40:41], v3 offset:128
    v_mfma_f32_16x16x32_bf16 v[248:251], v[104:107], v[156:159], v[248:251]
    ds_read_b64_tr_b16 v[42:43], v3 offset:4736
    v_mfma_f32_16x16x32_bf16 v[216:219], v[108:111], v[152:155], v[216:219]
    ds_read_b64_tr_b16 v[44:45], v3 offset:160
    v_mfma_f32_16x16x32_bf16 v[252:255], v[108:111], v[156:159], v[252:255]
    ds_read_b64_tr_b16 v[46:47], v3 offset:4768
    buffer_load_dwordx4 v20, s[8:11], s70 offen offset:3584 lds
    s_setprio 2
    s_waitcnt lgkmcnt(6) vmcnt(19)
    v_mfma_f32_16x16x32_bf16 v[184:187], v[24:27], v[160:163], v[184:187]
    ds_add_u32 v11, v13
    ds_read_b64_tr_b16 v[180:181], v3 offset:192
    v_mfma_f32_16x16x32_bf16 v[220:223], v[24:27], v[164:167], v[220:223]
    ds_read_b64_tr_b16 v[182:183], v3 offset:4800
    v_mfma_f32_16x16x32_bf16 v[188:191], v[28:31], v[160:163], v[188:191]
    ds_read_b64_tr_b16 v[104:105], v3 offset:224
    v_mfma_f32_16x16x32_bf16 v[224:227], v[28:31], v[164:167], v[224:227]
    ds_read_b64_tr_b16 v[106:107], v3 offset:4832
    v_readlane_b32 s67, v0, s68
    v_mfma_f32_16x16x32_bf16 v[192:195], v[32:35], v[160:163], v[192:195]
    ds_read_b64_tr_b16 v[108:109], v3 offset:256
    v_mfma_f32_16x16x32_bf16 v[228:231], v[32:35], v[164:167], v[228:231]
    ds_read_b64_tr_b16 v[110:111], v3 offset:4864
    v_readlane_b32 s70, v21, s68
    s_add_u32 s68, s68, 1
    s_waitcnt lgkmcnt(6)
    v_mfma_f32_16x16x32_bf16 v[196:199], v[36:39], v[160:163], v[196:199]
    ds_read_b64_tr_b16 v[24:25], v3 offset:9216
    v_mfma_f32_16x16x32_bf16 v[232:235], v[36:39], v[164:167], v[232:235]
    ds_read_b64_tr_b16 v[26:27], v3 offset:13824
    s_add_u32 m0, s60, 18432
    v_mfma_f32_16x16x32_bf16 v[200:203], v[40:43], v[160:163], v[200:203]
    ds_read_b64_tr_b16 v[28:29], v3 offset:9248
    v_mfma_f32_16x16x32_bf16 v[236:239], v[40:43], v[164:167], v[236:239]
    ds_read_b64_tr_b16 v[30:31], v3 offset:13856
    buffer_load_dwordx4 v15, s[8:11], s70 offen offset:0 lds
    v_mfma_f32_16x16x32_bf16 v[204:207], v[44:47], v[160:163], v[204:207]
    ds_read_b64_tr_b16 v[32:33], v3 offset:9280
    v_mfma_f32_16x16x32_bf16 v[240:243], v[44:47], v[164:167], v[240:243]
    ds_read_b64_tr_b16 v[34:35], v3 offset:13888
    buffer_load_dwordx4 v[128:131], v7, s[24:27], s67 offen offset:0 sc1
    s_waitcnt lgkmcnt(6)
    v_mfma_f32_16x16x32_bf16 v[208:211], v[180:183], v[160:163], v[208:211]
    ds_read_b64_tr_b16 v[36:37], v3 offset:9312
    v_mfma_f32_16x16x32_bf16 v[244:247], v[180:183], v[164:167], v[244:247]
    ds_read_b64_tr_b16 v[38:39], v3 offset:13920
    v_mfma_f32_16x16x32_bf16 v[212:215], v[104:107], v[160:163], v[212:215]
    ds_read_b64_tr_b16 v[40:41], v3 offset:9344
    v_mfma_f32_16x16x32_bf16 v[248:251], v[104:107], v[164:167], v[248:251]
    ds_read_b64_tr_b16 v[42:43], v3 offset:13952
    buffer_load_dwordx4 v[132:135], v7, s[24:27], s67 offen offset:1024 sc1
    v_mfma_f32_16x16x32_bf16 v[216:219], v[108:111], v[160:163], v[216:219]
    ds_read_b64_tr_b16 v[44:45], v3 offset:9376
    v_mfma_f32_16x16x32_bf16 v[252:255], v[108:111], v[164:167], v[252:255]
    ds_read_b64_tr_b16 v[46:47], v3 offset:13984
    buffer_load_dwordx4 v16, s[8:11], s70 offen offset:1024 lds
    s_waitcnt lgkmcnt(6) vmcnt(22)
    s_cmp_eq_u32 s66, 1
    s_cselect_b32 s59, 9, 0
    v_cmp_gt_i32 vcc, s59, v176
    s_cbranch_vccnz gm_h9
gm_h9b:
    v_mfma_f32_16x16x32_bf16 v[184:187], v[24:27], v[168:171], v[184:187]
    ds_read_b32 v4, v12
    ds_read_b64_tr_b16 v[180:181], v3 offset:9408
    v_mfma_f32_16x16x32_bf16 v[220:223], v[24:27], v[172:175], v[220:223]
    ds_read_b64_tr_b16 v[182:183], v3 offset:14016
    v_mfma_f32_16x16x32_bf16 v[188:191], v[28:31], v[168:171], v[188:191]
    ds_read_b64_tr_b16 v[104:105], v3 offset:9440
    v_mfma_f32_16x16x32_bf16 v[224:227], v[28:31], v[172:175], v[224:227]
    ds_read_b64_tr_b16 v[106:107], v3 offset:14048
    buffer_load_dwordx4 v[136:139], v7, s[24:27], s67 offen offset:2048 sc1
    v_mfma_f32_16x16x32_bf16 v[192:195], v[32:35], v[168:171], v[192:195]
    ds_read_b64_tr_b16 v[108:109], v3 offset:9472
    v_mfma_f32_16x16x32_bf16 v[228:231], v[32:35], v[172:175], v[228:231]
    ds_read_b64_tr_b16 v[110:111], v3 offset:14080
    buffer_load_dwordx4 v17, s[8:11], s70 offen offset:2048 lds
    s_waitcnt lgkmcnt(6)
    v_cmp_gt_u32 vcc, s64, v4
    s_cbranch_vccnz gm_g2r3
gm_g2r3b:
    s_add_u32 s64, s64, 1
    v_mfma_f32_16x16x32_bf16 v[196:199], v[36:39], v[168:171], v[196:199]
    ds_read_b64_tr_b16 v[24:25], v3 offset:18432
    v_mfma_f32_16x16x32_bf16 v[232:235], v[36:39], v[172:175], v[232:235]
    ds_read_b64_tr_b16 v[26:27], v3 offset:23040
    v_mfma_f32_16x16x32_bf16 v[200:203], v[40:43], v[168:171], v[200:203]
    ds_read_b64_tr_b16 v[28:29], v3 offset:18464
    v_mfma_f32_16x16x32_bf16 v[236:239], v[40:43], v[172:175], v[236:239]
    ds_read_b64_tr_b16 v[30:31], v3 offset:23072
    buffer_load_dwordx4 v[140:143], v7, s[24:27], s67 offen offset:3072 sc1
    v_mfma_f32_16x16x32_bf16 v[204:207], v[44:47], v[168:171], v[204:207]
    ds_read_b64_tr_b16 v[32:33], v3 offset:18496
    v_mfma_f32_16x16x32_bf16 v[240:243], v[44:47], v[172:175], v[240:243]
    ds_read_b64_tr_b16 v[34:35], v3 offset:23104
    buffer_load_dwordx4 v18, s[8:11], s70 offen offset:3072 lds
    s_waitcnt lgkmcnt(6)
    v_mfma_f32_16x16x32_bf16 v[208:211], v[180:183], v[168:171], v[208:211]
    ds_read_b64_tr_b16 v[36:37], v3 offset:18528
    v_mfma_f32_16x16x32_bf16 v[244:247], v[180:183], v[172:175], v[244:247]
    ds_read_b64_tr_b16 v[38:39], v3 offset:23136
    v_mfma_f32_16x16x32_bf16 v[212:215], v[104:107], v[168:171], v[212:215]
    ds_read_b64_tr_b16 v[40:41], v3 offset:18560
    v_mfma_f32_16x16x32_bf16 v[248:251], v[104:107], v[172:175], v[248:251]
    ds_read_b64_tr_b16 v[42:43], v3 offset:23168
    v_mfma_f32_16x16x32_bf16 v[216:219], v[108:111], v[168:171], v[216:219]
    ds_read_b64_tr_b16 v[44:45], v3 offset:18592
    v_mfma_f32_16x16x32_bf16 v[252:255], v[108:111], v[172:175], v[252:255]
    ds_read_b64_tr_b16 v[46:47], v3 offset:23200
    buffer_load_dwordx4 v20, s[8:11], s70 offen offset:3584 lds
    s_waitcnt lgkmcnt(6) vmcnt(18)
    v_mfma_f32_16x16x32_bf16 v[184:187], v[24:27], v[48:51], v[184:187]
    ds_add_u32 v11, v13
    v_mov_b32 v22, 9
    buffer_store_dword v22, v23, s[24:27], s90 offen sc1
    ds_read_b64_tr_b16 v[180:181], v3 offset:18624
    v_mfma_f32_16x16x32_bf16 v[220:223], v[24:27], v[52:55], v[220:223]
    ds_read_b64_tr_b16 v[182:183], v3 offset:23232
    s_mov_b32 s90, 0x40000000
    v_mfma_f32_16x16x32_bf16 v[188:191], v[28:31], v[48:51], v[188:191]
    ds_read_b64_tr_b16 v[104:105], v3 offset:18656
    v_mfma_f32_16x16x32_bf16 v[224:227], v[28:31], v[52:55], v[224:227]
    ds_read_b64_tr_b16 v[106:107], v3 offset:23264
    v_readlane_b32 s67, v0, s68
    v_mfma_f32_16x16x32_bf16 v[192:195], v[32:35], v[48:51], v[192:195]
    ds_read_b64_tr_b16 v[108:109], v3 offset:18688
    v_mfma_f32_16x16x32_bf16 v[228:231], v[32:35], v[52:55], v[228:231]
    ds_read_b64_tr_b16 v[110:111], v3 offset:23296
    v_readlane_b32 s70, v21, s68
    s_add_u32 s68, s68, 1
    s_waitcnt lgkmcnt(6)
    v_mfma_f32_16x16x32_bf16 v[196:199], v[36:39], v[48:51], v[196:199]
    ds_read_b64_tr_b16 v[24:25], v3 offset:27648
    v_mfma_f32_16x16x32_bf16 v[232:235], v[36:39], v[52:55], v[232:235]
    ds_read_b64_tr_b16 v[26:27], v3 offset:32256
    s_add_u32 m0, s60, 36864
    v_mfma_f32_16x16x32_bf16 v[200:203], v[40:43], v[48:51], v[200:203]
    ds_read_b64_tr_b16 v[28:29], v3 offset:27680
    v_mfma_f32_16x16x32_bf16 v[236:239], v[40:43], v[52:55], v[236:239]
    ds_read_b64_tr_b16 v[30:31], v3 offset:32288
    buffer_load_dwordx4 v15, s[8:11], s70 offen offset:0 lds
    v_mfma_f32_16x16x32_bf16 v[204:207], v[44:47], v[48:51], v[204:207]
    ds_read_b64_tr_b16 v[32:33], v3 offset:27712
    v_mfma_f32_16x16x32_bf16 v[240:243], v[44:47], v[52:55], v[240:243]
    ds_read_b64_tr_b16 v[34:35], v3 offset:32320
    buffer_load_dwordx4 v[144:147], v7, s[24:27], s67 offen offset:0 sc1
    s_waitcnt lgkmcnt(6)
    v_mfma_f32_16x16x32_bf16 v[208:211], v[180:183], v[48:51], v[208:211]
    ds_read_b64_tr_b16 v[36:37], v3 offset:27744
    v_mfma_f32_16x16x32_bf16 v[244:247], v[180:183], v[52:55], v[244:247]
    ds_read_b64_tr_b16 v[38:39], v3 offset:32352
    v_mfma_f32_16x16x32_bf16 v[212:215], v[104:107], v[48:51], v[212:215]
    ds_read_b64_tr_b16 v[40:41], v3 offset:27776
    v_mfma_f32_16x16x32_bf16 v[248:251], v[104:107], v[52:55], v[248:251]
    ds_read_b64_tr_b16 v[42:43], v3 offset:32384
    buffer_load_dwordx4 v[148:151], v7, s[24:27], s67 offen offset:1024 sc1
    v_mfma_f32_16x16x32_bf16 v[216:219], v[108:111], v[48:51], v[216:219]
    ds_read_b64_tr_b16 v[44:45], v3 offset:27808
    v_mfma_f32_16x16x32_bf16 v[252:255], v[108:111], v[52:55], v[252:255]
    ds_read_b64_tr_b16 v[46:47], v3 offset:32416
    buffer_load_dwordx4 v16, s[8:11], s70 offen offset:1024 lds
    s_waitcnt lgkmcnt(6) vmcnt(35)
    v_mfma_f32_16x16x32_bf16 v[184:187], v[24:27], v[56:59], v[184:187]
    ds_read_b32 v4, v12
    ds_read_b64_tr_b16 v[180:181], v3 offset:27840
    v_mfma_f32_16x16x32_bf16 v[220:223], v[24:27], v[60:63], v[220:223]
    ds_read_b64_tr_b16 v[182:183], v3 offset:32448
    v_mfma_f32_16x16x32_bf16 v[188:191], v[28:31], v[56:59], v[188:191]
    ds_read_b64_tr_b16 v[104:105], v3 offset:27872
    v_mfma_f32_16x16x32_bf16 v[224:227], v[28:31], v[60:63], v[224:227]
    ds_read_b64_tr_b16 v[106:107], v3 offset:32480
    buffer_load_dwordx4 v[152:155], v7, s[24:27], s67 offen offset:2048 sc1
    v_mfma_f32_16x16x32_bf16 v[192:195], v[32:35], v[56:59], v[192:195]
    ds_read_b64_tr_b16 v[108:109], v3 offset:27904
    v_mfma_f32_16x16x32_bf16 v[228:231], v[32:35], v[60:63], v[228:231]
    ds_read_b64_tr_b16 v[110:111], v3 offset:32512
    buffer_load_dwordx4 v17, s[8:11], s70 offen offset:2048 lds
    s_waitcnt lgkmcnt(6)
    v_cmp_gt_u32 vcc, s64, v4
    s_cbranch_vccnz gm_g2r4
gm_g2r4b:
    s_add_u32 s64, s64, 1
    v_mfma_f32_16x16x32_bf16 v[196:199], v[36:39], v[56:59], v[196:199]
    ds_read_b64_tr_b16 v[24:25], v3 offset:36864
    v_mfma_f32_16x16x32_bf16 v[232:235], v[36:39], v[60:63], v[232:235]
    ds_read_b64_tr_b16 v[26:27], v3 offset:41472
    v_mfma_f32_16x16x32_bf16 v[200:203], v[40:43], v[56:59], v[200:203]
    ds_read_b64_tr_b16 v[28:29], v3 offset:36896
    v_mfma_f32_16x16x32_bf16 v[236:239], v[40:43], v[60:63], v[236:239]
    ds_read_b64_tr_b16 v[30:31], v3 offset:41504
    buffer_load_dwordx4 v[156:159], v7, s[24:27], s67 offen offset:3072 sc1
    v_mfma_f32_16x16x32_bf16 v[204:207], v[44:47], v[56:59], v[204:207]
    ds_read_b64_tr_b16 v[32:33], v3 offset:36928
    v_mfma_f32_16x16x32_bf16 v[240:243], v[44:47], v[60:63], v[240:243]
    ds_read_b64_tr_b16 v[34:35], v3 offset:41536
    buffer_load_dwordx4 v18, s[8:11], s70 offen offset:3072 lds
    s_waitcnt lgkmcnt(6)
    v_mfma_f32_16x16x32_bf16 v[208:211], v[180:183], v[56:59], v[208:211]
    ds_read_b64_tr_b16 v[36:37], v3 offset:36960
    v_mfma_f32_16x16x32_bf16 v[244:247], v[180:183], v[60:63], v[244:247]
    ds_read_b64_tr_b16 v[38:39], v3 offset:41568
    v_mfma_f32_16x16x32_bf16 v[212:215], v[104:107], v[56:59], v[212:215]
    ds_read_b64_tr_b16 v[40:41], v3 offset:36992
    v_mfma_f32_16x16x32_bf16 v[248:251], v[104:107], v[60:63], v[248:251]
    ds_read_b64_tr_b16 v[42:43], v3 offset:41600
    v_mfma_f32_16x16x32_bf16 v[216:219], v[108:111], v[56:59], v[216:219]
    ds_read_b64_tr_b16 v[44:45], v3 offset:37024
    v_mfma_f32_16x16x32_bf16 v[252:255], v[108:111], v[60:63], v[252:255]
    ds_read_b64_tr_b16 v[46:47], v3 offset:41632
    buffer_load_dwordx4 v20, s[8:11], s70 offen offset:3584 lds
    s_waitcnt lgkmcnt(6) vmcnt(19)
    v_mfma_f32_16x16x32_bf16 v[184:187], v[24:27], v[64:67], v[184:187]
    ds_add_u32 v11, v13
    ds_read_b64_tr_b16 v[180:181], v3 offset:37056
    v_mfma_f32_16x16x32_bf16 v[220:223], v[24:27], v[68:71], v[220:223]
    ds_read_b64_tr_b16 v[182:183], v3 offset:41664
    v_mfma_f32_16x16x32_bf16 v[188:191], v[28:31], v[64:67], v[188:191]
    ds_read_b64_tr_b16 v[104:105], v3 offset:37088
    v_mfma_f32_16x16x32_bf16 v[224:227], v[28:31], v[68:71], v[224:227]
    ds_read_b64_tr_b16 v[106:107], v3 offset:41696
    v_readlane_b32 s67, v0, s68
    v_mfma_f32_16x16x32_bf16 v[192:195], v[32:35], v[64:67], v[192:195]
    ds_read_b64_tr_b16 v[108:109], v3 offset:37120
    v_mfma_f32_16x16x32_bf16 v[228:231], v[32:35], v[68:71], v[228:231]
    ds_read_b64_tr_b16 v[110:111], v3 offset:41728
    v_readlane_b32 s70, v21, s68
    s_add_u32 s68, s68, 1
    s_waitcnt lgkmcnt(6)
    v_mfma_f32_16x16x32_bf16 v[196:199], v[36:39], v[64:67], v[196:199]
    ds_read_b64_tr_b16 v[24:25], v3 offset:46080
    v_mfma_f32_16x16x32_bf16 v[232:235], v[36:39], v[68:71], v[232:235]
    ds_read_b64_tr_b16 v[26:27], v3 offset:50688
    s_add_u32 m0, s60, 55296
    v_mfma_f32_16x16x32_bf16 v[200:203], v[40:43], v[64:67], v[200:203]
    ds_read_b64_tr_b16 v[28:29], v3 offset:46112
    v_mfma_f32_16x16x32_bf16 v[236:239], v[40:43], v[68:71], v[236:239]
    ds_read_b64_tr_b16 v[30:31], v3 offset:50720
    buffer_load_dwordx4 v15, s[8:11], s70 offen offset:0 lds
    v_mfma_f32_16x16x32_bf16 v[204:207], v[44:47], v[64:67], v[204:207]
    ds_read_b64_tr_b16 v[32:33], v3 offset:46144
    v_mfma_f32_16x16x32_bf16 v[240:243], v[44:47], v[68:71], v[240:243]
    ds_read_b64_tr_b16 v[34:35], v3 offset:50752
    buffer_load_dwordx4 v[160:163], v7, s[24:27], s67 offen offset:0 sc1
    s_waitcnt lgkmcnt(6)
    v_mfma_f32_16x16x32_bf16 v[208:211], v[180:183], v[64:67], v[208:211]
    ds_read_b64_tr_b16 v[36:37], v3 offset:46176
    v_mfma_f32_16x16x32_bf16 v[244:247], v[180:183], v[68:71], v[244:247]
    ds_read_b64_tr_b16 v[38:39], v3 offset:50784
    v_mfma_f32_16x16x32_bf16 v[212:215], v[104:107], v[64:67], v[212:215]
    ds_read_b64_tr_b16 v[40:41], v3 offset:46208
    v_mfma_f32_16x16x32_bf16 v[248:251], v[104:107], v[68:71], v[248:251]
    ds_read_b64_tr_b16 v[42:43], v3 offset:50816
    buffer_load_dwordx4 v[164:167], v7, s[24:27], s67 offen offset:1024 sc1
    v_mfma_f32_16x16x32_bf16 v[216:219], v[108:111], v[64:67], v[216:219]
    ds_read_b64_tr_b16 v[44:45], v3 offset:46240
    v_mfma_f32_16x16x32_bf16 v[252:255], v[108:111], v[68:71], v[252:255]
    ds_read_b64_tr_b16 v[46:47], v3 offset:50848
    buffer_load_dwordx4 v16, s[8:11], s70 offen offset:1024 lds
    s_waitcnt lgkmcnt(6) vmcnt(34)
    v_mfma_f32_16x16x32_bf16 v[184:187], v[24:27], v[72:75], v[184:187]
    ds_read_b32 v4, v12
    ds_read_b64_tr_b16 v[180:181], v3 offset:46272
    v_mfma_f32_16x16x32_bf16 v[220:223], v[24:27], v[76:79], v[220:223]
    ds_read_b64_tr_b16 v[182:183], v3 offset:50880
    v_mfma_f32_16x16x32_bf16 v[188:191], v[28:31], v[72:75], v[188:191]
    ds_read_b64_tr_b16 v[104:105], v3 offset:46304
    v_mfma_f32_16x16x32_bf16 v[224:227], v[28:31], v[76:79], v[224:227]
    ds_read_b64_tr_b16 v[106:107], v3 offset:50912
    buffer_load_dwordx4 v[168:171], v7, s[24:27], s67 offen offset:2048 sc1
    v_mfma_f32_16x16x32_bf16 v[192:195], v[32:35], v[72:75], v[192:195]
    ds_read_b64_tr_b16 v[108:109], v3 offset:46336
    v_mfma_f32_16x16x32_bf16 v[228:231], v[32:35], v[76:79], v[228:231]
    ds_read_b64_tr_b16 v[110:111], v3 offset:50944
    buffer_load_dwordx4 v17, s[8:11], s70 offen offset:2048 lds
    s_waitcnt lgkmcnt(6)
    v_cmp_gt_u32 vcc, s64, v4
    s_cbranch_vccnz gm_g2r5
gm_g2r5b:
    s_add_u32 s64, s64, 1
    v_mfma_f32_16x16x32_bf16 v[196:199], v[36:39], v[72:75], v[196:199]
    ds_read_b64_tr_b16 v[24:25], v2 offset:0
    v_mfma_f32_16x16x32_bf16 v[232:235], v[36:39], v[76:79], v[232:235]
    ds_read_b64_tr_b16 v[26:27], v2 offset:4608
    v_mfma_f32_16x16x32_bf16 v[200:203], v[40:43], v[72:75], v[200:203]
    ds_read_b64_tr_b16 v[28:29], v2 offset:32
    v_mfma_f32_16x16x32_bf16 v[236:239], v[40:43], v[76:79], v[236:239]
    ds_read_b64_tr_b16 v[30:31], v2 offset:4640
    buffer_load_dwordx4 v[172:175], v7, s[24:27], s67 offen offset:3072 sc1
    v_mfma_f32_16x16x32_bf16 v[204:207], v[44:47], v[72:75], v[204:207]
    ds_read_b64_tr_b16 v[32:33], v2 offset:64
    v_mfma_f32_16x16x32_bf16 v[240:243], v[44:47], v[76:79], v[240:243]
    ds_read_b64_tr_b16 v[34:35], v2 offset:4672
    buffer_load_dwordx4 v18, s[8:11], s70 offen offset:3072 lds
    s_waitcnt lgkmcnt(6)
    v_mfma_f32_16x16x32_bf16 v[208:211], v[180:183], v[72:75], v[208:211]
    ds_read_b64_tr_b16 v[36:37], v2 offset:96
    v_mfma_f32_16x16x32_bf16 v[244:247], v[180:183], v[76:79], v[244:247]
    ds_read_b64_tr_b16 v[38:39], v2 offset:4704
    v_mfma_f32_16x16x32_bf16 v[212:215], v[104:107], v[72:75], v[212:215]
    ds_read_b64_tr_b16 v[40:41], v2 offset:128
    v_mfma_f32_16x16x32_bf16 v[248:251], v[104:107], v[76:79], v[248:251]
    ds_read_b64_tr_b16 v[42:43], v2 offset:4736
    v_mfma_f32_16x16x32_bf16 v[216:219], v[108:111], v[72:75], v[216:219]
    ds_read_b64_tr_b16 v[44:45], v2 offset:160
    v_mfma_f32_16x16x32_bf16 v[252:255], v[108:111], v[76:79], v[252:255]
    ds_read_b64_tr_b16 v[46:47], v2 offset:4768
    buffer_load_dwordx4 v20, s[8:11], s70 offen offset:3584 lds
    s_add_u32 s66, s66, 1
    s_branch gm_g2loop
gm_g2tail:
    s_waitcnt lgkmcnt(6) vmcnt(19)
    v_mfma_f32_16x16x32_bf16 v[184:187], v[24:27], v[144:147], v[184:187]
    ds_add_u32 v11, v13
    ds_read_b64_tr_b16 v[180:181], v2 offset:37056
    v_mfma_f32_16x16x32_bf16 v[220:223], v[24:27], v[148:151], v[220:223]
    ds_read_b64_tr_b16 v[182:183], v2 offset:41664
    v_mfma_f32_16x16x32_bf16 v[188:191], v[28:31], v[144:147], v[188:191]
    ds_read_b64_tr_b16 v[104:105], v2 offset:37088
    v_mfma_f32_16x16x32_bf16 v[224:227], v[28:31], v[148:151], v[224:227]
    ds_read_b64_tr_b16 v[106:107], v2 offset:41696
    v_mfma_f32_16x16x32_bf16 v[192:195], v[32:35], v[144:147], v[192:195]
    ds_read_b64_tr_b16 v[108:109], v2 offset:37120
    v_mfma_f32_16x16x32_bf16 v[228:231], v[32:35], v[148:151], v[228:231]
    ds_read_b64_tr_b16 v[110:111], v2 offset:41728
    s_waitcnt lgkmcnt(6)
    v_mfma_f32_16x16x32_bf16 v[196:199], v[36:39], v[144:147], v[196:199]
    ds_read_b64_tr_b16 v[24:25], v2 offset:46080
    v_mfma_f32_16x16x32_bf16 v[232:235], v[36:39], v[148:151], v[232:235]
    ds_read_b64_tr_b16 v[26:27], v2 offset:50688
    v_mfma_f32_16x16x32_bf16 v[200:203], v[40:43], v[144:147], v[200:203]
    ds_read_b64_tr_b16 v[28:29], v2 offset:46112
    v_mfma_f32_16x16x32_bf16 v[236:239], v[40:43], v[148:151], v[236:239]
    ds_read_b64_tr_b16 v[30:31], v2 offset:50720
    v_mfma_f32_16x16x32_bf16 v[204:207], v[44:47], v[144:147], v[204:207]
    ds_read_b64_tr_b16 v[32:33], v2 offset:46144
    v_mfma_f32_16x16x32_bf16 v[240:243], v[44:47], v[148:151], v[240:243]
    ds_read_b64_tr_b16 v[34:35], v2 offset:50752
    s_waitcnt lgkmcnt(6)
    v_mfma_f32_16x16x32_bf16 v[208:211], v[180:183], v[144:147], v[208:211]
    ds_read_b64_tr_b16 v[36:37], v2 offset:46176
    v_mfma_f32_16x16x32_bf16 v[244:247], v[180:183], v[148:151], v[244:247]
    ds_read_b64_tr_b16 v[38:39], v2 offset:50784
    v_mfma_f32_16x16x32_bf16 v[212:215], v[104:107], v[144:147], v[212:215]
    ds_read_b64_tr_b16 v[40:41], v2 offset:46208
    v_mfma_f32_16x16x32_bf16 v[248:251], v[104:107], v[148:151], v[248:251]
    ds_read_b64_tr_b16 v[42:43], v2 offset:50816
    v_mfma_f32_16x16x32_bf16 v[216:219], v[108:111], v[144:147], v[216:219]
    ds_read_b64_tr_b16 v[44:45], v2 offset:46240
    v_mfma_f32_16x16x32_bf16 v[252:255], v[108:111], v[148:151], v[252:255]
    ds_read_b64_tr_b16 v[46:47], v2 offset:50848
    s_waitcnt lgkmcnt(6) vmcnt(30)
    v_mfma_f32_16x16x32_bf16 v[184:187], v[24:27], v[152:155], v[184:187]
    ds_read_b32 v4, v12
    ds_read_b64_tr_b16 v[180:181], v2 offset:46272
    v_mfma_f32_16x16x32_bf16 v[220:223], v[24:27], v[156:159], v[220:223]
    ds_read_b64_tr_b16 v[182:183], v2 offset:50880
    v_mfma_f32_16x16x32_bf16 v[188:191], v[28:31], v[152:155], v[188:191]
    ds_read_b64_tr_b16 v[104:105], v2 offset:46304
    v_mfma_f32_16x16x32_bf16 v[224:227], v[28:31], v[156:159], v[224:227]
    ds_read_b64_tr_b16 v[106:107], v2 offset:50912
    v_mfma_f32_16x16x32_bf16 v[192:195], v[32:35], v[152:155], v[192:195]
    ds_read_b64_tr_b16 v[108:109], v2 offset:46336
    v_mfma_f32_16x16x32_bf16 v[228:231], v[32:35], v[156:159], v[228:231]
    ds_read_b64_tr_b16 v[110:111], v2 offset:50944
    s_waitcnt lgkmcnt(6)
    v_cmp_gt_u32 vcc, s64, v4
    s_cbranch_vccnz gm_g2r2t
gm_g2r2tb:
    s_add_u32 s64, s64, 1
    v_mfma_f32_16x16x32_bf16 v[196:199], v[36:39], v[152:155], v[196:199]
    ds_read_b64_tr_b16 v[24:25], v3 offset:0
    v_mfma_f32_16x16x32_bf16 v[232:235], v[36:39], v[156:159], v[232:235]
    ds_read_b64_tr_b16 v[26:27], v3 offset:4608
    v_mfma_f32_16x16x32_bf16 v[200:203], v[40:43], v[152:155], v[200:203]
    ds_read_b64_tr_b16 v[28:29], v3 offset:32
    v_mfma_f32_16x16x32_bf16 v[236:239], v[40:43], v[156:159], v[236:239]
    ds_read_b64_tr_b16 v[30:31], v3 offset:4640
    v_mfma_f32_16x16x32_bf16 v[204:207], v[44:47], v[152:155], v[204:207]
    ds_read_b64_tr_b16 v[32:33], v3 offset:64
    v_mfma_f32_16x16x32_bf16 v[240:243], v[44:47], v[156:159], v[240:243]
    ds_read_b64_tr_b16 v[34:35], v3 offset:4672
    s_waitcnt lgkmcnt(6)
    v_mfma_f32_16x16x32_bf16 v[208:211], v[180:183], v[152:155], v[208:211]
    ds_read_b64_tr_b16 v[36:37], v3 offset:96
    v_mfma_f32_16x16x32_bf16 v[244:247], v[180:183], v[156:159], v[244:247]
    ds_read_b64_tr_b16 v[38:39], v3 offset:4704
    v_mfma_f32_16x16x32_bf16 v[212:215], v[104:107], v[152:155], v[212:215]
    ds_read_b64_tr_b16 v[40:41], v3 offset:128
    v_mfma_f32_16x16x32_bf16 v[248:251], v[104:107], v[156:159], v[248:251]
    ds_read_b64_tr_b16 v[42:43], v3 offset:4736
    v_mfma_f32_16x16x32_bf16 v[216:219], v[108:111], v[152:155], v[216:219]
    ds_read_b64_tr_b16 v[44:45], v3 offset:160
    v_mfma_f32_16x16x32_bf16 v[252:255], v[108:111], v[156:159], v[252:255]
    ds_read_b64_tr_b16 v[46:47], v3 offset:4768
    s_setprio 2
    s_waitcnt lgkmcnt(6) vmcnt(10)
    v_mfma_f32_16x16x32_bf16 v[184:187], v[24:27], v[160:163], v[184:187]
    ds_add_u32 v11, v13
    ds_read_b64_tr_b16 v[180:181], v3 offset:192
    v_mfma_f32_16x16x32_bf16 v[220:223], v[24:27], v[164:167], v[220:223]
    ds_read_b64_tr_b16 v[182:183], v3 offset:4800
    v_mfma_f32_16x16x32_bf16 v[188:191], v[28:31], v[160:163], v[188:191]
    ds_read_b64_tr_b16 v[104:105], v3 offset:224
    v_mfma_f32_16x16x32_bf16 v[224:227], v[28:31], v[164:167], v[224:227]
    ds_read_b64_tr_b16 v[106:107], v3 offset:4832
    v_mfma_f32_16x16x32_bf16 v[192:195], v[32:35], v[160:163], v[192:195]
    ds_read_b64_tr_b16 v[108:109], v3 offset:256
    v_mfma_f32_16x16x32_bf16 v[228:231], v[32:35], v[164:167], v[228:231]
    ds_read_b64_tr_b16 v[110:111], v3 offset:4864
    s_waitcnt lgkmcnt(6)
    v_mfma_f32_16x16x32_bf16 v[196:199], v[36:39], v[160:163], v[196:199]
    ds_read_b64_tr_b16 v[24:25], v3 offset:9216
    v_mfma_f32_16x16x32_bf16 v[232:235], v[36:39], v[164:167], v[232:235]
    ds_read_b64_tr_b16 v[26:27], v3 offset:13824
    v_mfma_f32_16x16x32_bf16 v[200:203], v[40:43], v[160:163], v[200:203]
    ds_read_b64_tr_b16 v[28:29], v3 offset:9248
    v_mfma_f32_16x16x32_bf16 v[236:239], v[40:43], v[164:167], v[236:239]
    ds_read_b64_tr_b16 v[30:31], v3 offset:13856
    v_mfma_f32_16x16x32_bf16 v[204:207], v[44:47], v[160:163], v[204:207]
    ds_read_b64_tr_b16 v[32:33], v3 offset:9280
    v_mfma_f32_16x16x32_bf16 v[240:243], v[44:47], v[164:167], v[240:243]
    ds_read_b64_tr_b16 v[34:35], v3 offset:13888
    s_waitcnt lgkmcnt(6)
    v_mfma_f32_16x16x32_bf16 v[208:211], v[180:183], v[160:163], v[208:211]
    ds_read_b64_tr_b16 v[36:37], v3 offset:9312
    v_mfma_f32_16x16x32_bf16 v[244:247], v[180:183], v[164:167], v[244:247]
    ds_read_b64_tr_b16 v[38:39], v3 offset:13920
    v_mfma_f32_16x16x32_bf16 v[212:215], v[104:107], v[160:163], v[212:215]
    ds_read_b64_tr_b16 v[40:41], v3 offset:9344
    v_mfma_f32_16x16x32_bf16 v[248:251], v[104:107], v[164:167], v[248:251]
    ds_read_b64_tr_b16 v[42:43], v3 offset:13952
    v_mfma_f32_16x16x32_bf16 v[216:219], v[108:111], v[160:163], v[216:219]
    ds_read_b64_tr_b16 v[44:45], v3 offset:9376
    v_mfma_f32_16x16x32_bf16 v[252:255], v[108:111], v[164:167], v[252:255]
    ds_read_b64_tr_b16 v[46:47], v3 offset:13984
    s_waitcnt lgkmcnt(6) vmcnt(9)
    v_mfma_f32_16x16x32_bf16 v[184:187], v[24:27], v[168:171], v[184:187]
    ds_read_b32 v4, v12
    ds_read_b64_tr_b16 v[180:181], v3 offset:9408
    v_mfma_f32_16x16x32_bf16 v[220:223], v[24:27], v[172:175], v[220:223]
    ds_read_b64_tr_b16 v[182:183], v3 offset:14016
    v_mfma_f32_16x16x32_bf16 v[188:191], v[28:31], v[168:171], v[188:191]
    ds_read_b64_tr_b16 v[104:105], v3 offset:9440
    v_mfma_f32_16x16x32_bf16 v[224:227], v[28:31], v[172:175], v[224:227]
    ds_read_b64_tr_b16 v[106:107], v3 offset:14048
    v_mfma_f32_16x16x32_bf16 v[192:195], v[32:35], v[168:171], v[192:195]
    ds_read_b64_tr_b16 v[108:109], v3 offset:9472
    v_mfma_f32_16x16x32_bf16 v[228:231], v[32:35], v[172:175], v[228:231]
    ds_read_b64_tr_b16 v[110:111], v3 offset:14080
    s_waitcnt lgkmcnt(6)
    v_cmp_gt_u32 vcc, s64, v4
    s_cbranch_vccnz gm_g2r3t
gm_g2r3tb:
    s_add_u32 s64, s64, 1
    v_mfma_f32_16x16x32_bf16 v[196:199], v[36:39], v[168:171], v[196:199]
    ds_read_b64_tr_b16 v[24:25], v3 offset:18432
    v_mfma_f32_16x16x32_bf16 v[232:235], v[36:39], v[172:175], v[232:235]
    ds_read_b64_tr_b16 v[26:27], v3 offset:23040
    v_mfma_f32_16x16x32_bf16 v[200:203], v[40:43], v[168:171], v[200:203]
    ds_read_b64_tr_b16 v[28:29], v3 offset:18464
    v_mfma_f32_16x16x32_bf16 v[236:239], v[40:43], v[172:175], v[236:239]
    ds_read_b64_tr_b16 v[30:31], v3 offset:23072
    v_mfma_f32_16x16x32_bf16 v[204:207], v[44:47], v[168:171], v[204:207]
    ds_read_b64_tr_b16 v[32:33], v3 offset:18496
    v_mfma_f32_16x16x32_bf16 v[240:243], v[44:47], v[172:175], v[240:243]
    ds_read_b64_tr_b16 v[34:35], v3 offset:23104
    s_waitcnt lgkmcnt(6)
    v_mfma_f32_16x16x32_bf16 v[208:211], v[180:183], v[168:171], v[208:211]
    ds_read_b64_tr_b16 v[36:37], v3 offset:18528
    v_mfma_f32_16x16x32_bf16 v[244:247], v[180:183], v[172:175], v[244:247]
    ds_read_b64_tr_b16 v[38:39], v3 offset:23136
    v_mfma_f32_16x16x32_bf16 v[212:215], v[104:107], v[168:171], v[212:215]
    ds_read_b64_tr_b16 v[40:41], v3 offset:18560
    v_mfma_f32_16x16x32_bf16 v[248:251], v[104:107], v[172:175], v[248:251]
    ds_read_b64_tr_b16 v[42:43], v3 offset:23168
    v_mfma_f32_16x16x32_bf16 v[216:219], v[108:111], v[168:171], v[216:219]
    ds_read_b64_tr_b16 v[44:45], v3 offset:18592
    v_mfma_f32_16x16x32_bf16 v[252:255], v[108:111], v[172:175], v[252:255]
    ds_read_b64_tr_b16 v[46:47], v3 offset:23200
    s_waitcnt lgkmcnt(6) vmcnt(0)
    v_mfma_f32_16x16x32_bf16 v[184:187], v[24:27], v[48:51], v[184:187]
    ds_add_u32 v11, v13
    ds_read_b64_tr_b16 v[180:181], v3 offset:18624
    v_mfma_f32_16x16x32_bf16 v[220:223], v[24:27], v[52:55], v[220:223]
    ds_read_b64_tr_b16 v[182:183], v3 offset:23232
    v_mfma_f32_16x16x32_bf16 v[188:191], v[28:31], v[48:51], v[188:191]
    ds_read_b64_tr_b16 v[104:105], v3 offset:18656
    v_mfma_f32_16x16x32_bf16 v[224:227], v[28:31], v[52:55], v[224:227]
    ds_read_b64_tr_b16 v[106:107], v3 offset:23264
    v_mfma_f32_16x16x32_bf16 v[192:195], v[32:35], v[48:51], v[192:195]
    ds_read_b64_tr_b16 v[108:109], v3 offset:18688
    v_mfma_f32_16x16x32_bf16 v[228:231], v[32:35], v[52:55], v[228:231]
    ds_read_b64_tr_b16 v[110:111], v3 offset:23296
    s_waitcnt lgkmcnt(6)
    v_mfma_f32_16x16x32_bf16 v[196:199], v[36:39], v[48:51], v[196:199]
    ds_read_b64_tr_b16 v[24:25], v3 offset:27648
    v_mfma_f32_16x16x32_bf16 v[232:235], v[36:39], v[52:55], v[232:235]
    ds_read_b64_tr_b16 v[26:27], v3 offset:32256
    v_mfma_f32_16x16x32_bf16 v[200:203], v[40:43], v[48:51], v[200:203]
    ds_read_b64_tr_b16 v[28:29], v3 offset:27680
    v_mfma_f32_16x16x32_bf16 v[236:239], v[40:43], v[52:55], v[236:239]
    ds_read_b64_tr_b16 v[30:31], v3 offset:32288
    v_mfma_f32_16x16x32_bf16 v[204:207], v[44:47], v[48:51], v[204:207]
    ds_read_b64_tr_b16 v[32:33], v3 offset:27712
    v_mfma_f32_16x16x32_bf16 v[240:243], v[44:47], v[52:55], v[240:243]
    ds_read_b64_tr_b16 v[34:35], v3 offset:32320
    s_waitcnt lgkmcnt(6)
    v_mfma_f32_16x16x32_bf16 v[208:211], v[180:183], v[48:51], v[208:211]
    ds_read_b64_tr_b16 v[36:37], v3 offset:27744
    v_mfma_f32_16x16x32_bf16 v[244:247], v[180:183], v[52:55], v[244:247]
    ds_read_b64_tr_b16 v[38:39], v3 offset:32352
    v_mfma_f32_16x16x32_bf16 v[212:215], v[104:107], v[48:51], v[212:215]
    ds_read_b64_tr_b16 v[40:41], v3 offset:27776
    v_mfma_f32_16x16x32_bf16 v[248:251], v[104:107], v[52:55], v[248:251]
    ds_read_b64_tr_b16 v[42:43], v3 offset:32384
    v_mfma_f32_16x16x32_bf16 v[216:219], v[108:111], v[48:51], v[216:219]
    ds_read_b64_tr_b16 v[44:45], v3 offset:27808
    v_mfma_f32_16x16x32_bf16 v[252:255], v[108:111], v[52:55], v[252:255]
    ds_read_b64_tr_b16 v[46:47], v3 offset:32416
    s_waitcnt lgkmcnt(6) vmcnt(12)
    v_mfma_f32_16x16x32_bf16 v[184:187], v[24:27], v[56:59], v[184:187]
    ds_read_b32 v4, v12
    ds_read_b64_tr_b16 v[180:181], v3 offset:27840
    v_mfma_f32_16x16x32_bf16 v[220:223], v[24:27], v[60:63], v[220:223]
    ds_read_b64_tr_b16 v[182:183], v3 offset:32448
    v_mfma_f32_16x16x32_bf16 v[188:191], v[28:31], v[56:59], v[188:191]
    ds_read_b64_tr_b16 v[104:105], v3 offset:27872
    v_mfma_f32_16x16x32_bf16 v[224:227], v[28:31], v[60:63], v[224:227]
    ds_read_b64_tr_b16 v[106:107], v3 offset:32480
    v_mfma_f32_16x16x32_bf16 v[192:195], v[32:35], v[56:59], v[192:195]
    ds_read_b64_tr_b16 v[108:109], v3 offset:27904
    v_mfma_f32_16x16x32_bf16 v[228:231], v[32:35], v[60:63], v[228:231]
    ds_read_b64_tr_b16 v[110:111], v3 offset:32512
    s_waitcnt lgkmcnt(6)
    v_cmp_gt_u32 vcc, s64, v4
    s_cbranch_vccnz gm_g2r4t
gm_g2r4tb:
    s_add_u32 s64, s64, 1
    v_mfma_f32_16x16x32_bf16 v[196:199], v[36:39], v[56:59], v[196:199]
    ds_read_b64_tr_b16 v[24:25], v3 offset:36864
    v_mfma_f32_16x16x32_bf16 v[232:235], v[36:39], v[60:63], v[232:235]
    ds_read_b64_tr_b16 v[26:27], v3 offset:41472
    v_mfma_f32_16x16x32_bf16 v[200:203], v[40:43], v[56:59], v[200:203]
    ds_read_b64_tr_b16 v[28:29], v3 offset:46080
    v_mfma_f32_16x16x32_bf16 v[236:239], v[40:43], v[60:63], v[236:239]
    ds_read_b64_tr_b16 v[30:31], v3 offset:50688
    v_mfma_f32_16x16x32_bf16 v[204:207], v[44:47], v[56:59], v[204:207]
    ds_read_b64_tr_b16 v[32:33], v3 offset:36896
    v_mfma_f32_16x16x32_bf16 v[240:243], v[44:47], v[60:63], v[240:243]
    ds_read_b64_tr_b16 v[34:35], v3 offset:41504
    s_waitcnt lgkmcnt(6)
    v_mfma_f32_16x16x32_bf16 v[208:211], v[180:183], v[56:59], v[208:211]
    ds_read_b64_tr_b16 v[36:37], v3 offset:46112
    v_mfma_f32_16x16x32_bf16 v[244:247], v[180:183], v[60:63], v[244:247]
    ds_read_b64_tr_b16 v[38:39], v3 offset:50720
    v_mfma_f32_16x16x32_bf16 v[212:215], v[104:107], v[56:59], v[212:215]
    ds_read_b64_tr_b16 v[40:41], v3 offset:36928
    v_mfma_f32_16x16x32_bf16 v[248:251], v[104:107], v[60:63], v[248:251]
    ds_read_b64_tr_b16 v[42:43], v3 offset:41536
    v_mfma_f32_16x16x32_bf16 v[216:219], v[108:111], v[56:59], v[216:219]
    ds_read_b64_tr_b16 v[44:45], v3 offset:46144
    v_mfma_f32_16x16x32_bf16 v[252:255], v[108:111], v[60:63], v[252:255]
    ds_read_b64_tr_b16 v[46:47], v3 offset:50752
    s_waitcnt lgkmcnt(6) vmcnt(0)
    v_mfma_f32_16x16x32_bf16 v[184:187], v[24:27], v[64:67], v[184:187]
    ds_add_u32 v11, v13
    ds_read_b64_tr_b16 v[180:181], v3 offset:36960
    v_mfma_f32_16x16x32_bf16 v[220:223], v[24:27], v[68:71], v[220:223]
    ds_read_b64_tr_b16 v[182:183], v3 offset:41568
    v_mfma_f32_16x16x32_bf16 v[184:187], v[28:31], v[72:75], v[184:187]
    ds_read_b64_tr_b16 v[104:105], v3 offset:46176
    v_mfma_f32_16x16x32_bf16 v[220:223], v[28:31], v[76:79], v[220:223]
    ds_read_b64_tr_b16 v[106:107], v3 offset:50784
    v_mfma_f32_16x16x32_bf16 v[188:191], v[32:35], v[64:67], v[188:191]
    ds_read_b64_tr_b16 v[108:109], v3 offset:36992
    v_mfma_f32_16x16x32_bf16 v[224:227], v[32:35], v[68:71], v[224:227]
    ds_read_b64_tr_b16 v[110:111], v3 offset:41600
    s_waitcnt lgkmcnt(6)
    v_mfma_f32_16x16x32_bf16 v[188:191], v[36:39], v[72:75], v[188:191]
    ds_read_b64_tr_b16 v[24:25], v3 offset:46208
    v_mfma_f32_16x16x32_bf16 v[224:227], v[36:39], v[76:79], v[224:227]
    ds_read_b64_tr_b16 v[26:27], v3 offset:50816
    v_mfma_f32_16x16x32_bf16 v[192:195], v[40:43], v[64:67], v[192:195]
    ds_read_b64_tr_b16 v[28:29], v3 offset:37024
    v_mfma_f32_16x16x32_bf16 v[228:231], v[40:43], v[68:71], v[228:231]
    ds_read_b64_tr_b16 v[30:31], v3 offset:41632
    v_mfma_f32_16x16x32_bf16 v[192:195], v[44:47], v[72:75], v[192:195]
    ds_read_b64_tr_b16 v[32:33], v3 offset:46240
    v_mfma_f32_16x16x32_bf16 v[228:231], v[44:47], v[76:79], v[228:231]
    ds_read_b64_tr_b16 v[34:35], v3 offset:50848
    v_cvt_pk_bf16_f32 v80, v184, v185
    v_cvt_pk_bf16_f32 v81, v186, v187
    v_cvt_pk_bf16_f32 v82, v220, v221
    v_cvt_pk_bf16_f32 v83, v222, v223
    buffer_store_dwordx4 v[80:83], v7, s[24:27], s62 offen offset:0 sc1
    s_waitcnt lgkmcnt(6)
    v_mfma_f32_16x16x32_bf16 v[196:199], v[180:183], v[64:67], v[196:199]
    ds_read_b64_tr_b16 v[36:37], v3 offset:37056
    v_mfma_f32_16x16x32_bf16 v[232:235], v[180:183], v[68:71], v[232:235]
    ds_read_b64_tr_b16 v[38:39], v3 offset:41664
    v_mfma_f32_16x16x32_bf16 v[196:199], v[104:107], v[72:75], v[196:199]
    ds_read_b64_tr_b16 v[40:41], v3 offset:46272
    v_mfma_f32_16x16x32_bf16 v[232:235], v[104:107], v[76:79], v[232:235]
    ds_read_b64_tr_b16 v[42:43], v3 offset:50880
    v_cvt_pk_bf16_f32 v84, v188, v189
    v_cvt_pk_bf16_f32 v85, v190, v191
    v_cvt_pk_bf16_f32 v86, v224, v225
    v_cvt_pk_bf16_f32 v87, v226, v227
    buffer_store_dwordx4 v[84:87], v7, s[24:27], s62 offen offset:1024 sc1
    v_mfma_f32_16x16x32_bf16 v[200:203], v[108:111], v[64:67], v[200:203]
    ds_read_b64_tr_b16 v[44:45], v3 offset:37088
    v_mfma_f32_16x16x32_bf16 v[236:239], v[108:111], v[68:71], v[236:239]
    ds_read_b64_tr_b16 v[46:47], v3 offset:41696
    s_waitcnt lgkmcnt(6)
    v_mfma_f32_16x16x32_bf16 v[200:203], v[24:27], v[72:75], v[200:203]
    ds_read_b64_tr_b16 v[180:181], v3 offset:46304
    v_mfma_f32_16x16x32_bf16 v[236:239], v[24:27], v[76:79], v[236:239]
    ds_read_b64_tr_b16 v[182:183], v3 offset:50912
    v_cvt_pk_bf16_f32 v88, v192, v193
    v_cvt_pk_bf16_f32 v89, v194, v195
    v_cvt_pk_bf16_f32 v90, v228, v229
    v_cvt_pk_bf16_f32 v91, v230, v231
    buffer_store_dwordx4 v[88:91], v7, s[24:27], s62 offen offset:2048 sc1
    v_mfma_f32_16x16x32_bf16 v[204:207], v[28:31], v[64:67], v[204:207]
    ds_read_b64_tr_b16 v[104:105], v3 offset:37120
    v_mfma_f32_16x16x32_bf16 v[240:243], v[28:31], v[68:71], v[240:243]
    ds_read_b64_tr_b16 v[106:107], v3 offset:41728
    v_mfma_f32_16x16x32_bf16 v[204:207], v[32:35], v[72:75], v[204:207]
    ds_read_b64_tr_b16 v[108:109], v3 offset:46336
    v_mfma_f32_16x16x32_bf16 v[240:243], v[32:35], v[76:79], v[240:243]
    ds_read_b64_tr_b16 v[110:111], v3 offset:50944
    v_cvt_pk_bf16_f32 v92, v196, v197
    v_cvt_pk_bf16_f32 v93, v198, v199
    v_cvt_pk_bf16_f32 v94, v232, v233
    v_cvt_pk_bf16_f32 v95, v234, v235
    buffer_store_dwordx4 v[92:95], v7, s[24:27], s62 offen offset:3072 sc1
    s_add_u32 s62, s62, 4096
    s_waitcnt lgkmcnt(6)
    v_mfma_f32_16x16x32_bf16 v[208:211], v[36:39], v[64:67], v[208:211]
    v_mfma_f32_16x16x32_bf16 v[244:247], v[36:39], v[68:71], v[244:247]
    v_mfma_f32_16x16x32_bf16 v[208:211], v[40:43], v[72:75], v[208:211]
    v_mfma_f32_16x16x32_bf16 v[244:247], v[40:43], v[76:79], v[244:247]
    v_cvt_pk_bf16_f32 v96, v200, v201
    v_cvt_pk_bf16_f32 v97, v202, v203
    v_cvt_pk_bf16_f32 v98, v236, v237
    v_cvt_pk_bf16_f32 v99, v238, v239
    buffer_store_dwordx4 v[96:99], v7, s[24:27], s62 offen offset:0 sc1
    v_mfma_f32_16x16x32_bf16 v[212:215], v[44:47], v[64:67], v[212:215]
    v_mfma_f32_16x16x32_bf16 v[248:251], v[44:47], v[68:71], v[248:251]
    s_waitcnt lgkmcnt(0)
    v_mfma_f32_16x16x32_bf16 v[212:215], v[180:183], v[72:75], v[212:215]
    v_mfma_f32_16x16x32_bf16 v[248:251], v[180:183], v[76:79], v[248:251]
    v_cvt_pk_bf16_f32 v100, v204, v205
    v_cvt_pk_bf16_f32 v101, v206, v207
    v_cvt_pk_bf16_f32 v102, v240, v241
    v_cvt_pk_bf16_f32 v103, v242, v243
    buffer_store_dwordx4 v[100:103], v7, s[24:27], s62 offen offset:1024 sc1
    v_mfma_f32_16x16x32_bf16 v[216:219], v[104:107], v[64:67], v[216:219]
    v_mfma_f32_16x16x32_bf16 v[252:255], v[104:107], v[68:71], v[252:255]
    v_mfma_f32_16x16x32_bf16 v[216:219], v[108:111], v[72:75], v[216:219]
    v_mfma_f32_16x16x32_bf16 v[252:255], v[108:111], v[76:79], v[252:255]
    v_cvt_pk_bf16_f32 v80, v208, v209
    v_cvt_pk_bf16_f32 v81, v210, v211
    v_cvt_pk_bf16_f32 v82, v244, v245
    v_cvt_pk_bf16_f32 v83, v246, v247
    buffer_store_dwordx4 v[80:83], v7, s[24:27], s62 offen offset:2048 sc1
    s_setprio 2
    v_cvt_pk_bf16_f32 v84, v212, v213
    v_cvt_pk_bf16_f32 v85, v214, v215
    v_cvt_pk_bf16_f32 v86, v248, v249
    v_cvt_pk_bf16_f32 v87, v250, v251
    buffer_store_dwordx4 v[84:87], v7, s[24:27], s62 offen offset:3072 sc1
    s_add_u32 s62, s62, 4096
    v_cvt_pk_bf16_f32 v88, v216, v217
    v_cvt_pk_bf16_f32 v89, v218, v219
    v_cvt_pk_bf16_f32 v90, v252, v253
    v_cvt_pk_bf16_f32 v91, v254, v255
    buffer_store_dwordx4 v[88:91], v7, s[24:27], s62 offen offset:0 sc1
    s_lshl_b32 s56, s69, 2
    s_add_u32 s56, s56, s6
    s_lshl_b32 s56, s56, 6
    s_add_u32 s56, s56, 33037344
    s_waitcnt vmcnt(0)
    buffer_atomic_add v13, v23, s[24:27], s56 offen sc1
    s_branch gm_done
gm_qkv:
    v_and_b32 v15, 3, v1
    v_add_u32 v16, 5, v15
    v_add_u32 v17, 9, v15
    v_add_u32 v18, 14, v15
    v_add_u32 v21, 20, v15
    v_and_b32 v20, 1, v1
    v_mad_u32_u24 v20, v20, 9, 4
    v_and_b32 v96, 0xffffff80, v2
    v_and_b32 v97, 0x60, v2
    v_lshrrev_b32 v98, 4, v15
    v_lshl_add_u32 v98, v98, 13, v96
    v_and_b32 v15, 15, v15
    v_lshlrev_b32 v15, 3, v15
    v_xor_b32 v15, v15, v97
    v_add_u32 v15, v15, v98
    v_lshrrev_b32 v98, 4, v16
    v_lshl_add_u32 v98, v98, 13, v96
    v_and_b32 v16, 15, v16
    v_lshlrev_b32 v16, 3, v16
    v_xor_b32 v16, v16, v97
    v_add_u32 v16, v16, v98
    v_lshrrev_b32 v98, 4, v17
    v_lshl_add_u32 v98, v98, 13, v96
    v_and_b32 v17, 15, v17
    v_lshlrev_b32 v17, 3, v17
    v_xor_b32 v17, v17, v97
    v_add_u32 v17, v17, v98
    v_lshrrev_b32 v98, 4, v18
    v_lshl_add_u32 v98, v98, 13, v96
    v_and_b32 v18, 15, v18
    v_lshlrev_b32 v18, 3, v18
    v_xor_b32 v18, v18, v97
    v_add_u32 v18, v18, v98
    v_lshrrev_b32 v98, 4, v20
    v_lshl_add_u32 v98, v98, 13, v96
    v_and_b32 v20, 15, v20
    v_lshlrev_b32 v20, 3, v20
    v_xor_b32 v20, v20, v97
    v_add_u32 v20, v20, v98
    v_lshrrev_b32 v98, 4, v21
    v_lshl_add_u32 v98, v98, 13, v96
    v_and_b32 v21, 15, v21
    v_lshlrev_b32 v21, 3, v21
    v_xor_b32 v21, v21, v97
    v_add_u32 v21, v21, v98
gm_wq0:
    ds_read_b32 v14, v12
    s_sub_u32 s91, s91, 1
    s_cmp_lt_i32 s91, 0
    s_cbranch_scc1 gm_wq0x
    s_waitcnt lgkmcnt(0)
    v_cmp_gt_u32 vcc, 1, v14
    s_cbranch_vccnz gm_wq0
gm_wq0x:
    s_waitcnt lgkmcnt(0)
    ds_read_b64_tr_b16 v[24:25], v15 offset:0
    ds_read_b64_tr_b16 v[26:27], v15 offset:512
    ds_read_b64_tr_b16 v[28:29], v16 offset:0
    ds_read_b64_tr_b16 v[30:31], v16 offset:512
    ds_read_b64_tr_b16 v[32:33], v17 offset:0
    ds_read_b64_tr_b16 v[34:35], v17 offset:512
    ds_read_b64_tr_b16 v[36:37], v18 offset:0
    ds_read_b64_tr_b16 v[38:39], v18 offset:512
    ds_read_b64_tr_b16 v[40:41], v20 offset:0
    ds_read_b64_tr_b16 v[42:43], v20 offset:512
    ds_read_b64_tr_b16 v[44:45], v21 offset:0
    ds_read_b64_tr_b16 v[46:47], v21 offset:512
    s_waitcnt lgkmcnt(6)
    v_mfma_f32_16x16x32_bf16 v[48:51], v[24:27], v[112:115], 0
    ds_add_u32 v11, v13
    ds_read_b64_tr_b16 v[96:97], v15 offset:2048
    v_mfma_f32_16x16x32_bf16 v[52:55], v[24:27], v[116:119], 0
    ds_read_b64_tr_b16 v[98:99], v15 offset:2560
    v_mfma_f32_16x16x32_bf16 v[56:59], v[28:31], v[112:115], 0
    ds_read_b64_tr_b16 v[100:101], v16 offset:2048
    v_mfma_f32_16x16x32_bf16 v[60:63], v[28:31], v[116:119], 0
    ds_read_b64_tr_b16 v[102:103], v16 offset:2560
    v_mfma_f32_16x16x32_bf16 v[64:67], v[32:35], v[112:115], 0
    ds_read_b64_tr_b16 v[104:105], v17 offset:2048
    v_mfma_f32_16x16x32_bf16 v[68:71], v[32:35], v[116:119], 0
    ds_read_b64_tr_b16 v[106:107], v17 offset:2560
    s_waitcnt lgkmcnt(6)
    v_mfma_f32_16x16x32_bf16 v[72:75], v[36:39], v[112:115], 0
    ds_read_b64_tr_b16 v[108:109], v18 offset:2048
    v_mfma_f32_16x16x32_bf16 v[76:79], v[36:39], v[116:119], 0
    ds_read_b64_tr_b16 v[110:111], v18 offset:2560
    v_mfma_f32_16x16x32_bf16 v[80:83], v[40:43], v[112:115], 0
    ds_read_b64_tr_b16 v[24:25], v20 offset:2048
    v_mfma_f32_16x16x32_bf16 v[84:87], v[40:43], v[116:119], 0
    ds_read_b64_tr_b16 v[26:27], v20 offset:2560
    v_mfma_f32_16x16x32_bf16 v[88:91], v[44:47], v[112:115], 0
    ds_read_b64_tr_b16 v[28:29], v21 offset:2048
    v_mfma_f32_16x16x32_bf16 v[92:95], v[44:47], v[116:119], 0
    ds_read_b64_tr_b16 v[30:31], v21 offset:2560
    s_waitcnt lgkmcnt(6)
    v_mfma_f32_16x16x32_bf16 v[48:51], v[96:99], v[120:123], v[48:51]
    ds_read_b64_tr_b16 v[32:33], v15 offset:16384
    v_mfma_f32_16x16x32_bf16 v[52:55], v[96:99], v[124:127], v[52:55]
    ds_read_b64_tr_b16 v[34:35], v15 offset:16896
    v_mfma_f32_16x16x32_bf16 v[56:59], v[100:103], v[120:123], v[56:59]
    ds_read_b64_tr_b16 v[36:37], v16 offset:16384
    v_mfma_f32_16x16x32_bf16 v[60:63], v[100:103], v[124:127], v[60:63]
    ds_read_b64_tr_b16 v[38:39], v16 offset:16896
    v_mfma_f32_16x16x32_bf16 v[64:67], v[104:107], v[120:123], v[64:67]
    ds_read_b64_tr_b16 v[40:41], v17 offset:16384
    v_mfma_f32_16x16x32_bf16 v[68:71], v[104:107], v[124:127], v[68:71]
    ds_read_b64_tr_b16 v[42:43], v17 offset:16896
    s_waitcnt lgkmcnt(6)
    v_mfma_f32_16x16x32_bf16 v[72:75], v[108:111], v[120:123], v[72:75]
    ds_read_b32 v14, v12
    ds_read_b64_tr_b16 v[44:45], v18 offset:16384
    v_mfma_f32_16x16x32_bf16 v[76:79], v[108:111], v[124:127], v[76:79]
    ds_read_b64_tr_b16 v[46:47], v18 offset:16896
    v_mfma_f32_16x16x32_bf16 v[80:83], v[24:27], v[120:123], v[80:83]
    ds_read_b64_tr_b16 v[96:97], v20 offset:16384
    v_mfma_f32_16x16x32_bf16 v[84:87], v[24:27], v[124:127], v[84:87]
    ds_read_b64_tr_b16 v[98:99], v20 offset:16896
    v_mfma_f32_16x16x32_bf16 v[88:91], v[28:31], v[120:123], v[88:91]
    ds_read_b64_tr_b16 v[100:101], v21 offset:16384
    v_mfma_f32_16x16x32_bf16 v[92:95], v[28:31], v[124:127], v[92:95]
    ds_read_b64_tr_b16 v[102:103], v21 offset:16896
    s_waitcnt lgkmcnt(6)
    v_cmp_gt_u32 vcc, s64, v14
    s_cbranch_vccnz gm_qr0
gm_qr0b:
    v_mfma_f32_16x16x32_bf16 v[48:51], v[32:35], v[128:131], v[48:51]
    ds_read_b64_tr_b16 v[104:105], v15 offset:18432
    v_mfma_f32_16x16x32_bf16 v[52:55], v[32:35], v[132:135], v[52:55]
    ds_read_b64_tr_b16 v[106:107], v15 offset:18944
    v_mfma_f32_16x16x32_bf16 v[56:59], v[36:39], v[128:131], v[56:59]
    ds_read_b64_tr_b16 v[108:109], v16 offset:18432
    v_mfma_f32_16x16x32_bf16 v[60:63], v[36:39], v[132:135], v[60:63]
    ds_read_b64_tr_b16 v[110:111], v16 offset:18944
    v_mfma_f32_16x16x32_bf16 v[64:67], v[40:43], v[128:131], v[64:67]
    ds_read_b64_tr_b16 v[24:25], v17 offset:18432
    v_mfma_f32_16x16x32_bf16 v[68:71], v[40:43], v[132:135], v[68:71]
    ds_read_b64_tr_b16 v[26:27], v17 offset:18944
    s_add_u32 s64, s64, 1
    s_waitcnt lgkmcnt(6)
    v_mfma_f32_16x16x32_bf16 v[72:75], v[44:47], v[128:131], v[72:75]
    ds_read_b64_tr_b16 v[28:29], v18 offset:18432
    v_mfma_f32_16x16x32_bf16 v[76:79], v[44:47], v[132:135], v[76:79]
    ds_read_b64_tr_b16 v[30:31], v18 offset:18944
    v_mfma_f32_16x16x32_bf16 v[80:83], v[96:99], v[128:131], v[80:83]
    ds_read_b64_tr_b16 v[32:33], v20 offset:18432
    v_mfma_f32_16x16x32_bf16 v[84:87], v[96:99], v[132:135], v[84:87]
    ds_read_b64_tr_b16 v[34:35], v20 offset:18944
    v_mfma_f32_16x16x32_bf16 v[88:91], v[100:103], v[128:131], v[88:91]
    ds_read_b64_tr_b16 v[36:37], v21 offset:18432
    v_mfma_f32_16x16x32_bf16 v[92:95], v[100:103], v[132:135], v[92:95]
    ds_read_b64_tr_b16 v[38:39], v21 offset:18944
    s_waitcnt lgkmcnt(6)
    v_mfma_f32_16x16x32_bf16 v[48:51], v[104:107], v[136:139], v[48:51]
    ds_add_u32 v11, v13
    ds_read_b64_tr_b16 v[40:41], v15 offset:32768
    v_mfma_f32_16x16x32_bf16 v[52:55], v[104:107], v[140:143], v[52:55]
    ds_read_b64_tr_b16 v[42:43], v15 offset:33280
    v_mfma_f32_16x16x32_bf16 v[56:59], v[108:111], v[136:139], v[56:59]
    ds_read_b64_tr_b16 v[44:45], v16 offset:32768
    v_mfma_f32_16x16x32_bf16 v[60:63], v[108:111], v[140:143], v[60:63]
    ds_read_b64_tr_b16 v[46:47], v16 offset:33280
    v_mfma_f32_16x16x32_bf16 v[64:67], v[24:27], v[136:139], v[64:67]
    ds_read_b64_tr_b16 v[96:97], v17 offset:32768
    v_mfma_f32_16x16x32_bf16 v[68:71], v[24:27], v[140:143], v[68:71]
    ds_read_b64_tr_b16 v[98:99], v17 offset:33280
    s_waitcnt lgkmcnt(6)
    v_mfma_f32_16x16x32_bf16 v[72:75], v[28:31], v[136:139], v[72:75]
    ds_read_b64_tr_b16 v[100:101], v18 offset:32768
    v_mfma_f32_16x16x32_bf16 v[76:79], v[28:31], v[140:143], v[76:79]
    ds_read_b64_tr_b16 v[102:103], v18 offset:33280
    v_mfma_f32_16x16x32_bf16 v[80:83], v[32:35], v[136:139], v[80:83]
    ds_read_b64_tr_b16 v[104:105], v20 offset:32768
    v_mfma_f32_16x16x32_bf16 v[84:87], v[32:35], v[140:143], v[84:87]
    ds_read_b64_tr_b16 v[106:107], v20 offset:33280
    v_mfma_f32_16x16x32_bf16 v[88:91], v[36:39], v[136:139], v[88:91]
    ds_read_b64_tr_b16 v[108:109], v21 offset:32768
    v_mfma_f32_16x16x32_bf16 v[92:95], v[36:39], v[140:143], v[92:95]
    ds_read_b64_tr_b16 v[110:111], v21 offset:33280
    s_waitcnt lgkmcnt(6)
    v_mfma_f32_16x16x32_bf16 v[48:51], v[40:43], v[144:147], v[48:51]
    ds_read_b64_tr_b16 v[24:25], v15 offset:34816
    v_mfma_f32_16x16x32_bf16 v[52:55], v[40:43], v[148:151], v[52:55]
    ds_read_b64_tr_b16 v[26:27], v15 offset:35328
    v_mfma_f32_16x16x32_bf16 v[56:59], v[44:47], v[144:147], v[56:59]
    ds_read_b64_tr_b16 v[28:29], v16 offset:34816
    v_mfma_f32_16x16x32_bf16 v[60:63], v[44:47], v[148:151], v[60:63]
    ds_read_b64_tr_b16 v[30:31], v16 offset:35328
    v_mfma_f32_16x16x32_bf16 v[64:67], v[96:99], v[144:147], v[64:67]
    ds_read_b64_tr_b16 v[32:33], v17 offset:34816
    v_mfma_f32_16x16x32_bf16 v[68:71], v[96:99], v[148:151], v[68:71]
    ds_read_b64_tr_b16 v[34:35], v17 offset:35328
    s_waitcnt lgkmcnt(6)
    v_mfma_f32_16x16x32_bf16 v[72:75], v[100:103], v[144:147], v[72:75]
    ds_read_b32 v14, v12
    ds_read_b64_tr_b16 v[36:37], v18 offset:34816
    v_mfma_f32_16x16x32_bf16 v[76:79], v[100:103], v[148:151], v[76:79]
    ds_read_b64_tr_b16 v[38:39], v18 offset:35328
    v_mfma_f32_16x16x32_bf16 v[80:83], v[104:107], v[144:147], v[80:83]
    ds_read_b64_tr_b16 v[40:41], v20 offset:34816
    v_mfma_f32_16x16x32_bf16 v[84:87], v[104:107], v[148:151], v[84:87]
    ds_read_b64_tr_b16 v[42:43], v20 offset:35328
    v_mfma_f32_16x16x32_bf16 v[88:91], v[108:111], v[144:147], v[88:91]
    ds_read_b64_tr_b16 v[44:45], v21 offset:34816
    v_mfma_f32_16x16x32_bf16 v[92:95], v[108:111], v[148:151], v[92:95]
    ds_read_b64_tr_b16 v[46:47], v21 offset:35328
    s_waitcnt lgkmcnt(6)
    v_cmp_gt_u32 vcc, s64, v14
    s_cbranch_vccnz gm_qr1
gm_qr1b:
    v_add_u32 v15, 49152, v15
    v_mfma_f32_16x16x32_bf16 v[48:51], v[24:27], v[152:155], v[48:51]
    ds_read_b64_tr_b16 v[96:97], v15 offset:0
    v_mfma_f32_16x16x32_bf16 v[52:55], v[24:27], v[156:159], v[52:55]
    ds_read_b64_tr_b16 v[98:99], v15 offset:512
    v_add_u32 v16, 49152, v16
    v_mfma_f32_16x16x32_bf16 v[56:59], v[28:31], v[152:155], v[56:59]
    ds_read_b64_tr_b16 v[100:101], v16 offset:0
    v_mfma_f32_16x16x32_bf16 v[60:63], v[28:31], v[156:159], v[60:63]
    ds_read_b64_tr_b16 v[102:103], v16 offset:512
    v_add_u32 v17, 49152, v17
    v_mfma_f32_16x16x32_bf16 v[64:67], v[32:35], v[152:155], v[64:67]
    ds_read_b64_tr_b16 v[104:105], v17 offset:0
    v_mfma_f32_16x16x32_bf16 v[68:71], v[32:35], v[156:159], v[68:71]
    ds_read_b64_tr_b16 v[106:107], v17 offset:512
    s_add_u32 s64, s64, 1
    s_waitcnt lgkmcnt(6)
    v_add_u32 v18, 49152, v18
    v_mfma_f32_16x16x32_bf16 v[72:75], v[36:39], v[152:155], v[72:75]
    ds_read_b64_tr_b16 v[108:109], v18 offset:0
    v_mfma_f32_16x16x32_bf16 v[76:79], v[36:39], v[156:159], v[76:79]
    ds_read_b64_tr_b16 v[110:111], v18 offset:512
    v_add_u32 v20, 49152, v20
    v_mfma_f32_16x16x32_bf16 v[80:83], v[40:43], v[152:155], v[80:83]
    ds_read_b64_tr_b16 v[24:25], v20 offset:0
    v_mfma_f32_16x16x32_bf16 v[84:87], v[40:43], v[156:159], v[84:87]
    ds_read_b64_tr_b16 v[26:27], v20 offset:512
    v_add_u32 v21, 49152, v21
    v_mfma_f32_16x16x32_bf16 v[88:91], v[44:47], v[152:155], v[88:91]
    ds_read_b64_tr_b16 v[28:29], v21 offset:0
    v_mfma_f32_16x16x32_bf16 v[92:95], v[44:47], v[156:159], v[92:95]
    ds_read_b64_tr_b16 v[30:31], v21 offset:512
    s_waitcnt lgkmcnt(6)
    v_mfma_f32_16x16x32_bf16 v[48:51], v[96:99], v[160:163], v[48:51]
    ds_add_u32 v11, v13
    ds_read_b64_tr_b16 v[32:33], v15 offset:2048
    v_mfma_f32_16x16x32_bf16 v[52:55], v[96:99], v[164:167], v[52:55]
    ds_read_b64_tr_b16 v[34:35], v15 offset:2560
    v_mfma_f32_16x16x32_bf16 v[56:59], v[100:103], v[160:163], v[56:59]
    ds_read_b64_tr_b16 v[36:37], v16 offset:2048
    v_mfma_f32_16x16x32_bf16 v[60:63], v[100:103], v[164:167], v[60:63]
    ds_read_b64_tr_b16 v[38:39], v16 offset:2560
    v_mfma_f32_16x16x32_bf16 v[64:67], v[104:107], v[160:163], v[64:67]
    ds_read_b64_tr_b16 v[40:41], v17 offset:2048
    v_mfma_f32_16x16x32_bf16 v[68:71], v[104:107], v[164:167], v[68:71]
    ds_read_b64_tr_b16 v[42:43], v17 offset:2560
    s_waitcnt lgkmcnt(6)
    v_mfma_f32_16x16x32_bf16 v[72:75], v[108:111], v[160:163], v[72:75]
    ds_read_b64_tr_b16 v[44:45], v18 offset:2048
    v_mfma_f32_16x16x32_bf16 v[76:79], v[108:111], v[164:167], v[76:79]
    ds_read_b64_tr_b16 v[46:47], v18 offset:2560
    v_mfma_f32_16x16x32_bf16 v[80:83], v[24:27], v[160:163], v[80:83]
    ds_read_b64_tr_b16 v[96:97], v20 offset:2048
    v_mfma_f32_16x16x32_bf16 v[84:87], v[24:27], v[164:167], v[84:87]
    ds_read_b64_tr_b16 v[98:99], v20 offset:2560
    v_mfma_f32_16x16x32_bf16 v[88:91], v[28:31], v[160:163], v[88:91]
    ds_read_b64_tr_b16 v[100:101], v21 offset:2048
    v_mfma_f32_16x16x32_bf16 v[92:95], v[28:31], v[164:167], v[92:95]
    ds_read_b64_tr_b16 v[102:103], v21 offset:2560
    s_waitcnt lgkmcnt(6)
    v_mfma_f32_16x16x32_bf16 v[48:51], v[32:35], v[168:171], v[48:51]
    ds_read_b64_tr_b16 v[104:105], v15 offset:16384
    v_mfma_f32_16x16x32_bf16 v[52:55], v[32:35], v[172:175], v[52:55]
    ds_read_b64_tr_b16 v[106:107], v15 offset:16896
    v_mfma_f32_16x16x32_bf16 v[56:59], v[36:39], v[168:171], v[56:59]
    ds_read_b64_tr_b16 v[108:109], v16 offset:16384
    v_mfma_f32_16x16x32_bf16 v[60:63], v[36:39], v[172:175], v[60:63]
    ds_read_b64_tr_b16 v[110:111], v16 offset:16896
    v_mfma_f32_16x16x32_bf16 v[64:67], v[40:43], v[168:171], v[64:67]
    ds_read_b64_tr_b16 v[24:25], v17 offset:16384
    v_mfma_f32_16x16x32_bf16 v[68:71], v[40:43], v[172:175], v[68:71]
    ds_read_b64_tr_b16 v[26:27], v17 offset:16896
    s_waitcnt lgkmcnt(6)
    v_mfma_f32_16x16x32_bf16 v[72:75], v[44:47], v[168:171], v[72:75]
    ds_read_b32 v14, v12
    ds_read_b64_tr_b16 v[28:29], v18 offset:16384
    v_mfma_f32_16x16x32_bf16 v[76:79], v[44:47], v[172:175], v[76:79]
    ds_read_b64_tr_b16 v[30:31], v18 offset:16896
    v_mfma_f32_16x16x32_bf16 v[80:83], v[96:99], v[168:171], v[80:83]
    ds_read_b64_tr_b16 v[32:33], v20 offset:16384
    v_mfma_f32_16x16x32_bf16 v[84:87], v[96:99], v[172:175], v[84:87]
    ds_read_b64_tr_b16 v[34:35], v20 offset:16896
    v_mfma_f32_16x16x32_bf16 v[88:91], v[100:103], v[168:171], v[88:91]
    ds_read_b64_tr_b16 v[36:37], v21 offset:16384
    v_mfma_f32_16x16x32_bf16 v[92:95], v[100:103], v[172:175], v[92:95]
    ds_read_b64_tr_b16 v[38:39], v21 offset:16896
    s_waitcnt lgkmcnt(6)
    v_cmp_gt_u32 vcc, s64, v14
    s_cbranch_vccnz gm_qr2
gm_qr2b:
    v_mfma_f32_16x16x32_bf16 v[48:51], v[104:107], v[176:179], v[48:51]
    ds_read_b64_tr_b16 v[40:41], v15 offset:18432
    v_mfma_f32_16x16x32_bf16 v[52:55], v[104:107], v[180:183], v[52:55]
    ds_read_b64_tr_b16 v[42:43], v15 offset:18944
    v_mfma_f32_16x16x32_bf16 v[56:59], v[108:111], v[176:179], v[56:59]
    ds_read_b64_tr_b16 v[44:45], v16 offset:18432
    v_mfma_f32_16x16x32_bf16 v[60:63], v[108:111], v[180:183], v[60:63]
    ds_read_b64_tr_b16 v[46:47], v16 offset:18944
    v_mfma_f32_16x16x32_bf16 v[64:67], v[24:27], v[176:179], v[64:67]
    ds_read_b64_tr_b16 v[96:97], v17 offset:18432
    v_mfma_f32_16x16x32_bf16 v[68:71], v[24:27], v[180:183], v[68:71]
    ds_read_b64_tr_b16 v[98:99], v17 offset:18944
    s_add_u32 s64, s64, 1
    s_waitcnt lgkmcnt(6)
    v_mfma_f32_16x16x32_bf16 v[72:75], v[28:31], v[176:179], v[72:75]
    ds_read_b64_tr_b16 v[100:101], v18 offset:18432
    v_mfma_f32_16x16x32_bf16 v[76:79], v[28:31], v[180:183], v[76:79]
    ds_read_b64_tr_b16 v[102:103], v18 offset:18944
    v_mfma_f32_16x16x32_bf16 v[80:83], v[32:35], v[176:179], v[80:83]
    ds_read_b64_tr_b16 v[104:105], v20 offset:18432
    v_mfma_f32_16x16x32_bf16 v[84:87], v[32:35], v[180:183], v[84:87]
    ds_read_b64_tr_b16 v[106:107], v20 offset:18944
    v_mfma_f32_16x16x32_bf16 v[88:91], v[36:39], v[176:179], v[88:91]
    ds_read_b64_tr_b16 v[108:109], v21 offset:18432
    v_mfma_f32_16x16x32_bf16 v[92:95], v[36:39], v[180:183], v[92:95]
    ds_read_b64_tr_b16 v[110:111], v21 offset:18944
    s_waitcnt lgkmcnt(6)
    v_mfma_f32_16x16x32_bf16 v[48:51], v[40:43], v[184:187], v[48:51]
    ds_add_u32 v11, v13
    ds_read_b64_tr_b16 v[24:25], v15 offset:32768
    v_mfma_f32_16x16x32_bf16 v[52:55], v[40:43], v[188:191], v[52:55]
    ds_read_b64_tr_b16 v[26:27], v15 offset:33280
    v_mfma_f32_16x16x32_bf16 v[56:59], v[44:47], v[184:187], v[56:59]
    ds_read_b64_tr_b16 v[28:29], v16 offset:32768
    v_mfma_f32_16x16x32_bf16 v[60:63], v[44:47], v[188:191], v[60:63]
    ds_read_b64_tr_b16 v[30:31], v16 offset:33280
    v_mfma_f32_16x16x32_bf16 v[64:67], v[96:99], v[184:187], v[64:67]
    ds_read_b64_tr_b16 v[32:33], v17 offset:32768
    v_mfma_f32_16x16x32_bf16 v[68:71], v[96:99], v[188:191], v[68:71]
    ds_read_b64_tr_b16 v[34:35], v17 offset:33280
    s_waitcnt lgkmcnt(6)
    v_mfma_f32_16x16x32_bf16 v[72:75], v[100:103], v[184:187], v[72:75]
    ds_read_b64_tr_b16 v[36:37], v18 offset:32768
    v_mfma_f32_16x16x32_bf16 v[76:79], v[100:103], v[188:191], v[76:79]
    ds_read_b64_tr_b16 v[38:39], v18 offset:33280
    v_mfma_f32_16x16x32_bf16 v[80:83], v[104:107], v[184:187], v[80:83]
    ds_read_b64_tr_b16 v[40:41], v20 offset:32768
    v_mfma_f32_16x16x32_bf16 v[84:87], v[104:107], v[188:191], v[84:87]
    ds_read_b64_tr_b16 v[42:43], v20 offset:33280
    v_mfma_f32_16x16x32_bf16 v[88:91], v[108:111], v[184:187], v[88:91]
    ds_read_b64_tr_b16 v[44:45], v21 offset:32768
    v_mfma_f32_16x16x32_bf16 v[92:95], v[108:111], v[188:191], v[92:95]
    ds_read_b64_tr_b16 v[46:47], v21 offset:33280
    s_waitcnt lgkmcnt(6)
    v_mfma_f32_16x16x32_bf16 v[48:51], v[24:27], v[192:195], v[48:51]
    ds_read_b64_tr_b16 v[96:97], v15 offset:34816
    v_mfma_f32_16x16x32_bf16 v[52:55], v[24:27], v[196:199], v[52:55]
    ds_read_b64_tr_b16 v[98:99], v15 offset:35328
    v_mfma_f32_16x16x32_bf16 v[56:59], v[28:31], v[192:195], v[56:59]
    ds_read_b64_tr_b16 v[100:101], v16 offset:34816
    v_mfma_f32_16x16x32_bf16 v[60:63], v[28:31], v[196:199], v[60:63]
    ds_read_b64_tr_b16 v[102:103], v16 offset:35328
    v_mfma_f32_16x16x32_bf16 v[64:67], v[32:35], v[192:195], v[64:67]
    ds_read_b64_tr_b16 v[104:105], v17 offset:34816
    v_mfma_f32_16x16x32_bf16 v[68:71], v[32:35], v[196:199], v[68:71]
    ds_read_b64_tr_b16 v[106:107], v17 offset:35328
    s_waitcnt lgkmcnt(6)
    v_mfma_f32_16x16x32_bf16 v[72:75], v[36:39], v[192:195], v[72:75]
    ds_read_b32 v14, v12
    ds_read_b64_tr_b16 v[108:109], v18 offset:34816
    v_mfma_f32_16x16x32_bf16 v[76:79], v[36:39], v[196:199], v[76:79]
    ds_read_b64_tr_b16 v[110:111], v18 offset:35328
    v_mfma_f32_16x16x32_bf16 v[80:83], v[40:43], v[192:195], v[80:83]
    ds_read_b64_tr_b16 v[24:25], v20 offset:34816
    v_mfma_f32_16x16x32_bf16 v[84:87], v[40:43], v[196:199], v[84:87]
    ds_read_b64_tr_b16 v[26:27], v20 offset:35328
    v_mfma_f32_16x16x32_bf16 v[88:91], v[44:47], v[192:195], v[88:91]
    ds_read_b64_tr_b16 v[28:29], v21 offset:34816
    v_mfma_f32_16x16x32_bf16 v[92:95], v[44:47], v[196:199], v[92:95]
    ds_read_b64_tr_b16 v[30:31], v21 offset:35328
    s_waitcnt lgkmcnt(6)
    v_cmp_gt_u32 vcc, s64, v14
    s_cbranch_vccnz gm_qr3
gm_qr3b:
    v_add_u32 v15, 49152, v15
    v_mfma_f32_16x16x32_bf16 v[48:51], v[96:99], v[200:203], v[48:51]
    ds_read_b64_tr_b16 v[32:33], v15 offset:0
    v_mfma_f32_16x16x32_bf16 v[52:55], v[96:99], v[204:207], v[52:55]
    ds_read_b64_tr_b16 v[34:35], v15 offset:512
    v_add_u32 v16, 49152, v16
    v_mfma_f32_16x16x32_bf16 v[56:59], v[100:103], v[200:203], v[56:59]
    ds_read_b64_tr_b16 v[36:37], v16 offset:0
    v_mfma_f32_16x16x32_bf16 v[60:63], v[100:103], v[204:207], v[60:63]
    ds_read_b64_tr_b16 v[38:39], v16 offset:512
    v_add_u32 v17, 49152, v17
    v_mfma_f32_16x16x32_bf16 v[64:67], v[104:107], v[200:203], v[64:67]
    ds_read_b64_tr_b16 v[40:41], v17 offset:0
    v_mfma_f32_16x16x32_bf16 v[68:71], v[104:107], v[204:207], v[68:71]
    ds_read_b64_tr_b16 v[42:43], v17 offset:512
    s_add_u32 s64, s64, 1
    s_waitcnt lgkmcnt(6)
    v_add_u32 v18, 49152, v18
    v_mfma_f32_16x16x32_bf16 v[72:75], v[108:111], v[200:203], v[72:75]
    ds_read_b64_tr_b16 v[44:45], v18 offset:0
    v_mfma_f32_16x16x32_bf16 v[76:79], v[108:111], v[204:207], v[76:79]
    ds_read_b64_tr_b16 v[46:47], v18 offset:512
    v_add_u32 v20, 49152, v20
    v_mfma_f32_16x16x32_bf16 v[80:83], v[24:27], v[200:203], v[80:83]
    ds_read_b64_tr_b16 v[96:97], v20 offset:0
    v_mfma_f32_16x16x32_bf16 v[84:87], v[24:27], v[204:207], v[84:87]
    ds_read_b64_tr_b16 v[98:99], v20 offset:512
    v_add_u32 v21, 49152, v21
    v_mfma_f32_16x16x32_bf16 v[88:91], v[28:31], v[200:203], v[88:91]
    ds_read_b64_tr_b16 v[100:101], v21 offset:0
    v_mfma_f32_16x16x32_bf16 v[92:95], v[28:31], v[204:207], v[92:95]
    ds_read_b64_tr_b16 v[102:103], v21 offset:512
    s_waitcnt lgkmcnt(6)
    v_mfma_f32_16x16x32_bf16 v[48:51], v[32:35], v[208:211], v[48:51]
    ds_add_u32 v11, v13
    ds_read_b64_tr_b16 v[104:105], v15 offset:2048
    v_mfma_f32_16x16x32_bf16 v[52:55], v[32:35], v[212:215], v[52:55]
    ds_read_b64_tr_b16 v[106:107], v15 offset:2560
    v_mfma_f32_16x16x32_bf16 v[56:59], v[36:39], v[208:211], v[56:59]
    ds_read_b64_tr_b16 v[108:109], v16 offset:2048
    v_mfma_f32_16x16x32_bf16 v[60:63], v[36:39], v[212:215], v[60:63]
    ds_read_b64_tr_b16 v[110:111], v16 offset:2560
    v_mfma_f32_16x16x32_bf16 v[64:67], v[40:43], v[208:211], v[64:67]
    ds_read_b64_tr_b16 v[24:25], v17 offset:2048
    v_mfma_f32_16x16x32_bf16 v[68:71], v[40:43], v[212:215], v[68:71]
    ds_read_b64_tr_b16 v[26:27], v17 offset:2560
    s_waitcnt lgkmcnt(6)
    v_mfma_f32_16x16x32_bf16 v[72:75], v[44:47], v[208:211], v[72:75]
    ds_read_b64_tr_b16 v[28:29], v18 offset:2048
    v_mfma_f32_16x16x32_bf16 v[76:79], v[44:47], v[212:215], v[76:79]
    ds_read_b64_tr_b16 v[30:31], v18 offset:2560
    v_mfma_f32_16x16x32_bf16 v[80:83], v[96:99], v[208:211], v[80:83]
    ds_read_b64_tr_b16 v[32:33], v20 offset:2048
    v_mfma_f32_16x16x32_bf16 v[84:87], v[96:99], v[212:215], v[84:87]
    ds_read_b64_tr_b16 v[34:35], v20 offset:2560
    v_mfma_f32_16x16x32_bf16 v[88:91], v[100:103], v[208:211], v[88:91]
    ds_read_b64_tr_b16 v[36:37], v21 offset:2048
    v_mfma_f32_16x16x32_bf16 v[92:95], v[100:103], v[212:215], v[92:95]
    ds_read_b64_tr_b16 v[38:39], v21 offset:2560
    s_waitcnt lgkmcnt(6)
    v_mfma_f32_16x16x32_bf16 v[48:51], v[104:107], v[216:219], v[48:51]
    ds_read_b64_tr_b16 v[40:41], v15 offset:16384
    v_mfma_f32_16x16x32_bf16 v[52:55], v[104:107], v[220:223], v[52:55]
    ds_read_b64_tr_b16 v[42:43], v15 offset:16896
    v_mfma_f32_16x16x32_bf16 v[56:59], v[108:111], v[216:219], v[56:59]
    ds_read_b64_tr_b16 v[44:45], v16 offset:16384
    v_mfma_f32_16x16x32_bf16 v[60:63], v[108:111], v[220:223], v[60:63]
    ds_read_b64_tr_b16 v[46:47], v16 offset:16896
    v_mfma_f32_16x16x32_bf16 v[64:67], v[24:27], v[216:219], v[64:67]
    ds_read_b64_tr_b16 v[96:97], v17 offset:16384
    v_mfma_f32_16x16x32_bf16 v[68:71], v[24:27], v[220:223], v[68:71]
    ds_read_b64_tr_b16 v[98:99], v17 offset:16896
    s_waitcnt lgkmcnt(6)
    v_mfma_f32_16x16x32_bf16 v[72:75], v[28:31], v[216:219], v[72:75]
    ds_read_b32 v14, v12
    ds_read_b64_tr_b16 v[100:101], v18 offset:16384
    v_mfma_f32_16x16x32_bf16 v[76:79], v[28:31], v[220:223], v[76:79]
    ds_read_b64_tr_b16 v[102:103], v18 offset:16896
    v_mfma_f32_16x16x32_bf16 v[80:83], v[32:35], v[216:219], v[80:83]
    ds_read_b64_tr_b16 v[104:105], v20 offset:16384
    v_mfma_f32_16x16x32_bf16 v[84:87], v[32:35], v[220:223], v[84:87]
    ds_read_b64_tr_b16 v[106:107], v20 offset:16896
    v_mfma_f32_16x16x32_bf16 v[88:91], v[36:39], v[216:219], v[88:91]
    ds_read_b64_tr_b16 v[108:109], v21 offset:16384
    v_mfma_f32_16x16x32_bf16 v[92:95], v[36:39], v[220:223], v[92:95]
    ds_read_b64_tr_b16 v[110:111], v21 offset:16896
    s_waitcnt lgkmcnt(6)
    v_cmp_gt_u32 vcc, s64, v14
    s_cbranch_vccnz gm_qr4
gm_qr4b:
    v_mfma_f32_16x16x32_bf16 v[48:51], v[40:43], v[224:227], v[48:51]
    ds_read_b64_tr_b16 v[24:25], v15 offset:18432
    v_mfma_f32_16x16x32_bf16 v[52:55], v[40:43], v[228:231], v[52:55]
    ds_read_b64_tr_b16 v[26:27], v15 offset:18944
    v_mfma_f32_16x16x32_bf16 v[56:59], v[44:47], v[224:227], v[56:59]
    ds_read_b64_tr_b16 v[28:29], v16 offset:18432
    v_mfma_f32_16x16x32_bf16 v[60:63], v[44:47], v[228:231], v[60:63]
    ds_read_b64_tr_b16 v[30:31], v16 offset:18944
    v_mfma_f32_16x16x32_bf16 v[64:67], v[96:99], v[224:227], v[64:67]
    ds_read_b64_tr_b16 v[32:33], v17 offset:18432
    v_mfma_f32_16x16x32_bf16 v[68:71], v[96:99], v[228:231], v[68:71]
    ds_read_b64_tr_b16 v[34:35], v17 offset:18944
    s_add_u32 s64, s64, 1
    s_waitcnt lgkmcnt(6)
    v_mfma_f32_16x16x32_bf16 v[72:75], v[100:103], v[224:227], v[72:75]
    ds_read_b64_tr_b16 v[36:37], v18 offset:18432
    v_mfma_f32_16x16x32_bf16 v[76:79], v[100:103], v[228:231], v[76:79]
    ds_read_b64_tr_b16 v[38:39], v18 offset:18944
    v_mfma_f32_16x16x32_bf16 v[80:83], v[104:107], v[224:227], v[80:83]
    ds_read_b64_tr_b16 v[40:41], v20 offset:18432
    v_mfma_f32_16x16x32_bf16 v[84:87], v[104:107], v[228:231], v[84:87]
    ds_read_b64_tr_b16 v[42:43], v20 offset:18944
    v_mfma_f32_16x16x32_bf16 v[88:91], v[108:111], v[224:227], v[88:91]
    ds_read_b64_tr_b16 v[44:45], v21 offset:18432
    v_mfma_f32_16x16x32_bf16 v[92:95], v[108:111], v[228:231], v[92:95]
    ds_read_b64_tr_b16 v[46:47], v21 offset:18944
    s_waitcnt lgkmcnt(6)
    v_mfma_f32_16x16x32_bf16 v[48:51], v[24:27], v[232:235], v[48:51]
    ds_add_u32 v11, v13
    ds_read_b64_tr_b16 v[96:97], v15 offset:32768
    v_mfma_f32_16x16x32_bf16 v[52:55], v[24:27], v[236:239], v[52:55]
    ds_read_b64_tr_b16 v[98:99], v15 offset:33280
    v_mfma_f32_16x16x32_bf16 v[56:59], v[28:31], v[232:235], v[56:59]
    ds_read_b64_tr_b16 v[100:101], v16 offset:32768
    v_mfma_f32_16x16x32_bf16 v[60:63], v[28:31], v[236:239], v[60:63]
    ds_read_b64_tr_b16 v[102:103], v16 offset:33280
    v_mfma_f32_16x16x32_bf16 v[64:67], v[32:35], v[232:235], v[64:67]
    ds_read_b64_tr_b16 v[104:105], v17 offset:32768
    v_mfma_f32_16x16x32_bf16 v[68:71], v[32:35], v[236:239], v[68:71]
    ds_read_b64_tr_b16 v[106:107], v17 offset:33280
    s_waitcnt lgkmcnt(6)
    v_mfma_f32_16x16x32_bf16 v[72:75], v[36:39], v[232:235], v[72:75]
    ds_read_b64_tr_b16 v[108:109], v18 offset:32768
    v_mfma_f32_16x16x32_bf16 v[76:79], v[36:39], v[236:239], v[76:79]
    ds_read_b64_tr_b16 v[110:111], v18 offset:33280
    v_mfma_f32_16x16x32_bf16 v[80:83], v[40:43], v[232:235], v[80:83]
    ds_read_b64_tr_b16 v[24:25], v20 offset:32768
    v_mfma_f32_16x16x32_bf16 v[84:87], v[40:43], v[236:239], v[84:87]
    ds_read_b64_tr_b16 v[26:27], v20 offset:33280
    v_mfma_f32_16x16x32_bf16 v[88:91], v[44:47], v[232:235], v[88:91]
    ds_read_b64_tr_b16 v[28:29], v21 offset:32768
    v_mfma_f32_16x16x32_bf16 v[92:95], v[44:47], v[236:239], v[92:95]
    ds_read_b64_tr_b16 v[30:31], v21 offset:33280
    s_waitcnt lgkmcnt(6)
    v_mfma_f32_16x16x32_bf16 v[48:51], v[96:99], v[240:243], v[48:51]
    ds_read_b64_tr_b16 v[32:33], v15 offset:34816
    v_mfma_f32_16x16x32_bf16 v[52:55], v[96:99], v[244:247], v[52:55]
    ds_read_b64_tr_b16 v[34:35], v15 offset:35328
    v_mfma_f32_16x16x32_bf16 v[56:59], v[100:103], v[240:243], v[56:59]
    ds_read_b64_tr_b16 v[36:37], v16 offset:34816
    v_mfma_f32_16x16x32_bf16 v[60:63], v[100:103], v[244:247], v[60:63]
    ds_read_b64_tr_b16 v[38:39], v16 offset:35328
    v_mfma_f32_16x16x32_bf16 v[64:67], v[104:107], v[240:243], v[64:67]
    ds_read_b64_tr_b16 v[40:41], v17 offset:34816
    v_mfma_f32_16x16x32_bf16 v[68:71], v[104:107], v[244:247], v[68:71]
    ds_read_b64_tr_b16 v[42:43], v17 offset:35328
    s_waitcnt lgkmcnt(6)
    v_mfma_f32_16x16x32_bf16 v[72:75], v[108:111], v[240:243], v[72:75]
    ds_read_b64_tr_b16 v[44:45], v18 offset:34816
    v_mfma_f32_16x16x32_bf16 v[76:79], v[108:111], v[244:247], v[76:79]
    ds_read_b64_tr_b16 v[46:47], v18 offset:35328
    v_mfma_f32_16x16x32_bf16 v[80:83], v[24:27], v[240:243], v[80:83]
    ds_read_b64_tr_b16 v[96:97], v20 offset:34816
    v_mfma_f32_16x16x32_bf16 v[84:87], v[24:27], v[244:247], v[84:87]
    ds_read_b64_tr_b16 v[98:99], v20 offset:35328
    v_mfma_f32_16x16x32_bf16 v[88:91], v[28:31], v[240:243], v[88:91]
    ds_read_b64_tr_b16 v[100:101], v21 offset:34816
    v_mfma_f32_16x16x32_bf16 v[92:95], v[28:31], v[244:247], v[92:95]
    ds_read_b64_tr_b16 v[102:103], v21 offset:35328
    s_waitcnt lgkmcnt(6)
    v_mfma_f32_16x16x32_bf16 v[48:51], v[32:35], v[248:251], v[48:51]
    v_mfma_f32_16x16x32_bf16 v[52:55], v[32:35], v[252:255], v[52:55]
    v_mfma_f32_16x16x32_bf16 v[56:59], v[36:39], v[248:251], v[56:59]
    v_mfma_f32_16x16x32_bf16 v[60:63], v[36:39], v[252:255], v[60:63]
    v_mfma_f32_16x16x32_bf16 v[64:67], v[40:43], v[248:251], v[64:67]
    v_mfma_f32_16x16x32_bf16 v[68:71], v[40:43], v[252:255], v[68:71]
    s_add_u32 s64, s64, 1
    s_waitcnt lgkmcnt(0)
    v_mfma_f32_16x16x32_bf16 v[72:75], v[44:47], v[248:251], v[72:75]
    v_mfma_f32_16x16x32_bf16 v[76:79], v[44:47], v[252:255], v[76:79]
    v_mfma_f32_16x16x32_bf16 v[80:83], v[96:99], v[248:251], v[80:83]
    v_mfma_f32_16x16x32_bf16 v[84:87], v[96:99], v[252:255], v[84:87]
    v_mfma_f32_16x16x32_bf16 v[88:91], v[100:103], v[248:251], v[88:91]
    v_mfma_f32_16x16x32_bf16 v[92:95], v[100:103], v[252:255], v[92:95]
    v_lshrrev_b32 v15, 4, v1
    v_and_b32 v16, 15, v1
    v_mul_f32 v96, 0x3eae1a93, v10
    v_mul_f32 v97, 0x3eae1a93, v0
    v_lshrrev_b32 v20, 5, v1
    v_lshlrev_b32 v17, 4, v16
    v_lshl_add_u32 v17, v20, 9, v17
    v_bfe_u32 v20, v1, 4, 1
    v_lshl_add_u32 v17, v20, 3, v17
    s_lshr_b32 s56, s5, 1
    s_mul_i32 s59, s69, 3840
    s_add_u32 s59, s59, 18874368
    s_lshl_b32 s57, s69, 3
    s_add_u32 s57, s57, s56
    s_mul_i32 s57, s57, 2304
    s_add_u32 s57, s57, 30931968
    s_cmp_ge_u32 s56, 4
    s_cbranch_scc1 gm_qdone
    v_mul_f32 v88, v10, v88
    v_mul_f32 v89, v10, v89
    v_mul_f32 v90, v10, v90
    v_mul_f32 v91, v10, v91
    v_mul_f32 v92, v0, v92
    v_mul_f32 v93, v0, v93
    v_mul_f32 v94, v0, v94
    v_mul_f32 v95, v0, v95
    v_cvt_pk_bf16_f32 v88, v88, v89
    v_cvt_pk_bf16_f32 v89, v90, v91
    v_cvt_pk_bf16_f32 v92, v92, v93
    v_cvt_pk_bf16_f32 v93, v94, v95
    s_bitcmp1_b32 s56, 0
    s_cbranch_scc1 gm_q1
    s_lshr_b32 s58, s56, 1
    s_mul_i32 s63, s58, 3
    v_cmp_eq_u32 vcc, s63, v15
    v_lshlrev_b32 v20, 3, v16
    v_bfrev_b32 v21, 1
    v_cndmask_b32 v20, v21, v20, vcc
    s_cmp_eq_u32 s58, 0
    s_cselect_b64 vcc, -1, 0
    s_mul_i32 s58, s58, 2560
    s_add_u32 s63, s59, s58
    s_sub_u32 s59, s59, s58
    v_cndmask_b32 v90, v89, v88, vcc
    v_cndmask_b32 v94, v93, v92, vcc
    v_mov_b32 v91, 0x3f803f80
    v_mov_b32 v95, 0x3f803f80
    buffer_store_dwordx2 v[88:89], v17, s[24:27], s63 offen sc1
    buffer_store_dwordx2 v[92:93], v17, s[24:27], s63 offen offset:256 sc1
    buffer_store_dwordx2 v[90:91], v20, s[24:27], s59 offen offset:3584 sc1
    buffer_store_dwordx2 v[94:95], v20, s[24:27], s59 offen offset:3712 sc1
    s_branch gm_qdone
gm_q1:
    s_lshl_b32 s58, s3, 10
    s_add_u32 s58, s58, 159744
    v_lshl_add_u32 v20, v16, 1, s58
    v_lshl_add_u32 v20, v15, 8, v20
    ds_write_b16 v20, v88 offset:0
    ds_write_b16_d16_hi v20, v88 offset:64
    ds_write_b16 v20, v89 offset:128
    ds_write_b16_d16_hi v20, v89 offset:192
    ds_write_b16 v20, v92 offset:32
    ds_write_b16_d16_hi v20, v92 offset:96
    ds_write_b16 v20, v93 offset:160
    ds_write_b16_d16_hi v20, v93 offset:224
    v_lshl_add_u32 v20, v16, 6, s58
    v_lshl_add_u32 v20, v15, 4, v20
    v_mov_b32 v21, v7
    s_waitcnt lgkmcnt(0)
    ds_read_b128 v[88:91], v20
    s_cmp_eq_u32 s56, 1
    s_waitcnt lgkmcnt(0)
    s_cbranch_scc1 gm_q1s
    v_cmp_eq_u32 vcc, 12, v16
    v_mov_b32 v92, 0x3f803f80
    v_add_u32 v93, 2, v16
    v_and_b32 v93, 3, v93
    v_cndmask_b32 v88, v88, v92, vcc
    v_cndmask_b32 v89, v89, v92, vcc
    v_cndmask_b32 v90, v90, v92, vcc
    v_cndmask_b32 v91, v91, v92, vcc
    v_cmp_gt_u32 vcc, 12, v16
    v_lshl_add_u32 v21, v15, 2, v93
    v_lshlrev_b32 v21, 4, v21
    v_add_u32 v21, 1024, v21
    v_bfrev_b32 v94, 1
    v_cndmask_b32 v21, v21, v94, vcc
gm_q1s:
    buffer_store_dwordx4 v[88:91], v21, s[24:27], s59 offen offset:1280 sc1
gm_qdone:
    v_mul_f32 v48, v96, v48
    v_mul_f32 v49, v96, v49
    v_mul_f32 v50, v96, v50
    v_mul_f32 v51, v96, v51
    v_mul_f32 v52, v97, v52
    v_mul_f32 v53, v97, v53
    v_mul_f32 v54, v97, v54
    v_mul_f32 v55, v97, v55
    v_cvt_pk_bf16_f32 v48, v48, v49
    v_cvt_pk_bf16_f32 v49, v50, v51
    v_cvt_pk_bf16_f32 v52, v52, v53
    v_cvt_pk_bf16_f32 v53, v54, v55
    v_mul_f32 v56, v96, v56
    v_mul_f32 v57, v96, v57
    v_mul_f32 v58, v96, v58
    v_mul_f32 v59, v96, v59
    v_mul_f32 v60, v97, v60
    v_mul_f32 v61, v97, v61
    v_mul_f32 v62, v97, v62
    v_mul_f32 v63, v97, v63
    v_cvt_pk_bf16_f32 v56, v56, v57
    v_cvt_pk_bf16_f32 v57, v58, v59
    v_cvt_pk_bf16_f32 v60, v60, v61
    v_cvt_pk_bf16_f32 v61, v62, v63
    v_mul_f32 v80, v96, v80
    v_mul_f32 v81, v96, v81
    v_mul_f32 v82, v96, v82
    v_mul_f32 v83, v96, v83
    v_mul_f32 v84, v97, v84
    v_mul_f32 v85, v97, v85
    v_mul_f32 v86, v97, v86
    v_mul_f32 v87, v97, v87
    v_cvt_pk_bf16_f32 v80, v80, v81
    v_cvt_pk_bf16_f32 v81, v82, v83
    v_cvt_pk_bf16_f32 v84, v84, v85
    v_cvt_pk_bf16_f32 v85, v86, v87
    v_cmp_eq_u32 vcc, 0, v15
    v_lshlrev_b32 v18, 2, v16
    v_bfrev_b32 v20, 1
    v_cndmask_b32 v20, v20, v18, vcc
    buffer_store_dwordx2 v[48:49], v17, s[24:27], s57 offen offset:0 sc1
    buffer_store_dword v80, v20, s[24:27], s57 offen offset:1024 sc1
    buffer_store_dwordx2 v[52:53], v17, s[24:27], s57 offen offset:256 sc1
    buffer_store_dword v84, v20, s[24:27], s57 offen offset:1088 sc1
    buffer_store_dwordx2 v[56:57], v17, s[24:27], s57 offen offset:1152 sc1
    buffer_store_dword v81, v20, s[24:27], s57 offen offset:2176 sc1
    buffer_store_dwordx2 v[60:61], v17, s[24:27], s57 offen offset:1408 sc1
    buffer_store_dword v85, v20, s[24:27], s57 offen offset:2240 sc1
    v_mul_f32 v64, v96, v64
    v_mul_f32 v65, v96, v65
    v_mul_f32 v66, v96, v66
    v_mul_f32 v67, v96, v67
    v_mul_f32 v68, v97, v68
    v_mul_f32 v69, v97, v69
    v_mul_f32 v70, v97, v70
    v_mul_f32 v71, v97, v71
    v_cvt_pk_bf16_f32 v64, v64, v65
    v_cvt_pk_bf16_f32 v65, v66, v67
    v_cvt_pk_bf16_f32 v68, v68, v69
    v_cvt_pk_bf16_f32 v69, v70, v71
    v_mul_f32 v72, v96, v72
    v_mul_f32 v73, v96, v73
    v_mul_f32 v74, v96, v74
    v_mul_f32 v75, v96, v75
    v_mul_f32 v76, v97, v76
    v_mul_f32 v77, v97, v77
    v_mul_f32 v78, v97, v78
    v_mul_f32 v79, v97, v79
    v_cvt_pk_bf16_f32 v72, v72, v73
    v_cvt_pk_bf16_f32 v73, v74, v75
    v_cvt_pk_bf16_f32 v76, v76, v77
    v_cvt_pk_bf16_f32 v77, v78, v79
    s_mul_i32 s58, s3, 2304
    s_add_u32 s58, s58, 150528
    v_add_u32 v17, s58, v17
    v_add_u32 v18, s58, v18
    ds_write_b64 v17, v[64:65] offset:0
    ds_write_b64 v17, v[68:69] offset:256
    ds_write_b64 v17, v[72:73] offset:1152
    ds_write_b64 v17, v[76:77] offset:1408
    s_mov_b32 exec_lo, 0xffff0000
    s_mov_b32 exec_hi, 0
    ds_write_b32 v18, v80 offset:1024
    ds_write_b32 v18, v84 offset:1088
    ds_write_b32 v18, v81 offset:2176
    ds_write_b32 v18, v85 offset:2240
    s_mov_b64 exec, -1
    s_branch gm_qkvb
gm_xa2:
    ds_read_b32 v14, v15
    s_sub_u32 s91, s91, 1
    s_cmp_lt_i32 s91, 0
    s_cbranch_scc1 gm_xa2x
    s_waitcnt lgkmcnt(0)
    v_cmp_gt_u32 vcc, 2, v14
    s_cbranch_vccnz gm_xa2
gm_xa2x:
    s_waitcnt lgkmcnt(0)
    s_branch gm_xa2b
gm_xa4:
    ds_read_b32 v14, v15
    s_sub_u32 s91, s91, 1
    s_cmp_lt_i32 s91, 0
    s_cbranch_scc1 gm_xa4x
    s_waitcnt lgkmcnt(0)
    v_cmp_gt_u32 vcc, 3, v14
    s_cbranch_vccnz gm_xa4
gm_xa4x:
    s_waitcnt lgkmcnt(0)
    s_branch gm_xa4b
gm_xa6:
    ds_read_b32 v14, v15
    s_sub_u32 s91, s91, 1
    s_cmp_lt_i32 s91, 0
    s_cbranch_scc1 gm_xa6x
    s_waitcnt lgkmcnt(0)
    v_cmp_gt_u32 vcc, 4, v14
    s_cbranch_vccnz gm_xa6
gm_xa6x:
    s_waitcnt lgkmcnt(0)
    s_branch gm_xa6b
gm_xa8:
    ds_read_b32 v14, v15
    s_sub_u32 s91, s91, 1
    s_cmp_lt_i32 s91, 0
    s_cbranch_scc1 gm_xa8x
    s_waitcnt lgkmcnt(0)
    v_cmp_gt_u32 vcc, 5, v14
    s_cbranch_vccnz gm_xa8
gm_xa8x:
    s_waitcnt lgkmcnt(0)
    s_branch gm_xa8b
gm_phr0:
    ds_read_b32 v14, v12
    s_sub_u32 s91, s91, 1
    s_cmp_lt_i32 s91, 0
    s_cbranch_scc1 gm_phr0x
    s_waitcnt lgkmcnt(0)
    v_cmp_gt_u32 vcc, s64, v14
    s_cbranch_vccnz gm_phr0
gm_phr0x:
    s_waitcnt lgkmcnt(0)
    s_branch gm_phr0b
gm_plr0:
    ds_read_b32 v14, v12
    s_sub_u32 s91, s91, 1
    s_cmp_lt_i32 s91, 0
    s_cbranch_scc1 gm_plr0x
    s_waitcnt lgkmcnt(0)
    v_cmp_gt_u32 vcc, s64, v14
    s_cbranch_vccnz gm_plr0
gm_plr0x:
    s_waitcnt lgkmcnt(0)
    s_branch gm_plr0b
gm_plr1:
    ds_read_b32 v14, v12
    s_sub_u32 s91, s91, 1
    s_cmp_lt_i32 s91, 0
    s_cbranch_scc1 gm_plr1x
    s_waitcnt lgkmcnt(0)
    v_cmp_gt_u32 vcc, s64, v14
    s_cbranch_vccnz gm_plr1
gm_plr1x:
    s_waitcnt lgkmcnt(0)
    s_branch gm_plr1b
gm_plr2:
    ds_read_b32 v14, v12
    s_sub_u32 s91, s91, 1
    s_cmp_lt_i32 s91, 0
    s_cbranch_scc1 gm_plr2x
    s_waitcnt lgkmcnt(0)
    v_cmp_gt_u32 vcc, s64, v14
    s_cbranch_vccnz gm_plr2
gm_plr2x:
    s_waitcnt lgkmcnt(0)
    s_branch gm_plr2b
gm_plr3:
    ds_read_b32 v14, v12
    s_sub_u32 s91, s91, 1
    s_cmp_lt_i32 s91, 0
    s_cbranch_scc1 gm_plr3x
    s_waitcnt lgkmcnt(0)
    v_cmp_gt_u32 vcc, s64, v14
    s_cbranch_vccnz gm_plr3
gm_plr3x:
    s_waitcnt lgkmcnt(0)
    s_branch gm_plr3b
gm_plr4:
    ds_read_b32 v14, v12
    s_sub_u32 s91, s91, 1
    s_cmp_lt_i32 s91, 0
    s_cbranch_scc1 gm_plr4x
    s_waitcnt lgkmcnt(0)
    v_cmp_gt_u32 vcc, s64, v14
    s_cbranch_vccnz gm_plr4
gm_plr4x:
    s_waitcnt lgkmcnt(0)
    s_branch gm_plr4b
gm_plr5:
    ds_read_b32 v14, v12
    s_sub_u32 s91, s91, 1
    s_cmp_lt_i32 s91, 0
    s_cbranch_scc1 gm_plr5x
    s_waitcnt lgkmcnt(0)
    v_cmp_gt_u32 vcc, s64, v14
    s_cbranch_vccnz gm_plr5
gm_plr5x:
    s_waitcnt lgkmcnt(0)
    s_branch gm_plr5b
gm_ptr2:
    ds_read_b32 v14, v12
    s_sub_u32 s91, s91, 1
    s_cmp_lt_i32 s91, 0
    s_cbranch_scc1 gm_ptr2x
    s_waitcnt lgkmcnt(0)
    v_cmp_gt_u32 vcc, s64, v14
    s_cbranch_vccnz gm_ptr2
gm_ptr2x:
    s_waitcnt lgkmcnt(0)
    s_branch gm_ptr2b
gm_ptr3:
    ds_read_b32 v14, v12
    s_sub_u32 s91, s91, 1
    s_cmp_lt_i32 s91, 0
    s_cbranch_scc1 gm_ptr3x
    s_waitcnt lgkmcnt(0)
    v_cmp_gt_u32 vcc, s64, v14
    s_cbranch_vccnz gm_ptr3
gm_ptr3x:
    s_waitcnt lgkmcnt(0)
    s_branch gm_ptr3b
gm_ptr4:
    ds_read_b32 v14, v12
    s_sub_u32 s91, s91, 1
    s_cmp_lt_i32 s91, 0
    s_cbranch_scc1 gm_ptr4x
    s_waitcnt lgkmcnt(0)
    v_cmp_gt_u32 vcc, s64, v14
    s_cbranch_vccnz gm_ptr4
gm_ptr4x:
    s_waitcnt lgkmcnt(0)
    s_branch gm_ptr4b
gm_ptr5:
    ds_read_b32 v14, v12
    s_sub_u32 s91, s91, 1
    s_cmp_lt_i32 s91, 0
    s_cbranch_scc1 gm_ptr5x
    s_waitcnt lgkmcnt(0)
    v_cmp_gt_u32 vcc, s64, v14
    s_cbranch_vccnz gm_ptr5
gm_ptr5x:
    s_waitcnt lgkmcnt(0)
    s_branch gm_ptr5b
gm_g2r0:
    ds_read_b32 v4, v12
    s_sub_u32 s91, s91, 1
    s_cmp_lt_i32 s91, 0
    s_cbranch_scc1 gm_g2r0x
    s_waitcnt lgkmcnt(0)
    v_cmp_gt_u32 vcc, s64, v4
    s_cbranch_vccnz gm_g2r0
gm_g2r0x:
    s_waitcnt lgkmcnt(0)
    s_branch gm_g2r0b
gm_g2r1:
    ds_read_b32 v4, v12
    s_sub_u32 s91, s91, 1
    s_cmp_lt_i32 s91, 0
    s_cbranch_scc1 gm_g2r1x
    s_waitcnt lgkmcnt(0)
    v_cmp_gt_u32 vcc, s64, v4
    s_cbranch_vccnz gm_g2r1
gm_g2r1x:
    s_waitcnt lgkmcnt(0)
    s_branch gm_g2r1b
gm_g2r2:
    ds_read_b32 v4, v12
    s_sub_u32 s91, s91, 1
    s_cmp_lt_i32 s91, 0
    s_cbranch_scc1 gm_g2r2x
    s_waitcnt lgkmcnt(0)
    v_cmp_gt_u32 vcc, s64, v4
    s_cbranch_vccnz gm_g2r2
gm_g2r2x:
    s_waitcnt lgkmcnt(0)
    s_branch gm_g2r2b
gm_g2r3:
    ds_read_b32 v4, v12
    s_sub_u32 s91, s91, 1
    s_cmp_lt_i32 s91, 0
    s_cbranch_scc1 gm_g2r3x
    s_waitcnt lgkmcnt(0)
    v_cmp_gt_u32 vcc, s64, v4
    s_cbranch_vccnz gm_g2r3
gm_g2r3x:
    s_waitcnt lgkmcnt(0)
    s_branch gm_g2r3b
gm_g2r4:
    ds_read_b32 v4, v12
    s_sub_u32 s91, s91, 1
    s_cmp_lt_i32 s91, 0
    s_cbranch_scc1 gm_g2r4x
    s_waitcnt lgkmcnt(0)
    v_cmp_gt_u32 vcc, s64, v4
    s_cbranch_vccnz gm_g2r4
gm_g2r4x:
    s_waitcnt lgkmcnt(0)
    s_branch gm_g2r4b
gm_g2r5:
    ds_read_b32 v4, v12
    s_sub_u32 s91, s91, 1
    s_cmp_lt_i32 s91, 0
    s_cbranch_scc1 gm_g2r5x
    s_waitcnt lgkmcnt(0)
    v_cmp_gt_u32 vcc, s64, v4
    s_cbranch_vccnz gm_g2r5
gm_g2r5x:
    s_waitcnt lgkmcnt(0)
    s_branch gm_g2r5b
gm_g2r2t:
    ds_read_b32 v4, v12
    s_sub_u32 s91, s91, 1
    s_cmp_lt_i32 s91, 0
    s_cbranch_scc1 gm_g2r2tx
    s_waitcnt lgkmcnt(0)
    v_cmp_gt_u32 vcc, s64, v4
    s_cbranch_vccnz gm_g2r2t
gm_g2r2tx:
    s_waitcnt lgkmcnt(0)
    s_branch gm_g2r2tb
gm_g2r3t:
    ds_read_b32 v4, v12
    s_sub_u32 s91, s91, 1
    s_cmp_lt_i32 s91, 0
    s_cbranch_scc1 gm_g2r3tx
    s_waitcnt lgkmcnt(0)
    v_cmp_gt_u32 vcc, s64, v4
    s_cbranch_vccnz gm_g2r3t
gm_g2r3tx:
    s_waitcnt lgkmcnt(0)
    s_branch gm_g2r3tb
gm_g2r4t:
    ds_read_b32 v4, v12
    s_sub_u32 s91, s91, 1
    s_cmp_lt_i32 s91, 0
    s_cbranch_scc1 gm_g2r4tx
    s_waitcnt lgkmcnt(0)
    v_cmp_gt_u32 vcc, s64, v4
    s_cbranch_vccnz gm_g2r4t
gm_g2r4tx:
    s_waitcnt lgkmcnt(0)
    s_branch gm_g2r4tb
gm_qr0:
    ds_read_b32 v14, v12
    s_sub_u32 s91, s91, 1
    s_cmp_lt_i32 s91, 0
    s_cbranch_scc1 gm_qr0x
    s_waitcnt lgkmcnt(0)
    v_cmp_gt_u32 vcc, s64, v14
    s_cbranch_vccnz gm_qr0
gm_qr0x:
    s_waitcnt lgkmcnt(0)
    s_branch gm_qr0b
gm_qr1:
    ds_read_b32 v14, v12
    s_sub_u32 s91, s91, 1
    s_cmp_lt_i32 s91, 0
    s_cbranch_scc1 gm_qr1x
    s_waitcnt lgkmcnt(0)
    v_cmp_gt_u32 vcc, s64, v14
    s_cbranch_vccnz gm_qr1
gm_qr1x:
    s_waitcnt lgkmcnt(0)
    s_branch gm_qr1b
gm_qr2:
    ds_read_b32 v14, v12
    s_sub_u32 s91, s91, 1
    s_cmp_lt_i32 s91, 0
    s_cbranch_scc1 gm_qr2x
    s_waitcnt lgkmcnt(0)
    v_cmp_gt_u32 vcc, s64, v14
    s_cbranch_vccnz gm_qr2
gm_qr2x:
    s_waitcnt lgkmcnt(0)
    s_branch gm_qr2b
gm_qr3:
    ds_read_b32 v14, v12
    s_sub_u32 s91, s91, 1
    s_cmp_lt_i32 s91, 0
    s_cbranch_scc1 gm_qr3x
    s_waitcnt lgkmcnt(0)
    v_cmp_gt_u32 vcc, s64, v14
    s_cbranch_vccnz gm_qr3
gm_qr3x:
    s_waitcnt lgkmcnt(0)
    s_branch gm_qr3b
gm_qr4:
    ds_read_b32 v14, v12
    s_sub_u32 s91, s91, 1
    s_cmp_lt_i32 s91, 0
    s_cbranch_scc1 gm_qr4x
    s_waitcnt lgkmcnt(0)
    v_cmp_gt_u32 vcc, s64, v14
    s_cbranch_vccnz gm_qr4
gm_qr4x:
    s_waitcnt lgkmcnt(0)
    s_branch gm_qr4b
gm_ini2:
    buffer_load_dword v19, off, s[28:31], 0 sc1
    s_sub_u32 s91, s91, 16
    s_cmp_lt_i32 s91, 0
    s_cbranch_scc1 gm_ini2x
    s_waitcnt vmcnt(0)
    v_cmp_eq_u32 vcc, 0, v19
    s_cbranch_vccz gm_ini2x
    s_sleep 2
    s_branch gm_ini2
gm_ini2x:
    s_branch gm_ini2b
gm_h9:
    buffer_load_dword v176, v10, s[24:27], s63 offen sc1
    s_sub_u32 s91, s91, 16
    s_cmp_lt_i32 s91, 0
    s_cbranch_scc1 gm_h9x
    s_waitcnt vmcnt(0)
    v_cmp_gt_i32 vcc, 9, v176
    s_cbranch_vccz gm_h9x
    s_sleep 8
    s_branch gm_h9
gm_h9x:
    s_branch gm_h9b
gm_done:
    s_endpgm
xl_init:
    v_mul_u32_u24 v32, 4352, v1
    v_mov_b32 v28, 0
    v_mov_b32 v29, 0
    v_mov_b32 v30, 0
    v_mov_b32 v31, 0
    s_mov_b32 s57, 33037312
    buffer_store_dwordx4 v[28:31], v2, s[24:27], s57 offen offset:0 sc1
    buffer_store_dwordx4 v[28:31], v2, s[24:27], s57 offen offset:1024 sc1
    buffer_store_dwordx4 v[28:31], v2, s[24:27], s57 offen offset:2048 sc1
    buffer_store_dwordx4 v[28:31], v2, s[24:27], s57 offen offset:3072 sc1
    s_add_u32 s57, s57, 4096
    buffer_store_dwordx4 v[28:31], v2, s[24:27], s57 offen offset:0 sc1
    buffer_store_dwordx4 v[28:31], v2, s[24:27], s57 offen offset:1024 sc1
    buffer_store_dwordx4 v[28:31], v2, s[24:27], s57 offen offset:2048 sc1
    buffer_store_dwordx4 v[28:31], v2, s[24:27], s57 offen offset:3072 sc1
    s_add_u32 s57, s57, 4096
    buffer_store_dwordx4 v[28:31], v2, s[24:27], s57 offen offset:0 sc1
    buffer_store_dwordx4 v[28:31], v2, s[24:27], s57 offen offset:1024 sc1
    buffer_store_dwordx4 v[28:31], v2, s[24:27], s57 offen offset:2048 sc1
    buffer_store_dwordx4 v[28:31], v2, s[24:27], s57 offen offset:3072 sc1
    s_add_u32 s57, s57, 4096
    buffer_store_dwordx4 v[28:31], v2, s[24:27], s57 offen offset:0 sc1
    buffer_store_dwordx4 v[28:31], v2, s[24:27], s57 offen offset:1024 sc1
    buffer_store_dwordx4 v[28:31], v2, s[24:27], s57 offen offset:2048 sc1
    buffer_store_dwordx4 v[28:31], v2, s[24:27], s57 offen offset:3072 sc1
    s_add_u32 s57, s57, 4096
    buffer_store_dwordx4 v[28:31], v2, s[24:27], s57 offen offset:0 sc1
    buffer_store_dwordx4 v[28:31], v2, s[24:27], s57 offen offset:1024 sc1
    buffer_store_dwordx4 v[28:31], v2, s[24:27], s57 offen offset:2048 sc1
    buffer_store_dwordx4 v[28:31], v2, s[24:27], s57 offen offset:3072 sc1
    s_add_u32 s57, s57, 4096
    buffer_store_dword v28, v32, s[24:27], s57 offen sc1
    s_branch xl_initb
recurrent_scan__grouped_kv_mqa__glu_gated_swiglu__prompt_kernel_attn:
    s_sub_u32 s60, s3, 4
    s_lshr_b32 s61, s60, 1
    s_and_b32 s74, s5, 1
    v_lshlrev_b32 v2, 4, v1
    s_lshl_b32 s58, s3, 8
    s_add_u32 s58, s58, 147456
    v_lshl_add_u32 v23, v1, 2, s58
    v_mov_b32 v24, 1
    v_lshrrev_b32 v6, 3, v1
    s_and_b32 s58, s60, 1
    s_lshl_b32 s58, s58, 3
    v_add_u32 v6, s58, v6
    v_bfe_u32 v8, v1, 4, 1
    s_lshr_b32 s58, s58, 2
    v_or_b32 v8, s58, v8
    v_bfe_u32 v9, v1, 1, 2
    v_xor_b32 v8, v8, v9
    v_and_b32 v7, 1, v1
    v_mul_u32_u24 v20, 9216, v6
    v_lshl_add_u32 v20, v8, 5, v20
    v_lshl_add_u32 v20, v7, 4, v20
    s_mul_i32 s58, s5, 576
    s_lshl_b32 s59, s74, 6
    s_add_u32 s58, s58, s59
    v_add_u32 v20, s58, v20
    v_lshl_add_u32 v8, v8, 1, v7
    s_lshr_b32 s56, s5, 1
    s_mul_i32 s58, s56, 144
    s_lshl_b32 s59, s61, 7
    s_add_u32 s59, s59, s58
    v_mul_u32_u24 v21, 1152, v6
    v_lshl_add_u32 v21, v8, 4, v21
    v_add_u32 v21, s59, v21
    s_and_b32 s59, s56, 2
    s_lshl_b32 s59, s59, 1
    s_cmp_ge_u32 s56, 4
    s_cselect_b32 s59, 0x40000000, s59
    v_mul_u32_u24 v22, 36, v6
    v_lshl_add_u32 v22, v7, 4, v22
    v_add_u32 v22, s59, v22
    s_cmp_eq_u32 s61, 0
    s_cselect_b32 s58, 4, 1
    s_cselect_b32 s59, 2, 1
    s_cselect_b64 vcc, -1, 0
    v_cmp_gt_u32 s[70:71], s58, v8
    v_lshrrev_b32 v8, s59, v8
    v_cmp_eq_u32 s[72:73], 1, v8
    v_cndmask_b32 v22, v22, v21, vcc
    v_lshlrev_b32 v6, 2, v1
    v_and_b32 v7, 3, v1
    v_lshl_add_u32 v14, v7, 8, v6
    v_add_u32 v14, 147456, v14
    s_waitcnt vmcnt(16)
    ds_add_u32 v23, v24 offset:3072
    s_mov_b32 s12, s34
    s_mov_b32 s13, s35
    s_mov_b32 s14, 663552
    s_mov_b32 s15, 0x00020000
    s_and_b32 s58, s56, 1
    s_cmp_eq_u32 s58, 0
    s_cselect_b32 s16, s36, s38
    s_cselect_b32 s17, s37, s39
    s_cmp_eq_u32 s61, 0
    s_cselect_b32 s16, s34, s16
    s_cselect_b32 s17, s35, s17
    s_mov_b32 s18, 20736
    s_cselect_b32 s18, 663552, s18
    s_mov_b32 s19, 0x00020000
    s_cselect_b32 s20, s44, s46
    s_cselect_b32 s21, s45, s47
    s_mov_b32 s22, 5308416
    s_mov_b32 s23, 0x00020000
    s_movk_i32 s69, 576
    s_cselect_b32 s69, 18432, s69
    s_mov_b32 s8, s48
    s_mov_b32 s9, s49
    s_mov_b32 s10, 5308416
    s_mov_b32 s11, 0x00020000
    s_mov_b32 s44, s40
    s_mov_b32 s45, s41
    s_mov_b32 s46, 663552
    s_mov_b32 s47, 0x00020000
    s_waitcnt vmcnt(12)
    ds_add_u32 v23, v24 offset:3072
    s_waitcnt vmcnt(8)
    ds_add_u32 v23, v24 offset:3072
    s_waitcnt vmcnt(4)
    ds_add_u32 v23, v24 offset:3072
    s_waitcnt vmcnt(0)
    ds_add_u32 v23, v24 offset:3072
    s_lshl_b32 s57, s2, 3
    s_add_u32 s57, s57, s3
    s_cmp_eq_u32 s57, 6
    s_cbranch_scc1 xl_init
xl_initb:
    v_add_u32 v7, 2048, v23
    s_cmp_eq_u32 s74, 1
    s_cbranch_scc1 at_odd
at_eh3:
    s_sleep 1
    ds_read_b32 v8, v7
    s_sub_u32 s91, s91, 1
    s_cmp_lt_i32 s91, 0
    s_cbranch_scc1 at_eh3x
    s_waitcnt lgkmcnt(0)
    v_cmp_gt_u32 vcc, 3, v8
    s_cbranch_vccnz at_eh3
at_eh3x:
    s_waitcnt lgkmcnt(0)
    s_lshl_b32 s76, s60, 12
    s_add_u32 s76, s76, 0
    s_add_u32 s77, s79, 0
    s_cmp_ge_u32 s77, 9
    s_cselect_b32 s78, 9, 0
    s_sub_u32 s77, s77, s78
at_eb:
    s_mov_b32 m0, s76
    s_add_u32 s76, s76, 16384
    s_mul_i32 s78, s77, 589824
    buffer_load_dwordx4 v20, s[20:23], s78 offen offset:0 lds
    s_add_u32 s78, s78, 146432
    buffer_load_dwordx4 v20, s[20:23], s78 offen offset:1024 lds
    s_add_u32 s78, s78, 146432
    buffer_load_dwordx4 v20, s[20:23], s78 offen offset:2048 lds
    s_add_u32 s78, s78, 146432
    buffer_load_dwordx4 v20, s[20:23], s78 offen offset:3072 lds
    s_add_u32 s77, s77, 1
    s_cmp_eq_u32 s77, 9
    s_cselect_b32 s77, 0, s77
    s_cmp_lt_u32 s76, 49152
    s_cbranch_scc1 at_eb
    s_mov_b64 exec, -1
at_eh5:
    s_sleep 1
    ds_read_b32 v8, v7
    s_sub_u32 s91, s91, 1
    s_cmp_lt_i32 s91, 0
    s_cbranch_scc1 at_eh5x
    s_waitcnt lgkmcnt(0)
    v_cmp_gt_u32 vcc, 5, v8
    s_cbranch_vccnz at_eh5
at_eh5x:
    s_waitcnt lgkmcnt(0)
    s_lshl_b32 s76, s60, 12
    s_add_u32 s76, s76, 49152
    s_add_u32 s77, s79, 3
    s_cmp_ge_u32 s77, 9
    s_cselect_b32 s78, 9, 0
    s_sub_u32 s77, s77, s78
at_ec:
    s_mov_b32 m0, s76
    s_add_u32 s76, s76, 16384
    s_mul_i32 s78, s77, 589824
    buffer_load_dwordx4 v20, s[20:23], s78 offen offset:0 lds
    s_add_u32 s78, s78, 146432
    buffer_load_dwordx4 v20, s[20:23], s78 offen offset:1024 lds
    s_add_u32 s78, s78, 146432
    buffer_load_dwordx4 v20, s[20:23], s78 offen offset:2048 lds
    s_add_u32 s78, s78, 146432
    buffer_load_dwordx4 v20, s[20:23], s78 offen offset:3072 lds
    s_add_u32 s77, s77, 1
    s_cmp_eq_u32 s77, 9
    s_cselect_b32 s77, 0, s77
    s_cmp_lt_u32 s76, 81920
    s_cbranch_scc1 at_ec
    s_mov_b64 exec, -1
    v_mov_b32 v6, 1
    s_waitcnt vmcnt(10)
    ds_write_b32 v23, v6
    s_lshl_b32 s57, s2, 3
    s_add_u32 s57, s57, s3
    s_cmp_lg_u32 s57, 6
    s_cbranch_scc1 at_noinit
    v_mov_b32 v25, 0
    s_mov_b64 exec, 1
    buffer_store_dword v24, v25, s[28:31], 0 offen sc1
    s_mov_b64 exec, -1
at_noinit:
    v_mov_b32 v6, 3
    s_waitcnt vmcnt(2)
    ds_write_b32 v23, v6
    v_mov_b32 v6, 2147483647
    s_waitcnt vmcnt(0)
    ds_write_b32 v23, v6
    s_branch at_ld
at_odd:
    s_cmp_eq_u32 s61, 1
    s_cbranch_scc1 at_odd1
at_o0h3:
    s_sleep 1
    ds_read_b32 v8, v7
    s_sub_u32 s91, s91, 1
    s_cmp_lt_i32 s91, 0
    s_cbranch_scc1 at_o0h3x
    s_waitcnt lgkmcnt(0)
    v_cmp_gt_u32 vcc, 3, v8
    s_cbranch_vccnz at_o0h3
at_o0h3x:
    s_waitcnt lgkmcnt(0)
    s_lshl_b32 s76, s60, 12
    s_add_u32 s76, s76, 0
    s_add_u32 s77, s79, 0
    s_cmp_ge_u32 s77, 9
    s_cselect_b32 s78, 9, 0
    s_sub_u32 s77, s77, s78
at_o0b:
    s_mov_b32 m0, s76
    s_add_u32 s76, s76, 16384
    s_mul_i32 s78, s77, 73728
    buffer_load_dwordx4 v21, s[12:15], s78 offen offset:0 lds
    s_add_u32 s78, s78, 17408
    buffer_load_dwordx4 v21, s[12:15], s78 offen offset:1024 lds
    s_add_u32 s78, s78, 17408
    buffer_load_dwordx4 v21, s[12:15], s78 offen offset:2048 lds
    s_add_u32 s78, s78, 17408
    buffer_load_dwordx4 v21, s[12:15], s78 offen offset:3072 lds
    s_add_u32 s77, s77, 1
    s_cmp_eq_u32 s77, 9
    s_cselect_b32 s77, 0, s77
    s_cmp_lt_u32 s76, 49152
    s_cbranch_scc1 at_o0b
    s_mov_b64 exec, -1
at_o0h5:
    s_sleep 1
    ds_read_b32 v8, v7
    s_sub_u32 s91, s91, 1
    s_cmp_lt_i32 s91, 0
    s_cbranch_scc1 at_o0h5x
    s_waitcnt lgkmcnt(0)
    v_cmp_gt_u32 vcc, 5, v8
    s_cbranch_vccnz at_o0h5
at_o0h5x:
    s_waitcnt lgkmcnt(0)
    s_lshl_b32 s76, s60, 12
    s_add_u32 s76, s76, 49152
    s_add_u32 s77, s79, 3
    s_cmp_ge_u32 s77, 9
    s_cselect_b32 s78, 9, 0
    s_sub_u32 s77, s77, s78
at_o0c:
    s_mov_b32 m0, s76
    s_add_u32 s76, s76, 16384
    s_mul_i32 s78, s77, 73728
    buffer_load_dwordx4 v21, s[12:15], s78 offen offset:0 lds
    s_add_u32 s78, s78, 17408
    buffer_load_dwordx4 v21, s[12:15], s78 offen offset:1024 lds
    s_add_u32 s78, s78, 17408
    buffer_load_dwordx4 v21, s[12:15], s78 offen offset:2048 lds
    s_add_u32 s78, s78, 17408
    buffer_load_dwordx4 v21, s[12:15], s78 offen offset:3072 lds
    s_add_u32 s77, s77, 1
    s_cmp_eq_u32 s77, 9
    s_cselect_b32 s77, 0, s77
    s_cmp_lt_u32 s76, 81920
    s_cbranch_scc1 at_o0c
    s_mov_b64 exec, -1
    v_mov_b32 v6, 1
    s_waitcnt vmcnt(14)
    ds_write_b32 v23, v6
at_o0h9:
    s_sleep 1
    ds_read_b32 v8, v7
    s_sub_u32 s91, s91, 1
    s_cmp_lt_i32 s91, 0
    s_cbranch_scc1 at_o0h9x
    s_waitcnt lgkmcnt(0)
    v_cmp_gt_u32 vcc, 9, v8
    s_cbranch_vccnz at_o0h9
at_o0h9x:
    s_waitcnt lgkmcnt(0)
    s_lshl_b32 s76, s60, 12
    s_add_u32 s76, s76, 81920
    s_add_u32 s77, s79, 5
    s_cmp_ge_u32 s77, 9
    s_cselect_b32 s78, 9, 0
    s_sub_u32 s77, s77, s78
at_o0d:
    s_mov_b32 m0, s76
    s_add_u32 s76, s76, 16384
    s_mul_i32 s78, s77, 73728
    buffer_load_dwordx4 v21, s[12:15], s78 offen offset:0 lds
    s_add_u32 s78, s78, 17408
    buffer_load_dwordx4 v21, s[12:15], s78 offen offset:1024 lds
    s_add_u32 s78, s78, 17408
    buffer_load_dwordx4 v21, s[12:15], s78 offen offset:2048 lds
    s_add_u32 s78, s78, 17408
    buffer_load_dwordx4 v21, s[12:15], s78 offen offset:3072 lds
    s_add_u32 s77, s77, 1
    s_cmp_eq_u32 s77, 9
    s_cselect_b32 s77, 0, s77
    s_cmp_lt_u32 s76, 114688
    s_cbranch_scc1 at_o0d
    s_mov_b64 exec, -1
    v_mov_b32 v6, 2
    s_waitcnt vmcnt(16)
    ds_write_b32 v23, v6
    s_lshl_b32 s76, s60, 12
    s_add_u32 s76, s76, 114688
    s_add_u32 s77, s79, 7
    s_cmp_ge_u32 s77, 9
    s_cselect_b32 s78, 9, 0
    s_sub_u32 s77, s77, s78
at_o0e:
    s_mov_b32 m0, s76
    s_add_u32 s76, s76, 16384
    s_mul_i32 s78, s77, 73728
    buffer_load_dwordx4 v21, s[12:15], s78 offen offset:0 lds
    s_add_u32 s78, s78, 17408
    buffer_load_dwordx4 v21, s[12:15], s78 offen offset:1024 lds
    s_add_u32 s78, s78, 17408
    buffer_load_dwordx4 v21, s[12:15], s78 offen offset:2048 lds
    s_add_u32 s78, s78, 17408
    buffer_load_dwordx4 v21, s[12:15], s78 offen offset:3072 lds
    s_add_u32 s77, s77, 1
    s_cmp_eq_u32 s77, 9
    s_cselect_b32 s77, 0, s77
    s_cmp_lt_u32 s76, 147456
    s_cbranch_scc1 at_o0e
    s_mov_b64 exec, -1
    v_mov_b32 v6, 3
    s_waitcnt vmcnt(18)
    ds_write_b32 v23, v6
    v_mov_b32 v6, 4
    s_waitcnt vmcnt(12)
    ds_write_b32 v23, v6
    v_mov_b32 v6, 5
    s_waitcnt vmcnt(6)
    ds_write_b32 v23, v6
    v_mov_b32 v6, 6
    s_waitcnt vmcnt(0)
    ds_write_b32 v23, v6
    s_branch at_oddr
at_odd1:
at_o1h3:
    s_sleep 1
    ds_read_b32 v8, v7
    s_sub_u32 s91, s91, 1
    s_cmp_lt_i32 s91, 0
    s_cbranch_scc1 at_o1h3x
    s_waitcnt lgkmcnt(0)
    v_cmp_gt_u32 vcc, 3, v8
    s_cbranch_vccnz at_o1h3
at_o1h3x:
    s_waitcnt lgkmcnt(0)
    s_lshl_b32 s76, s60, 12
    s_add_u32 s76, s76, 0
    s_add_u32 s77, s79, 0
    s_cmp_ge_u32 s77, 9
    s_cselect_b32 s78, 9, 0
    s_sub_u32 s77, s77, s78
at_o1b:
    s_mov_b32 m0, s76
    s_add_u32 s76, s76, 16384
    s_mov_b64 exec, s[70:71]
    s_mul_i32 s78, s77, 73728
    buffer_load_dwordx4 v21, s[12:15], s78 offen offset:0 lds
    s_add_u32 s78, s78, 17408
    buffer_load_dwordx4 v21, s[12:15], s78 offen offset:1024 lds
    s_add_u32 s78, s78, 17408
    buffer_load_dwordx4 v21, s[12:15], s78 offen offset:2048 lds
    s_add_u32 s78, s78, 17408
    buffer_load_dwordx4 v21, s[12:15], s78 offen offset:3072 lds
    s_mov_b64 exec, s[72:73]
    s_mul_i32 s78, s77, 2304
    buffer_load_dwordx4 v22, s[16:19], s78 offen offset:0 lds
    s_add_u32 m0, m0, 448
    s_nop 0
    buffer_load_dwordx4 v22, s[16:19], s78 offen offset:576 lds
    s_add_u32 m0, m0, 448
    s_nop 0
    buffer_load_dwordx4 v22, s[16:19], s78 offen offset:1152 lds
    s_add_u32 m0, m0, 448
    s_nop 0
    buffer_load_dwordx4 v22, s[16:19], s78 offen offset:1728 lds
    s_add_u32 s77, s77, 1
    s_cmp_eq_u32 s77, 9
    s_cselect_b32 s77, 0, s77
    s_cmp_lt_u32 s76, 49152
    s_cbranch_scc1 at_o1b
    s_mov_b64 exec, -1
at_o1h5:
    s_sleep 1
    ds_read_b32 v8, v7
    s_sub_u32 s91, s91, 1
    s_cmp_lt_i32 s91, 0
    s_cbranch_scc1 at_o1h5x
    s_waitcnt lgkmcnt(0)
    v_cmp_gt_u32 vcc, 5, v8
    s_cbranch_vccnz at_o1h5
at_o1h5x:
    s_waitcnt lgkmcnt(0)
    s_lshl_b32 s76, s60, 12
    s_add_u32 s76, s76, 49152
    s_add_u32 s77, s79, 3
    s_cmp_ge_u32 s77, 9
    s_cselect_b32 s78, 9, 0
    s_sub_u32 s77, s77, s78
at_o1c:
    s_mov_b32 m0, s76
    s_add_u32 s76, s76, 16384
    s_mov_b64 exec, s[70:71]
    s_mul_i32 s78, s77, 73728
    buffer_load_dwordx4 v21, s[12:15], s78 offen offset:0 lds
    s_add_u32 s78, s78, 17408
    buffer_load_dwordx4 v21, s[12:15], s78 offen offset:1024 lds
    s_add_u32 s78, s78, 17408
    buffer_load_dwordx4 v21, s[12:15], s78 offen offset:2048 lds
    s_add_u32 s78, s78, 17408
    buffer_load_dwordx4 v21, s[12:15], s78 offen offset:3072 lds
    s_mov_b64 exec, s[72:73]
    s_mul_i32 s78, s77, 2304
    buffer_load_dwordx4 v22, s[16:19], s78 offen offset:0 lds
    s_add_u32 m0, m0, 448
    s_nop 0
    buffer_load_dwordx4 v22, s[16:19], s78 offen offset:576 lds
    s_add_u32 m0, m0, 448
    s_nop 0
    buffer_load_dwordx4 v22, s[16:19], s78 offen offset:1152 lds
    s_add_u32 m0, m0, 448
    s_nop 0
    buffer_load_dwordx4 v22, s[16:19], s78 offen offset:1728 lds
    s_add_u32 s77, s77, 1
    s_cmp_eq_u32 s77, 9
    s_cselect_b32 s77, 0, s77
    s_cmp_lt_u32 s76, 81920
    s_cbranch_scc1 at_o1c
    s_mov_b64 exec, -1
    v_mov_b32 v6, 1
    s_waitcnt vmcnt(26)
    ds_write_b32 v23, v6
at_o1h9:
    s_sleep 1
    ds_read_b32 v8, v7
    s_sub_u32 s91, s91, 1
    s_cmp_lt_i32 s91, 0
    s_cbranch_scc1 at_o1h9x
    s_waitcnt lgkmcnt(0)
    v_cmp_gt_u32 vcc, 9, v8
    s_cbranch_vccnz at_o1h9
at_o1h9x:
    s_waitcnt lgkmcnt(0)
    s_lshl_b32 s76, s60, 12
    s_add_u32 s76, s76, 81920
    s_add_u32 s77, s79, 5
    s_cmp_ge_u32 s77, 9
    s_cselect_b32 s78, 9, 0
    s_sub_u32 s77, s77, s78
at_o1d:
    s_mov_b32 m0, s76
    s_add_u32 s76, s76, 16384
    s_mov_b64 exec, s[70:71]
    s_mul_i32 s78, s77, 73728
    buffer_load_dwordx4 v21, s[12:15], s78 offen offset:0 lds
    s_add_u32 s78, s78, 17408
    buffer_load_dwordx4 v21, s[12:15], s78 offen offset:1024 lds
    s_add_u32 s78, s78, 17408
    buffer_load_dwordx4 v21, s[12:15], s78 offen offset:2048 lds
    s_add_u32 s78, s78, 17408
    buffer_load_dwordx4 v21, s[12:15], s78 offen offset:3072 lds
    s_mov_b64 exec, s[72:73]
    s_mul_i32 s78, s77, 2304
    buffer_load_dwordx4 v22, s[16:19], s78 offen offset:0 lds
    s_add_u32 m0, m0, 448
    s_nop 0
    buffer_load_dwordx4 v22, s[16:19], s78 offen offset:576 lds
    s_add_u32 m0, m0, 448
    s_nop 0
    buffer_load_dwordx4 v22, s[16:19], s78 offen offset:1152 lds
    s_add_u32 m0, m0, 448
    s_nop 0
    buffer_load_dwordx4 v22, s[16:19], s78 offen offset:1728 lds
    s_add_u32 s77, s77, 1
    s_cmp_eq_u32 s77, 9
    s_cselect_b32 s77, 0, s77
    s_cmp_lt_u32 s76, 114688
    s_cbranch_scc1 at_o1d
    s_mov_b64 exec, -1
    v_mov_b32 v6, 2
    s_waitcnt vmcnt(32)
    ds_write_b32 v23, v6
    s_lshl_b32 s76, s60, 12
    s_add_u32 s76, s76, 114688
    s_add_u32 s77, s79, 7
    s_cmp_ge_u32 s77, 9
    s_cselect_b32 s78, 9, 0
    s_sub_u32 s77, s77, s78
at_o1e:
    s_mov_b32 m0, s76
    s_add_u32 s76, s76, 16384
    s_mov_b64 exec, s[70:71]
    s_mul_i32 s78, s77, 73728
    buffer_load_dwordx4 v21, s[12:15], s78 offen offset:0 lds
    s_add_u32 s78, s78, 17408
    buffer_load_dwordx4 v21, s[12:15], s78 offen offset:1024 lds
    s_add_u32 s78, s78, 17408
    buffer_load_dwordx4 v21, s[12:15], s78 offen offset:2048 lds
    s_add_u32 s78, s78, 17408
    buffer_load_dwordx4 v21, s[12:15], s78 offen offset:3072 lds
    s_mov_b64 exec, s[72:73]
    s_mul_i32 s78, s77, 2304
    buffer_load_dwordx4 v22, s[16:19], s78 offen offset:0 lds
    s_add_u32 m0, m0, 448
    s_nop 0
    buffer_load_dwordx4 v22, s[16:19], s78 offen offset:576 lds
    s_add_u32 m0, m0, 448
    s_nop 0
    buffer_load_dwordx4 v22, s[16:19], s78 offen offset:1152 lds
    s_add_u32 m0, m0, 448
    s_nop 0
    buffer_load_dwordx4 v22, s[16:19], s78 offen offset:1728 lds
    s_add_u32 s77, s77, 1
    s_cmp_eq_u32 s77, 9
    s_cselect_b32 s77, 0, s77
    s_cmp_lt_u32 s76, 147456
    s_cbranch_scc1 at_o1e
    s_mov_b64 exec, -1
    v_mov_b32 v6, 3
    s_waitcnt vmcnt(34)
    ds_write_b32 v23, v6
    v_mov_b32 v6, 4
    s_waitcnt vmcnt(24)
    ds_write_b32 v23, v6
    v_mov_b32 v6, 5
    s_waitcnt vmcnt(10)
    ds_write_b32 v23, v6
    v_mov_b32 v6, 6
    s_waitcnt vmcnt(0)
    ds_write_b32 v23, v6
at_oddr:
at_g4:
    s_sleep 2
    ds_read_b32 v8, v14
    s_sub_u32 s91, s91, 1
    s_cmp_lt_i32 s91, 0
    s_cbranch_scc1 at_g4x
    s_waitcnt lgkmcnt(0)
    v_cmp_gt_u32 vcc, 4, v8
    s_cbranch_vccnz at_g4
at_g4x:
    s_waitcnt lgkmcnt(0)
    s_lshl_b32 s76, s60, 12
    s_add_u32 s76, s76, 0
    s_add_u32 s77, s79, 0
    s_cmp_ge_u32 s77, 9
    s_cselect_b32 s78, 9, 0
    s_sub_u32 s77, s77, s78
at_z4:
    s_mov_b32 m0, s76
    s_add_u32 s76, s76, 16384
    s_mul_i32 s78, s77, 589824
    buffer_load_dwordx4 v20, s[20:23], s78 offen offset:0 lds
    s_add_u32 s78, s78, 146432
    buffer_load_dwordx4 v20, s[20:23], s78 offen offset:1024 lds
    s_add_u32 s78, s78, 146432
    buffer_load_dwordx4 v20, s[20:23], s78 offen offset:2048 lds
    s_add_u32 s78, s78, 146432
    buffer_load_dwordx4 v20, s[20:23], s78 offen offset:3072 lds
    s_add_u32 s77, s77, 1
    s_cmp_eq_u32 s77, 9
    s_cselect_b32 s77, 0, s77
    s_cmp_lt_u32 s76, 49152
    s_cbranch_scc1 at_z4
    s_mov_b64 exec, -1
at_g5:
    s_sleep 2
    ds_read_b32 v8, v14
    s_sub_u32 s91, s91, 1
    s_cmp_lt_i32 s91, 0
    s_cbranch_scc1 at_g5x
    s_waitcnt lgkmcnt(0)
    v_cmp_gt_u32 vcc, 5, v8
    s_cbranch_vccnz at_g5
at_g5x:
    s_waitcnt lgkmcnt(0)
    s_lshl_b32 s76, s60, 12
    s_add_u32 s76, s76, 49152
    s_add_u32 s77, s79, 3
    s_cmp_ge_u32 s77, 9
    s_cselect_b32 s78, 9, 0
    s_sub_u32 s77, s77, s78
at_z5:
    s_mov_b32 m0, s76
    s_add_u32 s76, s76, 16384
    s_mul_i32 s78, s77, 589824
    buffer_load_dwordx4 v20, s[20:23], s78 offen offset:0 lds
    s_add_u32 s78, s78, 146432
    buffer_load_dwordx4 v20, s[20:23], s78 offen offset:1024 lds
    s_add_u32 s78, s78, 146432
    buffer_load_dwordx4 v20, s[20:23], s78 offen offset:2048 lds
    s_add_u32 s78, s78, 146432
    buffer_load_dwordx4 v20, s[20:23], s78 offen offset:3072 lds
    s_add_u32 s77, s77, 1
    s_cmp_eq_u32 s77, 9
    s_cselect_b32 s77, 0, s77
    s_cmp_lt_u32 s76, 65536
    s_cbranch_scc1 at_z5
    s_mov_b64 exec, -1
at_g6:
    s_sleep 2
    ds_read_b32 v8, v14
    s_sub_u32 s91, s91, 1
    s_cmp_lt_i32 s91, 0
    s_cbranch_scc1 at_g6x
    s_waitcnt lgkmcnt(0)
    v_cmp_gt_u32 vcc, 6, v8
    s_cbranch_vccnz at_g6
at_g6x:
    s_waitcnt lgkmcnt(0)
    s_lshl_b32 s76, s60, 12
    s_add_u32 s76, s76, 65536
    s_add_u32 s77, s79, 4
    s_cmp_ge_u32 s77, 9
    s_cselect_b32 s78, 9, 0
    s_sub_u32 s77, s77, s78
at_z6:
    s_mov_b32 m0, s76
    s_add_u32 s76, s76, 16384
    s_mul_i32 s78, s77, 589824
    buffer_load_dwordx4 v20, s[20:23], s78 offen offset:0 lds
    s_add_u32 s78, s78, 146432
    buffer_load_dwordx4 v20, s[20:23], s78 offen offset:1024 lds
    s_add_u32 s78, s78, 146432
    buffer_load_dwordx4 v20, s[20:23], s78 offen offset:2048 lds
    s_add_u32 s78, s78, 146432
    buffer_load_dwordx4 v20, s[20:23], s78 offen offset:3072 lds
    s_add_u32 s77, s77, 1
    s_cmp_eq_u32 s77, 9
    s_cselect_b32 s77, 0, s77
    s_cmp_lt_u32 s76, 81920
    s_cbranch_scc1 at_z6
    s_mov_b64 exec, -1
    v_mov_b32 v6, 7
    s_waitcnt vmcnt(10)
    ds_write_b32 v23, v6
    v_mov_b32 v6, 9
    s_waitcnt vmcnt(2)
    ds_write_b32 v23, v6
    v_mov_b32 v6, 2147483647
    s_waitcnt vmcnt(0)
    ds_write_b32 v23, v6
at_ld:
    s_cmp_eq_u32 s74, 1
    s_cbranch_scc1 at_nopack
    s_lshl_b32 s77, s4, 3
    s_lshr_b32 s56, s5, 1
    s_add_u32 s77, s77, s56
    s_lshl_b32 s77, s77, 2
    s_add_u32 s77, s77, s60
at_pack:
    s_mov_b32 s56, s77
    s_mul_i32 s57, s56, 3641
    s_lshr_b32 s57, s57, 16
    s_mul_i32 s58, s57, 18
    s_sub_u32 s58, s56, s58
    v_lshrrev_b32 v24, 5, v1
    v_mul_u32_u24 v24, 18, v24
    v_bfe_u32 v25, v1, 4, 1
    v_lshl_add_u32 v24, v25, 2, v24
    v_bfe_u32 v25, v1, 3, 1
    v_lshl_add_u32 v24, v25, 3, v24
    v_bfe_u32 v25, v1, 1, 2
    v_add_u32 v24, v24, v25
    v_lshrrev_b32 v25, 2, v1
    v_mul_u32_u24 v25, 18, v25
    v_bfe_u32 v26, v1, 1, 1
    v_add3_u32 v25, v25, v26, 16
    s_mul_i32 s59, s58, 36
    s_sub_u32 s78, s58, 16
    s_mul_i32 s78, s78, 288
    s_cmp_lt_u32 s58, 16
    s_cselect_b32 s59, s59, s78
    s_cselect_b64 vcc, -1, 0
    s_mul_i32 s59, s59, 1152
    s_lshl_b32 s57, s57, 5
    s_add_u32 s59, s59, s57
    v_cndmask_b32 v24, v25, v24, vcc
    v_mul_u32_u24 v24, 1152, v24
    v_and_b32 v25, 1, v1
    v_lshl_add_u32 v24, v25, 4, v24
    s_lshl_b32 s57, s60, 10
    s_add_u32 s57, s57, 159744
    s_mov_b32 m0, s57
    v_lshrrev_b32 v25, 4, v1
    buffer_load_dwordx4 v24, s[44:47], s59 offen lds
    v_lshl_add_u32 v25, v25, 8, s57
    v_and_b32 v26, 15, v1
    v_lshl_add_u32 v25, v26, 3, v25
    s_lshl_b32 s56, s56, 10
    s_add_u32 s56, s56, 32111616
    s_waitcnt vmcnt(0)
    ds_read_b64_tr_b16 v[28:29], v25
    ds_read_b64_tr_b16 v[30:31], v25 offset:128
    s_waitcnt lgkmcnt(0)
    buffer_store_dwordx4 v[28:31], v2, s[24:27], s56 offen sc1
    s_add_u32 s77, s77, 512
    s_cmp_lt_u32 s77, 648
    s_cbranch_scc1 at_pack
at_nopack:
    v_lshlrev_b32 v24, 2, v1
    v_add_u32 v24, 150272, v24
    v_mov_b32 v25, 1
    s_waitcnt vmcnt(0)
    ds_add_u32 v24, v25
    s_and_b32 s56, s60, 1
    s_lshl_b32 s62, s5, 1
    s_add_u32 s62, s62, s56
    v_lshrrev_b32 v6, 5, v1
    v_lshlrev_b32 v7, 31, v6
    s_mul_i32 s57, s56, 2560
    v_lshl_add_u32 v3, v1, 3, v7
    v_add_u32 v3, s57, v3
    v_add_u32 v20, s57, v2
    v_and_b32 v8, 31, v1
    v_lshlrev_b32 v9, 4, v8
    v_lshl_add_u32 v4, v6, 8, v9
    v_add_u32 v0, 512, v4
    v_lshl_add_u32 v9, v6, 6, v9
    v_cmp_lt_u32 vcc, 15, v8
    v_add_u32 v9, 768, v9
    v_add_u32 v7, 128, v9
    v_cndmask_b32 v4, v4, v9, vcc
    v_cndmask_b32 v0, v0, v7, vcc
    v_mov_b32 v9, 2147483648
    v_cmp_lt_u32 vcc, 18, v8
    v_mov_b32 v5, 0xdddddddd
    s_nop 0
    v_cndmask_b32 v4, v4, v9, vcc
    v_cndmask_b32 v0, v0, v9, vcc
    s_mul_i32 s67, s61, 122880
    s_add_u32 s67, s67, 18874368
    v_lshlrev_b32 v6, 2, v1
    s_lshl_b32 s57, s60, 7
    s_add_u32 s57, s57, 149504
    v_lshl_add_u32 v10, v8, 2, s57
    v_xor_b32 v11, 256, v10
    s_mul_i32 s57, s60, 6144
    s_add_u32 s57, s57, 110592
    v_add_u32 v12, s57, v2
    s_xor_b32 s57, s60, 2
    s_mul_i32 s57, s57, 6144
    s_add_u32 s57, s57, 110592
    v_add_u32 v13, s57, v2
    s_mov_b32 s65, 1
    s_mov_b32 s66, 0x42ac0000
    s_mov_b32 s68, 0
    v_add_u32 v7, 150016, v6
    v_mov_b32 v48, 0
    v_mov_b32 v49, 0
    v_mov_b32 v50, 0
    v_mov_b32 v51, 0
    v_mov_b32 v52, 0
    v_mov_b32 v53, 0
    v_mov_b32 v54, 0
    v_mov_b32 v55, 0
    v_mov_b32 v56, 0
    v_mov_b32 v57, 0
    v_mov_b32 v58, 0
    v_mov_b32 v59, 0
    v_mov_b32 v60, 0
    v_mov_b32 v61, 0
    v_mov_b32 v62, 0
    v_mov_b32 v63, 0
    v_mov_b32 v64, 0
    v_mov_b32 v65, 0
    v_mov_b32 v66, 0
    v_mov_b32 v67, 0
    v_mov_b32 v68, 0
    v_mov_b32 v69, 0
    v_mov_b32 v70, 0
    v_mov_b32 v71, 0
    v_mov_b32 v72, 0
    v_mov_b32 v73, 0
    v_mov_b32 v74, 0
    v_mov_b32 v75, 0
    v_mov_b32 v76, 0
    v_mov_b32 v77, 0
    v_mov_b32 v78, 0
    v_mov_b32 v79, 0
    v_mov_b32 v80, 0
    v_mov_b32 v81, 0
    v_mov_b32 v82, 0
    v_mov_b32 v83, 0
    v_mov_b32 v84, 0
    v_mov_b32 v85, 0
    v_mov_b32 v86, 0
    v_mov_b32 v87, 0
    v_mov_b32 v88, 0
    v_mov_b32 v89, 0
    v_mov_b32 v90, 0
    v_mov_b32 v91, 0
    v_mov_b32 v92, 0
    v_mov_b32 v93, 0
    v_mov_b32 v94, 0
    v_mov_b32 v95, 0
    v_mov_b32 v96, 0
    v_mov_b32 v97, 0
    v_mov_b32 v98, 0
    v_mov_b32 v99, 0
    v_mov_b32 v100, 0
    v_mov_b32 v101, 0
    v_mov_b32 v102, 0
    v_mov_b32 v103, 0
    v_mov_b32 v104, 0
    v_mov_b32 v105, 0
    v_mov_b32 v106, 0
    v_mov_b32 v107, 0
    v_mov_b32 v108, 0
    v_mov_b32 v109, 0
    v_mov_b32 v110, 0
    v_mov_b32 v111, 0
    v_mov_b32 v228, 0
    v_mov_b32 v229, 0
    v_mov_b32 v230, 0
    v_mov_b32 v231, 0
    v_mov_b32 v232, 0
    v_mov_b32 v233, 0
    v_mov_b32 v234, 0
    v_mov_b32 v235, 0
    s_setprio 3
    s_cmp_lg_u32 s60, 0
    s_cbranch_scc1 at_wkv
    v_mov_b32 v9, 0
at_ini:
    buffer_load_dword v8, v9, s[28:31], 0 offen sc1
    s_sub_u32 s91, s91, 16
    s_cmp_lt_i32 s91, 0
    s_cbranch_scc1 at_inix
    s_waitcnt vmcnt(0)
    v_cmp_eq_u32 vcc, 0, v8
    s_cbranch_vccz at_inix
    s_sleep 2
    s_branch at_ini
at_inix:
at_wp:
    s_sleep 4
    ds_read_b32 v8, v24
    s_sub_u32 s91, s91, 16
    s_cmp_lt_i32 s91, 0
    s_cbranch_scc1 at_wpx
    s_waitcnt lgkmcnt(0)
    v_cmp_gt_u32 vcc, 4, v8
    s_cbranch_vccnz at_wp
at_wpx:
    s_cmp_eq_u32 s74, 1
    s_cselect_b32 s57, 9, 0
at_wg:
    s_sleep 4
    ds_read_b32 v8, v14
    s_sub_u32 s91, s91, 16
    s_cmp_lt_i32 s91, 0
    s_cbranch_scc1 at_wgx
    s_waitcnt lgkmcnt(0)
    v_cmp_gt_u32 vcc, s57, v8
    s_cbranch_vccnz at_wg
at_wgx:
    s_mov_b32 s57, 33057792
    v_mul_u32_u24 v9, 4352, v1
    buffer_atomic_add v25, v9, s[24:27], s57 offen sc1
    s_cmp_eq_u32 s74, 0
    s_cselect_b32 s58, 11, 0
at_we:
    s_sleep 4
    ds_read_b32 v8, v14
    s_sub_u32 s91, s91, 16
    s_cmp_lt_i32 s91, 0
    s_cbranch_scc1 at_wex
    s_waitcnt lgkmcnt(0)
    v_cmp_gt_u32 vcc, s58, v8
    s_cbranch_vccnz at_we
at_wex:
    s_and_b32 s58, s2, 15
    s_mul_i32 s58, s58, 4352
    s_add_u32 s57, s57, s58
    v_mov_b32 v9, 0
    s_sleep 30
at_kvf:
    buffer_load_dword v8, v9, s[24:27], s57 offen sc1
    s_sub_u32 s91, s91, 16
    s_cmp_lt_i32 s91, 0
    s_cbranch_scc1 at_kvfx
    s_waitcnt vmcnt(0)
    v_cmp_ne_u32 vcc, 0x100, v8
    s_cbranch_vccz at_kvfx
    s_sleep 30
    s_branch at_kvf
at_kvfx:
    v_mov_b32 v8, 1
    ds_write_b32 v7, v8
at_wkv:
    ds_read_b32 v8, v7
    s_sub_u32 s91, s91, 16
    s_cmp_lt_i32 s91, 0
    s_cbranch_scc1 at_wkvx
    s_waitcnt lgkmcnt(0)
    v_cmp_gt_u32 vcc, 1, v8
    s_cbranch_vccz at_wkvx
    s_sleep 4
    s_branch at_wkv
at_wkvx:
    s_waitcnt lgkmcnt(0) vmcnt(0)
    s_mul_i32 s57, s56, 1152
    v_and_b32 v8, 31, v1
    v_lshlrev_b32 v8, 2, v8
    s_cmp_eq_u32 s74, 0
    s_cbranch_scc1 at_qg
    s_lshl_b32 s58, s61, 1
    s_xor_b32 s58, s58, 0
    s_mul_i32 s58, s58, 2304
    s_add_u32 s58, s58, s57
    s_add_u32 s58, s58, 150528
    v_add_u32 v9, s58, v2
    ds_read_b128 v[24:27], v9
    v_add_u32 v9, s58, v8
    ds_read_b32 v40, v9 offset:1024
    s_lshl_b32 s58, s61, 1
    s_xor_b32 s58, s58, 1
    s_mul_i32 s58, s58, 2304
    s_add_u32 s58, s58, s57
    s_add_u32 s58, s58, 150528
    v_add_u32 v9, s58, v2
    ds_read_b128 v[28:31], v9
    v_add_u32 v9, s58, v8
    ds_read_b32 v42, v9 offset:1024
    s_lshl_b32 s58, s61, 1
    s_xor_b32 s58, s58, 2
    s_mul_i32 s58, s58, 2304
    s_add_u32 s58, s58, s57
    s_add_u32 s58, s58, 150528
    v_add_u32 v9, s58, v2
    ds_read_b128 v[32:35], v9
    v_add_u32 v9, s58, v8
    ds_read_b32 v44, v9 offset:1024
    s_lshl_b32 s58, s61, 1
    s_xor_b32 s58, s58, 3
    s_mul_i32 s58, s58, 2304
    s_add_u32 s58, s58, s57
    s_add_u32 s58, s58, 150528
    v_add_u32 v9, s58, v2
    ds_read_b128 v[36:39], v9
    v_add_u32 v9, s58, v8
    ds_read_b32 v46, v9 offset:1024
    s_branch at_qd
at_qg:
    s_lshl_b32 s59, s4, 5
    s_lshr_b32 s58, s5, 1
    s_add_u32 s59, s59, s58
    s_mul_i32 s59, s59, 2304
    s_add_u32 s57, s57, s59
    s_add_u32 s57, s57, 30931968
    s_lshl_b32 s58, s61, 1
    s_xor_b32 s58, s58, 0
    s_mul_i32 s58, s58, 18432
    s_add_u32 s58, s58, s57
    buffer_load_dwordx4 v[24:27], v2, s[24:27], s58 offen sc1
    buffer_load_dword v40, v8, s[24:27], s58 offen offset:1024 sc1
    s_lshl_b32 s58, s61, 1
    s_xor_b32 s58, s58, 1
    s_mul_i32 s58, s58, 18432
    s_add_u32 s58, s58, s57
    buffer_load_dwordx4 v[28:31], v2, s[24:27], s58 offen sc1
    buffer_load_dword v42, v8, s[24:27], s58 offen offset:1024 sc1
    s_lshl_b32 s58, s61, 1
    s_xor_b32 s58, s58, 2
    s_mul_i32 s58, s58, 18432
    s_add_u32 s58, s58, s57
    buffer_load_dwordx4 v[32:35], v2, s[24:27], s58 offen sc1
    buffer_load_dword v44, v8, s[24:27], s58 offen offset:1024 sc1
    s_lshl_b32 s58, s61, 1
    s_xor_b32 s58, s58, 3
    s_mul_i32 s58, s58, 18432
    s_add_u32 s58, s58, s57
    buffer_load_dwordx4 v[36:39], v2, s[24:27], s58 offen sc1
    buffer_load_dword v46, v8, s[24:27], s58 offen offset:1024 sc1
at_qd:
    s_and_b32 s58, s4, 7
    s_lshl_b32 s58, s58, 2
    s_add_u32 s58, s58, s6
    s_lshl_b32 s58, s58, 2
    s_add_u32 s58, s58, s60
    s_mul_i32 s58, s58, 10368
    s_mul_i32 s78, s7, 1327104
    s_add_u32 s78, s78, s58
at_restart:
    v_mov_b32 v41, 0
    v_mov_b32 v16, 0xff800000
    v_mov_b32 v43, 0
    v_mov_b32 v17, 0xff800000
    v_mov_b32 v45, 0
    v_mov_b32 v18, 0xff800000
    v_mov_b32 v47, 0
    v_mov_b32 v19, 0xff800000
    s_mov_b32 s59, 18874368
    s_mov_b32 s64, 0
at_pre:
    buffer_load_dwordx4 v[240:243], v20, s[24:27], s59 offen sc1
    buffer_load_dwordx2 v[244:245], v3, s[24:27], s59 offen offset:1024 sc1
    s_add_u32 s59, s59, 3840
    buffer_load_dwordx4 v[248:251], v20, s[24:27], s59 offen sc1
    buffer_load_dwordx2 v[252:253], v3, s[24:27], s59 offen offset:1024 sc1
    s_add_u32 s59, s59, 3840
    s_mov_b32 s63, s67
    buffer_load_dwordx4 v[176:179], v20, s[24:27], s63 offen sc1
    buffer_load_dwordx2 v[188:189], v3, s[24:27], s63 offen offset:1024 sc1
    buffer_load_dwordx4 v[180:183], v4, s[24:27], s63 offen offset:1280 sc1
    buffer_load_dwordx4 v[184:187], v0, s[24:27], s63 offen offset:1280 sc1
    s_add_u32 s63, s63, 3840
    buffer_load_dwordx4 v[192:195], v20, s[24:27], s63 offen sc1
    buffer_load_dwordx2 v[204:205], v3, s[24:27], s63 offen offset:1024 sc1
    buffer_load_dwordx4 v[196:199], v4, s[24:27], s63 offen offset:1280 sc1
    buffer_load_dwordx4 v[200:203], v0, s[24:27], s63 offen offset:1280 sc1
    s_add_u32 s63, s63, 3840
    buffer_load_dwordx4 v[208:211], v20, s[24:27], s63 offen sc1
    buffer_load_dwordx2 v[220:221], v3, s[24:27], s63 offen offset:1024 sc1
    buffer_load_dwordx4 v[212:215], v4, s[24:27], s63 offen offset:1280 sc1
    buffer_load_dwordx4 v[216:219], v0, s[24:27], s63 offen offset:1280 sc1
    s_add_u32 s63, s63, 3840
    s_waitcnt vmcnt(12) lgkmcnt(0)
    v_mfma_f32_32x32x8_bf16 v[112:127], v[244:245], v[40:41], 0
    v_mfma_f32_32x32x16_bf16 v[112:127], v[240:243], v[24:27], v[112:127]
    v_mfma_f32_32x32x8_bf16 v[128:143], v[244:245], v[42:43], 0
    v_mfma_f32_32x32x16_bf16 v[128:143], v[240:243], v[28:31], v[128:143]
    v_mfma_f32_32x32x8_bf16 v[144:159], v[244:245], v[44:45], 0
    v_mfma_f32_32x32x16_bf16 v[144:159], v[240:243], v[32:35], v[144:159]
    v_mfma_f32_32x32x8_bf16 v[160:175], v[244:245], v[46:47], 0
    v_mfma_f32_32x32x16_bf16 v[160:175], v[240:243], v[36:39], v[160:175]
    s_nop 5
    v_max3_f32 v16, v112, v113, v16
    v_max3_f32 v16, v114, v115, v16
    v_max3_f32 v16, v116, v117, v16
    v_max3_f32 v16, v118, v119, v16
    v_max3_f32 v16, v120, v121, v16
    v_max3_f32 v16, v122, v123, v16
    v_max3_f32 v16, v124, v125, v16
    v_max3_f32 v16, v126, v127, v16
    v_max3_f32 v17, v128, v129, v17
    v_max3_f32 v17, v130, v131, v17
    v_max3_f32 v17, v132, v133, v17
    v_max3_f32 v17, v134, v135, v17
    v_max3_f32 v17, v136, v137, v17
    v_max3_f32 v17, v138, v139, v17
    v_max3_f32 v17, v140, v141, v17
    v_max3_f32 v17, v142, v143, v17
    v_max3_f32 v18, v144, v145, v18
    v_max3_f32 v18, v146, v147, v18
    v_max3_f32 v18, v148, v149, v18
    v_max3_f32 v18, v150, v151, v18
    v_max3_f32 v18, v152, v153, v18
    v_max3_f32 v18, v154, v155, v18
    v_max3_f32 v18, v156, v157, v18
    v_max3_f32 v18, v158, v159, v18
    v_max3_f32 v19, v160, v161, v19
    v_max3_f32 v19, v162, v163, v19
    v_max3_f32 v19, v164, v165, v19
    v_max3_f32 v19, v166, v167, v19
    v_max3_f32 v19, v168, v169, v19
    v_max3_f32 v19, v170, v171, v19
    v_max3_f32 v19, v172, v173, v19
    v_max3_f32 v19, v174, v175, v19
    v_mfma_f32_32x32x8_bf16 v[112:127], v[252:253], v[40:41], 0
    v_mfma_f32_32x32x16_bf16 v[112:127], v[248:251], v[24:27], v[112:127]
    v_mfma_f32_32x32x8_bf16 v[128:143], v[252:253], v[42:43], 0
    v_mfma_f32_32x32x16_bf16 v[128:143], v[248:251], v[28:31], v[128:143]
    v_mfma_f32_32x32x8_bf16 v[144:159], v[252:253], v[44:45], 0
    v_mfma_f32_32x32x16_bf16 v[144:159], v[248:251], v[32:35], v[144:159]
    v_mfma_f32_32x32x8_bf16 v[160:175], v[252:253], v[46:47], 0
    v_mfma_f32_32x32x16_bf16 v[160:175], v[248:251], v[36:39], v[160:175]
    s_nop 5
    v_max3_f32 v16, v112, v113, v16
    v_max3_f32 v16, v114, v115, v16
    v_max3_f32 v16, v116, v117, v16
    v_max3_f32 v16, v118, v119, v16
    v_max3_f32 v16, v120, v121, v16
    v_max3_f32 v16, v122, v123, v16
    v_max3_f32 v16, v124, v125, v16
    v_max3_f32 v16, v126, v127, v16
    v_max3_f32 v17, v128, v129, v17
    v_max3_f32 v17, v130, v131, v17
    v_max3_f32 v17, v132, v133, v17
    v_max3_f32 v17, v134, v135, v17
    v_max3_f32 v17, v136, v137, v17
    v_max3_f32 v17, v138, v139, v17
    v_max3_f32 v17, v140, v141, v17
    v_max3_f32 v17, v142, v143, v17
    v_max3_f32 v18, v144, v145, v18
    v_max3_f32 v18, v146, v147, v18
    v_max3_f32 v18, v148, v149, v18
    v_max3_f32 v18, v150, v151, v18
    v_max3_f32 v18, v152, v153, v18
    v_max3_f32 v18, v154, v155, v18
    v_max3_f32 v18, v156, v157, v18
    v_max3_f32 v18, v158, v159, v18
    v_max3_f32 v19, v160, v161, v19
    v_max3_f32 v19, v162, v163, v19
    v_max3_f32 v19, v164, v165, v19
    v_max3_f32 v19, v166, v167, v19
    v_max3_f32 v19, v168, v169, v19
    v_max3_f32 v19, v170, v171, v19
    v_max3_f32 v19, v172, v173, v19
    v_max3_f32 v19, v174, v175, v19
    s_add_u32 s64, s64, 1
    s_cmp_lt_u32 s64, s65
    s_cbranch_scc1 at_pre
    v_mov_b32 v112, v16
    v_mov_b32 v113, v17
    v_mov_b32 v114, v18
    v_mov_b32 v115, v19
    s_nop 1
    v_permlane32_swap_b32 v112, v16
    v_permlane32_swap_b32 v113, v17
    v_permlane32_swap_b32 v114, v18
    v_permlane32_swap_b32 v115, v19
    s_nop 1
    v_max_f32 v16, v16, v112
    v_max_f32 v17, v17, v113
    v_max_f32 v18, v18, v114
    v_max_f32 v19, v19, v115
    v_add_f32 v16, s66, v16
    v_add_f32 v17, s66, v17
    v_add_f32 v18, s66, v18
    v_add_f32 v19, s66, v19
    v_and_b32 v112, 0xffff0000, v16
    v_and_b32 v113, 0xffff0000, v17
    v_and_b32 v114, 0xffff0000, v18
    v_and_b32 v115, 0xffff0000, v19
    v_sub_f32 v16, v112, v16
    v_sub_f32 v17, v113, v17
    v_sub_f32 v18, v114, v18
    v_sub_f32 v19, v115, v19
    v_cvt_pk_bf16_f32 v41, -v112, v16
    v_cvt_pk_bf16_f32 v43, -v113, v17
    v_cvt_pk_bf16_f32 v45, -v114, v18
    v_cvt_pk_bf16_f32 v47, -v115, v19
    v_mov_b32 v160, 0
    v_mov_b32 v161, 0
    v_mov_b32 v162, 0
    v_mov_b32 v163, 0
    v_mov_b32 v164, 0
    v_mov_b32 v165, 0
    v_mov_b32 v166, 0
    v_mov_b32 v167, 0
    v_mov_b32 v168, 0
    v_mov_b32 v169, 0
    v_mov_b32 v170, 0
    v_mov_b32 v171, 0
    v_mov_b32 v172, 0
    v_mov_b32 v173, 0
    v_mov_b32 v174, 0
    v_mov_b32 v175, 0
    s_waitcnt vmcnt(8)
    v_mfma_f32_32x32x8_bf16 v[112:127], v[188:189], v[40:41], 0
    v_mfma_f32_32x32x16_bf16 v[112:127], v[176:179], v[24:27], v[112:127]
    s_mov_b32 s64, 0
    s_setprio 1
    s_nop 7
    s_nop 3
at_loop:
    v_mfma_f32_32x32x8_bf16 v[128:143], v[188:189], v[42:43], 0
    v_exp_f32 v112, v112
    v_exp_f32 v113, v113
    v_exp_f32 v114, v114
    v_exp_f32 v115, v115
    v_mfma_f32_32x32x16_bf16 v[128:143], v[176:179], v[28:31], v[128:143]
    v_exp_f32 v116, v116
    v_exp_f32 v117, v117
    v_exp_f32 v118, v118
    v_exp_f32 v119, v119
    v_smfmac_f32_32x32x32_bf16 v[96:111], v[228:231], v[160:167], v5
    v_exp_f32 v120, v120
    v_exp_f32 v121, v121
    v_exp_f32 v122, v122
    v_exp_f32 v123, v123
    v_smfmac_f32_32x32x32_bf16 v[96:111], v[232:235], v[168:175], v5
    v_exp_f32 v124, v124
    v_exp_f32 v125, v125
    v_exp_f32 v126, v126
    v_exp_f32 v127, v127
    v_mfma_f32_32x32x8_bf16 v[144:159], v[188:189], v[44:45], 0
    buffer_load_dwordx4 v[224:227], v20, s[24:27], s63 offen sc1
    v_exp_f32 v128, v128
    v_exp_f32 v129, v129
    v_exp_f32 v130, v130
    v_exp_f32 v131, v131
    v_mfma_f32_32x32x16_bf16 v[144:159], v[176:179], v[32:35], v[144:159]
    buffer_load_dwordx2 v[236:237], v3, s[24:27], s63 offen offset:1024 sc1
    v_exp_f32 v132, v132
    v_exp_f32 v133, v133
    v_exp_f32 v134, v134
    v_exp_f32 v135, v135
    v_smfmac_f32_32x32x32_bf16 v[48:63], v[180:183], v[112:119], v5
    buffer_load_dwordx4 v[228:231], v4, s[24:27], s63 offen offset:1280 sc1
    v_exp_f32 v136, v136
    v_exp_f32 v137, v137
    v_exp_f32 v138, v138
    v_exp_f32 v139, v139
    v_smfmac_f32_32x32x32_bf16 v[48:63], v[184:187], v[120:127], v5
    buffer_load_dwordx4 v[232:235], v0, s[24:27], s63 offen offset:1280 sc1
    s_add_u32 s63, s63, 3840
    v_exp_f32 v140, v140
    v_exp_f32 v141, v141
    v_exp_f32 v142, v142
    v_exp_f32 v143, v143
    v_mfma_f32_32x32x8_bf16 v[160:175], v[188:189], v[46:47], 0
    v_exp_f32 v144, v144
    v_exp_f32 v145, v145
    v_exp_f32 v146, v146
    v_exp_f32 v147, v147
    v_mfma_f32_32x32x16_bf16 v[160:175], v[176:179], v[36:39], v[160:175]
    v_exp_f32 v148, v148
    v_exp_f32 v149, v149
    v_exp_f32 v150, v150
    v_exp_f32 v151, v151
    v_smfmac_f32_32x32x32_bf16 v[64:79], v[180:183], v[128:135], v5
    v_exp_f32 v152, v152
    v_exp_f32 v153, v153
    v_exp_f32 v154, v154
    v_exp_f32 v155, v155
    v_smfmac_f32_32x32x32_bf16 v[64:79], v[184:187], v[136:143], v5
    v_exp_f32 v156, v156
    v_exp_f32 v157, v157
    v_exp_f32 v158, v158
    v_exp_f32 v159, v159
    s_waitcnt vmcnt(8)
    v_mfma_f32_32x32x8_bf16 v[112:127], v[204:205], v[40:41], 0
    v_exp_f32 v160, v160
    v_exp_f32 v161, v161
    v_exp_f32 v162, v162
    v_exp_f32 v163, v163
    v_mfma_f32_32x32x16_bf16 v[112:127], v[192:195], v[24:27], v[112:127]
    v_exp_f32 v164, v164
    v_exp_f32 v165, v165
    v_exp_f32 v166, v166
    v_exp_f32 v167, v167
    v_smfmac_f32_32x32x32_bf16 v[80:95], v[180:183], v[144:151], v5
    v_exp_f32 v168, v168
    v_exp_f32 v169, v169
    v_exp_f32 v170, v170
    v_exp_f32 v171, v171
    v_smfmac_f32_32x32x32_bf16 v[80:95], v[184:187], v[152:159], v5
    v_exp_f32 v172, v172
    v_exp_f32 v173, v173
    v_exp_f32 v174, v174
    v_exp_f32 v175, v175
    v_mfma_f32_32x32x8_bf16 v[128:143], v[204:205], v[42:43], 0
    v_exp_f32 v112, v112
    v_exp_f32 v113, v113
    v_exp_f32 v114, v114
    v_exp_f32 v115, v115
    v_mfma_f32_32x32x16_bf16 v[128:143], v[192:195], v[28:31], v[128:143]
    v_exp_f32 v116, v116
    v_exp_f32 v117, v117
    v_exp_f32 v118, v118
    v_exp_f32 v119, v119
    v_smfmac_f32_32x32x32_bf16 v[96:111], v[180:183], v[160:167], v5
    v_exp_f32 v120, v120
    v_exp_f32 v121, v121
    v_exp_f32 v122, v122
    v_exp_f32 v123, v123
    v_smfmac_f32_32x32x32_bf16 v[96:111], v[184:187], v[168:175], v5
    v_exp_f32 v124, v124
    v_exp_f32 v125, v125
    v_exp_f32 v126, v126
    v_exp_f32 v127, v127
    v_mfma_f32_32x32x8_bf16 v[144:159], v[204:205], v[44:45], 0
    buffer_load_dwordx4 v[176:179], v20, s[24:27], s63 offen sc1
    v_exp_f32 v128, v128
    v_exp_f32 v129, v129
    v_exp_f32 v130, v130
    v_exp_f32 v131, v131
    v_mfma_f32_32x32x16_bf16 v[144:159], v[192:195], v[32:35], v[144:159]
    buffer_load_dwordx2 v[188:189], v3, s[24:27], s63 offen offset:1024 sc1
    v_exp_f32 v132, v132
    v_exp_f32 v133, v133
    v_exp_f32 v134, v134
    v_exp_f32 v135, v135
    v_smfmac_f32_32x32x32_bf16 v[48:63], v[196:199], v[112:119], v5
    buffer_load_dwordx4 v[180:183], v4, s[24:27], s63 offen offset:1280 sc1
    v_exp_f32 v136, v136
    v_exp_f32 v137, v137
    v_exp_f32 v138, v138
    v_exp_f32 v139, v139
    v_smfmac_f32_32x32x32_bf16 v[48:63], v[200:203], v[120:127], v5
    buffer_load_dwordx4 v[184:187], v0, s[24:27], s63 offen offset:1280 sc1
    s_add_u32 s63, s63, 3840
    v_exp_f32 v140, v140
    v_exp_f32 v141, v141
    v_exp_f32 v142, v142
    v_exp_f32 v143, v143
    v_mfma_f32_32x32x8_bf16 v[160:175], v[204:205], v[46:47], 0
    v_exp_f32 v144, v144
    v_exp_f32 v145, v145
    v_exp_f32 v146, v146
    v_exp_f32 v147, v147
    v_mfma_f32_32x32x16_bf16 v[160:175], v[192:195], v[36:39], v[160:175]
    v_exp_f32 v148, v148
    v_exp_f32 v149, v149
    v_exp_f32 v150, v150
    v_exp_f32 v151, v151
    v_smfmac_f32_32x32x32_bf16 v[64:79], v[196:199], v[128:135], v5
    v_exp_f32 v152, v152
    v_exp_f32 v153, v153
    v_exp_f32 v154, v154
    v_exp_f32 v155, v155
    v_smfmac_f32_32x32x32_bf16 v[64:79], v[200:203], v[136:143], v5
    v_exp_f32 v156, v156
    v_exp_f32 v157, v157
    v_exp_f32 v158, v158
    v_exp_f32 v159, v159
    s_waitcnt vmcnt(8)
    v_mfma_f32_32x32x8_bf16 v[112:127], v[220:221], v[40:41], 0
    v_exp_f32 v160, v160
    v_exp_f32 v161, v161
    v_exp_f32 v162, v162
    v_exp_f32 v163, v163
    v_mfma_f32_32x32x16_bf16 v[112:127], v[208:211], v[24:27], v[112:127]
    v_exp_f32 v164, v164
    v_exp_f32 v165, v165
    v_exp_f32 v166, v166
    v_exp_f32 v167, v167
    v_smfmac_f32_32x32x32_bf16 v[80:95], v[196:199], v[144:151], v5
    v_exp_f32 v168, v168
    v_exp_f32 v169, v169
    v_exp_f32 v170, v170
    v_exp_f32 v171, v171
    v_smfmac_f32_32x32x32_bf16 v[80:95], v[200:203], v[152:159], v5
    v_exp_f32 v172, v172
    v_exp_f32 v173, v173
    v_exp_f32 v174, v174
    v_exp_f32 v175, v175
    v_mfma_f32_32x32x8_bf16 v[128:143], v[220:221], v[42:43], 0
    v_exp_f32 v112, v112
    v_exp_f32 v113, v113
    v_exp_f32 v114, v114
    v_exp_f32 v115, v115
    v_mfma_f32_32x32x16_bf16 v[128:143], v[208:211], v[28:31], v[128:143]
    v_exp_f32 v116, v116
    v_exp_f32 v117, v117
    v_exp_f32 v118, v118
    v_exp_f32 v119, v119
    v_smfmac_f32_32x32x32_bf16 v[96:111], v[196:199], v[160:167], v5
    v_exp_f32 v120, v120
    v_exp_f32 v121, v121
    v_exp_f32 v122, v122
    v_exp_f32 v123, v123
    v_smfmac_f32_32x32x32_bf16 v[96:111], v[200:203], v[168:175], v5
    v_exp_f32 v124, v124
    v_exp_f32 v125, v125
    v_exp_f32 v126, v126
    v_exp_f32 v127, v127
    v_mfma_f32_32x32x8_bf16 v[144:159], v[220:221], v[44:45], 0
    buffer_load_dwordx4 v[192:195], v20, s[24:27], s63 offen sc1
    v_exp_f32 v128, v128
    v_exp_f32 v129, v129
    v_exp_f32 v130, v130
    v_exp_f32 v131, v131
    v_mfma_f32_32x32x16_bf16 v[144:159], v[208:211], v[32:35], v[144:159]
    buffer_load_dwordx2 v[204:205], v3, s[24:27], s63 offen offset:1024 sc1
    v_exp_f32 v132, v132
    v_exp_f32 v133, v133
    v_exp_f32 v134, v134
    v_exp_f32 v135, v135
    v_smfmac_f32_32x32x32_bf16 v[48:63], v[212:215], v[112:119], v5
    buffer_load_dwordx4 v[196:199], v4, s[24:27], s63 offen offset:1280 sc1
    v_exp_f32 v136, v136
    v_exp_f32 v137, v137
    v_exp_f32 v138, v138
    v_exp_f32 v139, v139
    v_smfmac_f32_32x32x32_bf16 v[48:63], v[216:219], v[120:127], v5
    buffer_load_dwordx4 v[200:203], v0, s[24:27], s63 offen offset:1280 sc1
    s_add_u32 s63, s63, 3840
    v_exp_f32 v140, v140
    v_exp_f32 v141, v141
    v_exp_f32 v142, v142
    v_exp_f32 v143, v143
    v_mfma_f32_32x32x8_bf16 v[160:175], v[220:221], v[46:47], 0
    v_exp_f32 v144, v144
    v_exp_f32 v145, v145
    v_exp_f32 v146, v146
    v_exp_f32 v147, v147
    v_mfma_f32_32x32x16_bf16 v[160:175], v[208:211], v[36:39], v[160:175]
    v_exp_f32 v148, v148
    v_exp_f32 v149, v149
    v_exp_f32 v150, v150
    v_exp_f32 v151, v151
    v_smfmac_f32_32x32x32_bf16 v[64:79], v[212:215], v[128:135], v5
    v_exp_f32 v152, v152
    v_exp_f32 v153, v153
    v_exp_f32 v154, v154
    v_exp_f32 v155, v155
    v_smfmac_f32_32x32x32_bf16 v[64:79], v[216:219], v[136:143], v5
    v_exp_f32 v156, v156
    v_exp_f32 v157, v157
    v_exp_f32 v158, v158
    v_exp_f32 v159, v159
    s_waitcnt vmcnt(8)
    v_mfma_f32_32x32x8_bf16 v[112:127], v[236:237], v[40:41], 0
    v_exp_f32 v160, v160
    v_exp_f32 v161, v161
    v_exp_f32 v162, v162
    v_exp_f32 v163, v163
    v_mfma_f32_32x32x16_bf16 v[112:127], v[224:227], v[24:27], v[112:127]
    v_exp_f32 v164, v164
    v_exp_f32 v165, v165
    v_exp_f32 v166, v166
    v_exp_f32 v167, v167
    v_smfmac_f32_32x32x32_bf16 v[80:95], v[212:215], v[144:151], v5
    v_exp_f32 v168, v168
    v_exp_f32 v169, v169
    v_exp_f32 v170, v170
    v_exp_f32 v171, v171
    v_smfmac_f32_32x32x32_bf16 v[80:95], v[216:219], v[152:159], v5
    v_exp_f32 v172, v172
    v_exp_f32 v173, v173
    v_exp_f32 v174, v174
    v_exp_f32 v175, v175
    v_mfma_f32_32x32x8_bf16 v[128:143], v[236:237], v[42:43], 0
    v_exp_f32 v112, v112
    v_exp_f32 v113, v113
    v_exp_f32 v114, v114
    v_exp_f32 v115, v115
    v_mfma_f32_32x32x16_bf16 v[128:143], v[224:227], v[28:31], v[128:143]
    v_exp_f32 v116, v116
    v_exp_f32 v117, v117
    v_exp_f32 v118, v118
    v_exp_f32 v119, v119
    v_smfmac_f32_32x32x32_bf16 v[96:111], v[212:215], v[160:167], v5
    v_exp_f32 v120, v120
    v_exp_f32 v121, v121
    v_exp_f32 v122, v122
    v_exp_f32 v123, v123
    v_smfmac_f32_32x32x32_bf16 v[96:111], v[216:219], v[168:175], v5
    v_exp_f32 v124, v124
    v_exp_f32 v125, v125
    v_exp_f32 v126, v126
    v_exp_f32 v127, v127
    v_mfma_f32_32x32x8_bf16 v[144:159], v[236:237], v[44:45], 0
    buffer_load_dwordx4 v[208:211], v20, s[24:27], s63 offen sc1
    v_exp_f32 v128, v128
    v_exp_f32 v129, v129
    v_exp_f32 v130, v130
    v_exp_f32 v131, v131
    v_mfma_f32_32x32x16_bf16 v[144:159], v[224:227], v[32:35], v[144:159]
    buffer_load_dwordx2 v[220:221], v3, s[24:27], s63 offen offset:1024 sc1
    v_exp_f32 v132, v132
    v_exp_f32 v133, v133
    v_exp_f32 v134, v134
    v_exp_f32 v135, v135
    v_smfmac_f32_32x32x32_bf16 v[48:63], v[228:231], v[112:119], v5
    buffer_load_dwordx4 v[212:215], v4, s[24:27], s63 offen offset:1280 sc1
    v_exp_f32 v136, v136
    v_exp_f32 v137, v137
    v_exp_f32 v138, v138
    v_exp_f32 v139, v139
    v_smfmac_f32_32x32x32_bf16 v[48:63], v[232:235], v[120:127], v5
    buffer_load_dwordx4 v[216:219], v0, s[24:27], s63 offen offset:1280 sc1
    s_add_u32 s63, s63, 3840
    v_exp_f32 v140, v140
    v_exp_f32 v141, v141
    v_exp_f32 v142, v142
    v_exp_f32 v143, v143
    v_mfma_f32_32x32x8_bf16 v[160:175], v[236:237], v[46:47], 0
    v_exp_f32 v144, v144
    v_exp_f32 v145, v145
    v_exp_f32 v146, v146
    v_exp_f32 v147, v147
    v_mfma_f32_32x32x16_bf16 v[160:175], v[224:227], v[36:39], v[160:175]
    v_exp_f32 v148, v148
    v_exp_f32 v149, v149
    v_exp_f32 v150, v150
    v_exp_f32 v151, v151
    v_smfmac_f32_32x32x32_bf16 v[64:79], v[228:231], v[128:135], v5
    v_exp_f32 v152, v152
    v_exp_f32 v153, v153
    v_exp_f32 v154, v154
    v_exp_f32 v155, v155
    v_smfmac_f32_32x32x32_bf16 v[64:79], v[232:235], v[136:143], v5
    v_exp_f32 v156, v156
    v_exp_f32 v157, v157
    v_exp_f32 v158, v158
    v_exp_f32 v159, v159
    s_waitcnt vmcnt(8)
    v_mfma_f32_32x32x8_bf16 v[112:127], v[188:189], v[40:41], 0
    v_exp_f32 v160, v160
    v_exp_f32 v161, v161
    v_exp_f32 v162, v162
    v_exp_f32 v163, v163
    v_mfma_f32_32x32x16_bf16 v[112:127], v[176:179], v[24:27], v[112:127]
    v_exp_f32 v164, v164
    v_exp_f32 v165, v165
    v_exp_f32 v166, v166
    v_exp_f32 v167, v167
    v_smfmac_f32_32x32x32_bf16 v[80:95], v[228:231], v[144:151], v5
    v_exp_f32 v168, v168
    v_exp_f32 v169, v169
    v_exp_f32 v170, v170
    v_exp_f32 v171, v171
    v_smfmac_f32_32x32x32_bf16 v[80:95], v[232:235], v[152:159], v5
    v_exp_f32 v172, v172
    v_exp_f32 v173, v173
    v_exp_f32 v174, v174
    v_exp_f32 v175, v175
    s_cmp_gt_u32 s64, 2
    s_cbranch_scc1 at_nopf
    buffer_load_dword v15, v2, s[8:11], s78 offen
    buffer_load_dword v15, v2, s[8:11], s78 offen offset:1024
    buffer_load_dword v15, v2, s[8:11], s78 offen offset:2048
    buffer_load_dword v15, v2, s[8:11], s78 offen offset:3072
    s_add_u32 s78, s78, 4096
at_nopf:
    s_add_u32 s64, s64, 1
    s_cmp_lt_u32 s64, 8
    s_cbranch_scc1 at_loop
    s_nop 0
    s_setprio 3
    v_smfmac_f32_32x32x32_bf16 v[96:111], v[228:231], v[160:167], v5
    v_smfmac_f32_32x32x32_bf16 v[96:111], v[232:235], v[168:175], v5
    s_mul_i32 s75, s6, 9
    s_lshl_b32 s56, s60, 1
    s_add_u32 s75, s75, s56
    s_mul_i32 s69, s75, 18432
    s_add_u32 s69, s69, 32111616
    s_add_u32 s59, s69, 28672
    buffer_load_dwordx4 v[160:163], v2, s[24:27], s59 offen offset:2048 sc1
    buffer_load_dwordx4 v[164:167], v2, s[24:27], s59 offen offset:3072 sc1
    s_add_u32 s59, s69, 32768
    buffer_load_dwordx4 v[168:171], v2, s[24:27], s59 offen offset:0 sc1
    buffer_load_dwordx4 v[172:175], v2, s[24:27], s59 offen offset:1024 sc1
    buffer_load_dwordx4 v[176:179], v2, s[24:27], s59 offen offset:2048 sc1
    buffer_load_dwordx4 v[180:183], v2, s[24:27], s59 offen offset:3072 sc1
at_p2:
    ds_read_b32 v8, v14
    s_sub_u32 s91, s91, 1
    s_cmp_lt_i32 s91, 0
    s_cbranch_scc1 at_p2x
    s_waitcnt lgkmcnt(0)
    v_cmp_gt_u32 vcc, 32, v8
    s_cbranch_vccnz at_p2
at_p2x:
    s_waitcnt lgkmcnt(0)
    s_nop 3
    ds_write_b128 v12, v[80:83] offset:0
    ds_write_b128 v12, v[84:87] offset:1024
    ds_write_b128 v12, v[88:91] offset:2048
    ds_write_b128 v12, v[96:99] offset:3072
    ds_write_b128 v12, v[100:103] offset:4096
    ds_write_b128 v12, v[104:107] offset:5120
    v_add_f32 v16, abs(v48), abs(v49)
    v_add_f32 v17, abs(v64), abs(v65)
    v_add_f32 v18, abs(v80), abs(v81)
    v_add_f32 v19, abs(v96), abs(v97)
    v_add_f32 v16, abs(v50), v16
    v_add_f32 v17, abs(v66), v17
    v_add_f32 v18, abs(v82), v18
    v_add_f32 v19, abs(v98), v19
    v_add_f32 v16, abs(v51), v16
    v_add_f32 v17, abs(v67), v17
    v_add_f32 v18, abs(v83), v18
    v_add_f32 v19, abs(v99), v19
    v_add_f32 v16, abs(v52), v16
    v_add_f32 v17, abs(v68), v17
    v_add_f32 v18, abs(v84), v18
    v_add_f32 v19, abs(v100), v19
    v_add_f32 v16, abs(v53), v16
    v_add_f32 v17, abs(v69), v17
    v_add_f32 v18, abs(v85), v18
    v_add_f32 v19, abs(v101), v19
    v_add_f32 v16, abs(v54), v16
    v_add_f32 v17, abs(v70), v17
    v_add_f32 v18, abs(v86), v18
    v_add_f32 v19, abs(v102), v19
    v_add_f32 v16, abs(v55), v16
    v_add_f32 v17, abs(v71), v17
    v_add_f32 v18, abs(v87), v18
    v_add_f32 v19, abs(v103), v19
    v_add_f32 v16, abs(v56), v16
    v_add_f32 v17, abs(v72), v17
    v_add_f32 v18, abs(v88), v18
    v_add_f32 v19, abs(v104), v19
    v_add_f32 v16, abs(v57), v16
    v_add_f32 v17, abs(v73), v17
    v_add_f32 v18, abs(v89), v18
    v_add_f32 v19, abs(v105), v19
    v_min3_f32 v9, v16, v17, v18
    s_cmp_eq_u32 s61, 0
    s_cselect_b32 s58, 0x0b800000, 0
    v_min_f32 v9, v9, v19
    v_cmp_gt_f32 s[70:71], s58, v9
    v_add_f32 v16, abs(v58), v16
    v_add_f32 v17, abs(v74), v17
    v_add_f32 v18, abs(v90), v18
    v_add_f32 v19, abs(v106), v19
    v_add_f32 v16, v16, v17
    v_add_f32 v18, v18, v19
    v_mov_b32 v6, 0x7e000000
    v_add_f32 v16, v16, v18
    v_cmp_nlt_f32 vcc, v16, v6
    s_add_u32 s68, s68, 2
    s_or_b64 vcc, vcc, s[70:71]
    s_cselect_b32 s57, 1, 0
    s_add_u32 s58, s68, s57
    v_mov_b32 v7, s58
    s_waitcnt lgkmcnt(0)
    ds_write_b32 v10, v7
    s_add_u32 s59, s69, 12288
    buffer_load_dwordx4 v[96:99], v2, s[24:27], s59 offen offset:2048 sc1
    buffer_load_dwordx4 v[100:103], v2, s[24:27], s59 offen offset:3072 sc1
    s_add_u32 s59, s69, 16384
    buffer_load_dwordx4 v[104:107], v2, s[24:27], s59 offen offset:0 sc1
    buffer_load_dwordx4 v[108:111], v2, s[24:27], s59 offen offset:1024 sc1
at_xw:
    ds_read_b32 v8, v11
    s_sub_u32 s91, s91, 1
    s_cmp_lt_i32 s91, 0
    s_cbranch_scc1 at_xwx
    s_waitcnt lgkmcnt(0)
    v_cmp_gt_u32 vcc, s68, v8
    s_cbranch_vccnz at_xw
at_xwx:
    s_waitcnt lgkmcnt(0)
    v_readfirstlane_b32 s58, v8
    ds_read_b128 v[112:115], v13 offset:0
    ds_read_b128 v[116:119], v13 offset:1024
    ds_read_b128 v[120:123], v13 offset:2048
    ds_read_b128 v[128:131], v13 offset:3072
    ds_read_b128 v[132:135], v13 offset:4096
    ds_read_b128 v[136:139], v13 offset:5120
    s_cmp_lg_u32 s58, s68
    s_cselect_b32 s57, 1, s57
    s_cmp_eq_u32 s68, 2
    s_cselect_b32 s57, s57, 0
    s_waitcnt lgkmcnt(0)
    s_cmp_eq_u32 s57, 0
    s_cbranch_scc1 at_fin
    s_mov_b32 s65, 32
    s_mov_b32 s66, 0
    s_waitcnt vmcnt(0)
    v_mov_b32 v48, 0
    v_mov_b32 v49, 0
    v_mov_b32 v50, 0
    v_mov_b32 v51, 0
    v_mov_b32 v52, 0
    v_mov_b32 v53, 0
    v_mov_b32 v54, 0
    v_mov_b32 v55, 0
    v_mov_b32 v56, 0
    v_mov_b32 v57, 0
    v_mov_b32 v58, 0
    v_mov_b32 v59, 0
    v_mov_b32 v60, 0
    v_mov_b32 v61, 0
    v_mov_b32 v62, 0
    v_mov_b32 v63, 0
    v_mov_b32 v64, 0
    v_mov_b32 v65, 0
    v_mov_b32 v66, 0
    v_mov_b32 v67, 0
    v_mov_b32 v68, 0
    v_mov_b32 v69, 0
    v_mov_b32 v70, 0
    v_mov_b32 v71, 0
    v_mov_b32 v72, 0
    v_mov_b32 v73, 0
    v_mov_b32 v74, 0
    v_mov_b32 v75, 0
    v_mov_b32 v76, 0
    v_mov_b32 v77, 0
    v_mov_b32 v78, 0
    v_mov_b32 v79, 0
    v_mov_b32 v80, 0
    v_mov_b32 v81, 0
    v_mov_b32 v82, 0
    v_mov_b32 v83, 0
    v_mov_b32 v84, 0
    v_mov_b32 v85, 0
    v_mov_b32 v86, 0
    v_mov_b32 v87, 0
    v_mov_b32 v88, 0
    v_mov_b32 v89, 0
    v_mov_b32 v90, 0
    v_mov_b32 v91, 0
    v_mov_b32 v92, 0
    v_mov_b32 v93, 0
    v_mov_b32 v94, 0
    v_mov_b32 v95, 0
    v_mov_b32 v96, 0
    v_mov_b32 v97, 0
    v_mov_b32 v98, 0
    v_mov_b32 v99, 0
    v_mov_b32 v100, 0
    v_mov_b32 v101, 0
    v_mov_b32 v102, 0
    v_mov_b32 v103, 0
    v_mov_b32 v104, 0
    v_mov_b32 v105, 0
    v_mov_b32 v106, 0
    v_mov_b32 v107, 0
    v_mov_b32 v108, 0
    v_mov_b32 v109, 0
    v_mov_b32 v110, 0
    v_mov_b32 v111, 0
    v_mov_b32 v228, 0
    v_mov_b32 v229, 0
    v_mov_b32 v230, 0
    v_mov_b32 v231, 0
    v_mov_b32 v232, 0
    v_mov_b32 v233, 0
    v_mov_b32 v234, 0
    v_mov_b32 v235, 0
    s_branch at_restart
at_fin:
    v_add_f32 v48, v48, v112
    v_add_f32 v49, v49, v113
    v_add_f32 v50, v50, v114
    v_add_f32 v51, v51, v115
    v_add_f32 v52, v52, v116
    v_add_f32 v53, v53, v117
    v_add_f32 v54, v54, v118
    v_add_f32 v55, v55, v119
    v_add_f32 v56, v56, v120
    v_add_f32 v57, v57, v121
    v_add_f32 v58, v58, v122
    v_add_f32 v64, v64, v128
    v_add_f32 v65, v65, v129
    v_add_f32 v66, v66, v130
    v_add_f32 v67, v67, v131
    v_add_f32 v68, v68, v132
    v_add_f32 v69, v69, v133
    v_add_f32 v70, v70, v134
    v_add_f32 v71, v71, v135
    v_add_f32 v72, v72, v136
    v_add_f32 v73, v73, v137
    v_add_f32 v74, v74, v138
    v_rcp_f32 v58, v58
    v_rcp_f32 v74, v74
    s_nop 0
    v_mov_b32 v59, v58
    v_mov_b32 v75, v74
    s_nop 1
    v_permlane32_swap_b32 v58, v59
    v_permlane32_swap_b32 v74, v75
    s_nop 1
    v_mul_f32 v48, v48, v58
    v_mul_f32 v49, v49, v58
    v_mul_f32 v50, v50, v58
    v_mul_f32 v51, v51, v58
    v_mul_f32 v52, v52, v58
    v_mul_f32 v53, v53, v58
    v_mul_f32 v54, v54, v58
    v_mul_f32 v55, v55, v58
    v_mul_f32 v56, v56, v58
    v_mul_f32 v57, v57, v58
    v_cvt_pk_bf16_f32 v48, v48, v49
    v_cvt_pk_bf16_f32 v49, v50, v51
    v_cvt_pk_bf16_f32 v50, v52, v53
    v_cvt_pk_bf16_f32 v51, v54, v55
    v_cvt_pk_bf16_f32 v52, v56, v57
    v_mul_f32 v64, v64, v74
    v_mul_f32 v65, v65, v74
    v_mul_f32 v66, v66, v74
    v_mul_f32 v67, v67, v74
    v_mul_f32 v68, v68, v74
    v_mul_f32 v69, v69, v74
    v_mul_f32 v70, v70, v74
    v_mul_f32 v71, v71, v74
    v_mul_f32 v72, v72, v74
    v_mul_f32 v73, v73, v74
    v_cvt_pk_bf16_f32 v64, v64, v65
    v_cvt_pk_bf16_f32 v65, v66, v67
    v_cvt_pk_bf16_f32 v66, v68, v69
    v_cvt_pk_bf16_f32 v67, v70, v71
    v_cvt_pk_bf16_f32 v68, v72, v73
    v_lshlrev_b32 v10, 2, v1
    v_add_u32 v10, 150272, v10
    v_mov_b32 v9, 1
    ds_add_u32 v10, v9
    s_lshl_b32 s56, s4, 2
    s_lshl_b32 s58, s61, 1
    s_add_u32 s56, s56, s58
    s_lshl_b32 s57, s56, 5
    s_add_u32 s57, s57, s62
    s_lshl_b32 s57, s57, 7
    s_add_u32 s57, s57, 32775168
    s_mul_i32 s56, s56, 36864
    s_add_u32 s56, s56, 19135488
    s_lshl_b32 s58, s62, 9
    s_add_u32 s56, s56, s58
    v_bfe_u32 v6, v1, 4, 1
    v_mul_u32_u24 v6, 18432, v6
    v_and_b32 v7, 15, v1
    v_lshl_add_u32 v6, v7, 4, v6
    v_lshrrev_b32 v8, 5, v1
    v_lshl_add_u32 v6, v8, 8, v6
    v_lshlrev_b32 v7, 2, v1
    v_lshl_add_u32 v7, v8, 31, v7
    buffer_store_dwordx4 v[48:51], v6, s[24:27], s56 offen sc1
    buffer_store_dword v52, v7, s[24:27], s57 offen sc1
    s_add_u32 s56, s56, 36864
    s_add_u32 s57, s57, 4096
    buffer_store_dwordx4 v[64:67], v6, s[24:27], s56 offen sc1
    buffer_store_dword v68, v7, s[24:27], s57 offen sc1
    s_lshl_b32 s56, s4, 1
    s_add_u32 s57, s56, s61
    s_lshl_b32 s57, s57, 7
    s_add_u32 s57, s57, 33053696
    s_lshr_b32 s58, s7, 1
    s_add_u32 s56, s56, s58
    s_lshl_b32 s56, s56, 7
    s_add_u32 s63, s56, 33053696
    v_mov_b32 v8, 1
    v_mov_b32 v9, 0
    s_mov_b32 s65, s75
    s_add_u32 s59, s69, 16384
    buffer_load_dwordx4 v[112:115], v2, s[24:27], s59 offen offset:2048 sc1
    buffer_load_dwordx4 v[116:119], v2, s[24:27], s59 offen offset:3072 sc1
    s_add_u32 s59, s69, 20480
    buffer_load_dwordx4 v[120:123], v2, s[24:27], s59 offen offset:0 sc1
    buffer_load_dwordx4 v[124:127], v2, s[24:27], s59 offen offset:1024 sc1
    s_waitcnt vmcnt(4)
    s_mov_b64 exec, 1
    buffer_atomic_add v8, v9, s[24:27], s57 offen sc1
    s_mov_b64 exec, -1
    s_setprio 0
    s_add_u32 s59, s69, 20480
    buffer_load_dwordx4 v[128:131], v2, s[24:27], s59 offen offset:2048 sc1
    s_waitcnt vmcnt(4)
    buffer_load_dwordx4 v[132:135], v2, s[24:27], s59 offen offset:3072 sc1
    s_waitcnt vmcnt(4)
    s_add_u32 s59, s69, 24576
    buffer_load_dwordx4 v[136:139], v2, s[24:27], s59 offen offset:0 sc1
    s_waitcnt vmcnt(4)
    buffer_load_dwordx4 v[140:143], v2, s[24:27], s59 offen offset:1024 sc1
    s_waitcnt vmcnt(4)
    buffer_load_dwordx4 v[144:147], v2, s[24:27], s59 offen offset:2048 sc1
    s_waitcnt vmcnt(4)
    buffer_load_dwordx4 v[148:151], v2, s[24:27], s59 offen offset:3072 sc1
    s_waitcnt vmcnt(4)
    s_add_u32 s59, s69, 28672
    buffer_load_dwordx4 v[152:155], v2, s[24:27], s59 offen offset:0 sc1
    s_waitcnt vmcnt(4)
    buffer_load_dwordx4 v[156:159], v2, s[24:27], s59 offen offset:1024 sc1
    s_waitcnt vmcnt(4)
    s_add_u32 s59, s69, 0
    buffer_load_dwordx4 v[40:43], v2, s[24:27], s59 offen offset:0 sc1
    s_waitcnt vmcnt(4)
    buffer_load_dwordx4 v[44:47], v2, s[24:27], s59 offen offset:1024 sc1
    s_waitcnt vmcnt(4)
    buffer_load_dwordx4 v[48:51], v2, s[24:27], s59 offen offset:2048 sc1
    s_waitcnt vmcnt(4)
    buffer_load_dwordx4 v[52:55], v2, s[24:27], s59 offen offset:3072 sc1
    s_waitcnt vmcnt(4)
    s_add_u32 s59, s69, 4096
    buffer_load_dwordx4 v[56:59], v2, s[24:27], s59 offen offset:0 sc1
    s_waitcnt vmcnt(4)
    buffer_load_dwordx4 v[60:63], v2, s[24:27], s59 offen offset:1024 sc1
    s_waitcnt vmcnt(4)
    buffer_load_dwordx4 v[64:67], v2, s[24:27], s59 offen offset:2048 sc1
    s_waitcnt vmcnt(4)
    buffer_load_dwordx4 v[68:71], v2, s[24:27], s59 offen offset:3072 sc1
    s_waitcnt vmcnt(4)
    s_add_u32 s59, s69, 8192
    buffer_load_dwordx4 v[72:75], v2, s[24:27], s59 offen offset:0 sc1
    s_waitcnt vmcnt(4)
    buffer_load_dwordx4 v[76:79], v2, s[24:27], s59 offen offset:1024 sc1
    s_waitcnt vmcnt(4)
    buffer_load_dwordx4 v[80:83], v2, s[24:27], s59 offen offset:2048 sc1
    s_waitcnt vmcnt(4)
    buffer_load_dwordx4 v[84:87], v2, s[24:27], s59 offen offset:3072 sc1
    s_waitcnt vmcnt(4)
    s_add_u32 s59, s69, 12288
    buffer_load_dwordx4 v[88:91], v2, s[24:27], s59 offen offset:0 sc1
    s_waitcnt vmcnt(4)
    buffer_load_dwordx4 v[92:95], v2, s[24:27], s59 offen offset:1024 sc1
    s_waitcnt vmcnt(4)
    s_cmp_lg_u32 s60, 3
    s_cbranch_scc1 at_w2t
    s_add_u32 s59, s69, 36864
    buffer_load_dwordx4 v[184:187], v2, s[24:27], s59 offen offset:0 sc1
    s_waitcnt vmcnt(4)
    buffer_load_dwordx4 v[188:191], v2, s[24:27], s59 offen offset:1024 sc1
    s_waitcnt vmcnt(4)
    buffer_load_dwordx4 v[192:195], v2, s[24:27], s59 offen offset:2048 sc1
    s_waitcnt vmcnt(4)
    buffer_load_dwordx4 v[196:199], v2, s[24:27], s59 offen offset:3072 sc1
    s_waitcnt vmcnt(4)
    s_add_u32 s59, s69, 40960
    buffer_load_dwordx4 v[200:203], v2, s[24:27], s59 offen offset:0 sc1
    s_waitcnt vmcnt(4)
    buffer_load_dwordx4 v[204:207], v2, s[24:27], s59 offen offset:1024 sc1
    s_waitcnt vmcnt(4)
    buffer_load_dwordx4 v[208:211], v2, s[24:27], s59 offen offset:2048 sc1
    s_waitcnt vmcnt(4)
    buffer_load_dwordx4 v[212:215], v2, s[24:27], s59 offen offset:3072 sc1
    s_waitcnt vmcnt(4)
    s_add_u32 s59, s69, 45056
    buffer_load_dwordx4 v[216:219], v2, s[24:27], s59 offen offset:0 sc1
    s_waitcnt vmcnt(4)
    buffer_load_dwordx4 v[220:223], v2, s[24:27], s59 offen offset:1024 sc1
    s_waitcnt vmcnt(4)
    buffer_load_dwordx4 v[224:227], v2, s[24:27], s59 offen offset:2048 sc1
    s_waitcnt vmcnt(4)
    buffer_load_dwordx4 v[228:231], v2, s[24:27], s59 offen offset:3072 sc1
    s_waitcnt vmcnt(4)
    s_add_u32 s59, s69, 49152
    buffer_load_dwordx4 v[232:235], v2, s[24:27], s59 offen offset:0 sc1
    s_waitcnt vmcnt(4)
    buffer_load_dwordx4 v[236:239], v2, s[24:27], s59 offen offset:1024 sc1
    s_waitcnt vmcnt(4)
    buffer_load_dwordx4 v[240:243], v2, s[24:27], s59 offen offset:2048 sc1
    s_waitcnt vmcnt(4)
    buffer_load_dwordx4 v[244:247], v2, s[24:27], s59 offen offset:3072 sc1
    s_waitcnt vmcnt(4)
    s_add_u32 s59, s69, 53248
    buffer_load_dwordx4 v[248:251], v2, s[24:27], s59 offen offset:0 sc1
    s_waitcnt vmcnt(4)
    buffer_load_dwordx4 v[252:255], v2, s[24:27], s59 offen offset:1024 sc1
    s_waitcnt vmcnt(4)
at_w2t:
    v_lshlrev_b32 v6, 2, v1
    v_add_u32 v7, 150016, v6
    s_cmp_lg_u32 s60, 0
    s_cbranch_scc1 at_wo
at_wx:
    s_sleep 4
    ds_read_b32 v8, v10
    s_sub_u32 s91, s91, 16
    s_cmp_lt_i32 s91, 0
    s_cbranch_scc1 at_wxx
    s_waitcnt lgkmcnt(0)
    v_cmp_gt_u32 vcc, 8, v8
    s_cbranch_vccnz at_wx
at_wxx:
at_ocf:
    buffer_load_dword v8, v9, s[24:27], s63 offen sc1
    s_sub_u32 s91, s91, 16
    s_cmp_lt_i32 s91, 0
    s_cbranch_scc1 at_ocfx
    s_waitcnt vmcnt(0)
    v_cmp_gt_u32 vcc, 32, v8
    s_cbranch_vccz at_ocfx
    s_sleep 20
    s_branch at_ocf
at_ocfx:
    v_mov_b32 v8, 2
    ds_write_b32 v7, v8
at_wo:
    s_sleep 4
    ds_read_b32 v8, v7
    s_sub_u32 s91, s91, 16
    s_cmp_lt_i32 s91, 0
    s_cbranch_scc1 at_wox
    s_waitcnt lgkmcnt(0)
    v_cmp_gt_u32 vcc, 2, v8
    s_cbranch_vccnz at_wo
at_wox:
    s_setprio 3
    s_lshl_b32 s58, s4, 2
    s_add_u32 s58, s58, s7
    s_mul_i32 s56, s58, 36864
    s_lshl_b32 s57, s60, 12
    s_add_u32 s56, s56, s57
    s_add_u32 s56, s56, 19135488
    s_lshl_b32 s57, s60, 13
    s_add_u32 s57, s57, 110592
    v_add_u32 v6, 17408, v2
    s_add_u32 m0, s57, 0
    s_nop 0
    buffer_load_dwordx4 v2, s[24:27], s56 offen sc1 lds
    buffer_load_dwordx4 v6, s[24:27], s56 offen offset:1024 sc1 lds
    s_add_u32 s56, s56, 1024
    s_add_u32 m0, s57, 2048
    s_nop 0
    buffer_load_dwordx4 v2, s[24:27], s56 offen sc1 lds
    buffer_load_dwordx4 v6, s[24:27], s56 offen offset:1024 sc1 lds
    s_add_u32 s56, s56, 1024
    s_add_u32 m0, s57, 4096
    s_nop 0
    buffer_load_dwordx4 v2, s[24:27], s56 offen sc1 lds
    buffer_load_dwordx4 v6, s[24:27], s56 offen offset:1024 sc1 lds
    s_add_u32 s56, s56, 1024
    s_add_u32 m0, s57, 6144
    s_nop 0
    buffer_load_dwordx4 v2, s[24:27], s56 offen sc1 lds
    buffer_load_dwordx4 v6, s[24:27], s56 offen offset:1024 sc1 lds
    s_add_u32 s56, s56, 1024
    s_lshl_b32 s57, s60, 10
    s_add_u32 m0, s57, 143360
    s_lshl_b32 s56, s58, 12
    s_add_u32 s56, s56, s57
    s_add_u32 s56, s56, 32775168
    buffer_load_dwordx4 v2, s[24:27], s56 offen sc1 lds
    s_lshl_b32 s63, s58, 2
    s_add_u32 s63, s63, s6
    s_lshl_b32 s63, s63, 6
    s_add_u32 s63, s63, 33037344
    s_mul_i32 s67, s58, 36864
    s_lshl_b32 s56, s65, 5
    s_add_u32 s67, s67, s56
    s_mul_i32 s58, s58, 36
    s_add_u32 s58, s58, s65
    s_lshl_b32 s58, s58, 10
    s_add_u32 s66, s58, 21494784
    v_add_u32 v12, 110592, v2
    v_lshrrev_b32 v6, 4, v1
    v_lshlrev_b32 v6, 9, v6
    v_and_b32 v8, 15, v1
    v_lshl_add_u32 v6, v8, 2, v6
    v_add_u32 v13, 143360, v6
    v_add_u32 v14, 2048, v13
    v_add_u32 v7, 256, v7
    v_mov_b32 v8, 1
    s_waitcnt vmcnt(0)
    ds_add_u32 v7, v8
at_wl:
    ds_read_b32 v8, v7
    s_sub_u32 s91, s91, 1
    s_cmp_lt_i32 s91, 0
    s_cbranch_scc1 at_wlx
    s_waitcnt lgkmcnt(0)
    v_cmp_gt_u32 vcc, 12, v8
    s_cbranch_vccnz at_wl
at_wlx:
    s_waitcnt lgkmcnt(0)
    ds_read_b128 v[32:35], v12 offset:0
    ds_read_b128 v[36:39], v12 offset:1024
    s_waitcnt lgkmcnt(0)
    v_mfma_f32_16x16x32_bf16 v[16:19], v[40:43], v[32:35], 0
    v_mfma_f32_16x16x32_bf16 v[20:23], v[40:43], v[36:39], 0
    v_mfma_f32_16x16x32_bf16 v[24:27], v[112:115], v[32:35], 0
    v_mfma_f32_16x16x32_bf16 v[28:31], v[112:115], v[36:39], 0
    ds_read_b128 v[40:43], v12 offset:2048
    ds_read_b128 v[112:115], v12 offset:3072
    ds_read_b128 v[32:35], v12 offset:4096
    ds_read_b128 v[36:39], v12 offset:5120
    s_waitcnt lgkmcnt(2)
    v_mfma_f32_16x16x32_bf16 v[16:19], v[44:47], v[40:43], v[16:19]
    v_mfma_f32_16x16x32_bf16 v[20:23], v[44:47], v[112:115], v[20:23]
    v_mfma_f32_16x16x32_bf16 v[24:27], v[116:119], v[40:43], v[24:27]
    v_mfma_f32_16x16x32_bf16 v[28:31], v[116:119], v[112:115], v[28:31]
    ds_read_b128 v[44:47], v12 offset:6144
    ds_read_b128 v[116:119], v12 offset:7168
    s_waitcnt lgkmcnt(2)
    v_mfma_f32_16x16x32_bf16 v[16:19], v[48:51], v[32:35], v[16:19]
    v_mfma_f32_16x16x32_bf16 v[20:23], v[48:51], v[36:39], v[20:23]
    v_mfma_f32_16x16x32_bf16 v[24:27], v[120:123], v[32:35], v[24:27]
    v_mfma_f32_16x16x32_bf16 v[28:31], v[120:123], v[36:39], v[28:31]
    ds_read_b128 v[48:51], v12 offset:8192
    ds_read_b128 v[120:123], v12 offset:9216
    ds_read_b128 v[40:43], v12 offset:10240
    ds_read_b128 v[112:115], v12 offset:11264
    ds_read_b128 v[32:35], v12 offset:12288
    ds_read_b128 v[36:39], v12 offset:13312
    s_waitcnt lgkmcnt(6)
    v_mfma_f32_16x16x32_bf16 v[16:19], v[52:55], v[44:47], v[16:19]
    v_mfma_f32_16x16x32_bf16 v[20:23], v[52:55], v[116:119], v[20:23]
    v_mfma_f32_16x16x32_bf16 v[24:27], v[124:127], v[44:47], v[24:27]
    v_mfma_f32_16x16x32_bf16 v[28:31], v[124:127], v[116:119], v[28:31]
    ds_read_b128 v[44:47], v12 offset:14336
    ds_read_b128 v[116:119], v12 offset:15360
    s_waitcnt lgkmcnt(6)
    v_mfma_f32_16x16x32_bf16 v[16:19], v[56:59], v[48:51], v[16:19]
    v_mfma_f32_16x16x32_bf16 v[20:23], v[56:59], v[120:123], v[20:23]
    v_mfma_f32_16x16x32_bf16 v[24:27], v[128:131], v[48:51], v[24:27]
    v_mfma_f32_16x16x32_bf16 v[28:31], v[128:131], v[120:123], v[28:31]
    ds_read_b128 v[48:51], v12 offset:16384
    ds_read_b128 v[120:123], v12 offset:17408
    s_waitcnt lgkmcnt(6)
    v_mfma_f32_16x16x32_bf16 v[16:19], v[60:63], v[40:43], v[16:19]
    v_mfma_f32_16x16x32_bf16 v[20:23], v[60:63], v[112:115], v[20:23]
    v_mfma_f32_16x16x32_bf16 v[24:27], v[132:135], v[40:43], v[24:27]
    v_mfma_f32_16x16x32_bf16 v[28:31], v[132:135], v[112:115], v[28:31]
    ds_read_b128 v[40:43], v12 offset:18432
    ds_read_b128 v[112:115], v12 offset:19456
    s_waitcnt lgkmcnt(6)
    v_mfma_f32_16x16x32_bf16 v[16:19], v[64:67], v[32:35], v[16:19]
    v_mfma_f32_16x16x32_bf16 v[20:23], v[64:67], v[36:39], v[20:23]
    v_mfma_f32_16x16x32_bf16 v[24:27], v[136:139], v[32:35], v[24:27]
    v_mfma_f32_16x16x32_bf16 v[28:31], v[136:139], v[36:39], v[28:31]
    ds_read_b128 v[32:35], v12 offset:20480
    ds_read_b128 v[36:39], v12 offset:21504
    s_waitcnt lgkmcnt(6)
    v_mfma_f32_16x16x32_bf16 v[16:19], v[68:71], v[44:47], v[16:19]
    v_mfma_f32_16x16x32_bf16 v[20:23], v[68:71], v[116:119], v[20:23]
    v_mfma_f32_16x16x32_bf16 v[24:27], v[140:143], v[44:47], v[24:27]
    v_mfma_f32_16x16x32_bf16 v[28:31], v[140:143], v[116:119], v[28:31]
    ds_read_b128 v[44:47], v12 offset:22528
    ds_read_b128 v[116:119], v12 offset:23552
    s_waitcnt lgkmcnt(6)
    v_mfma_f32_16x16x32_bf16 v[16:19], v[72:75], v[48:51], v[16:19]
    v_mfma_f32_16x16x32_bf16 v[20:23], v[72:75], v[120:123], v[20:23]
    v_mfma_f32_16x16x32_bf16 v[24:27], v[144:147], v[48:51], v[24:27]
    v_mfma_f32_16x16x32_bf16 v[28:31], v[144:147], v[120:123], v[28:31]
    ds_read_b128 v[48:51], v12 offset:24576
    ds_read_b128 v[120:123], v12 offset:25600
    s_waitcnt lgkmcnt(6)
    v_mfma_f32_16x16x32_bf16 v[16:19], v[76:79], v[40:43], v[16:19]
    v_mfma_f32_16x16x32_bf16 v[20:23], v[76:79], v[112:115], v[20:23]
    v_mfma_f32_16x16x32_bf16 v[24:27], v[148:151], v[40:43], v[24:27]
    v_mfma_f32_16x16x32_bf16 v[28:31], v[148:151], v[112:115], v[28:31]
    ds_read_b128 v[40:43], v12 offset:26624
    ds_read_b128 v[112:115], v12 offset:27648
    s_waitcnt lgkmcnt(6)
    v_mfma_f32_16x16x32_bf16 v[16:19], v[80:83], v[32:35], v[16:19]
    v_mfma_f32_16x16x32_bf16 v[20:23], v[80:83], v[36:39], v[20:23]
    v_mfma_f32_16x16x32_bf16 v[24:27], v[152:155], v[32:35], v[24:27]
    v_mfma_f32_16x16x32_bf16 v[28:31], v[152:155], v[36:39], v[28:31]
    ds_read_b128 v[32:35], v12 offset:28672
    ds_read_b128 v[36:39], v12 offset:29696
    s_waitcnt lgkmcnt(6)
    v_mfma_f32_16x16x32_bf16 v[16:19], v[84:87], v[44:47], v[16:19]
    v_mfma_f32_16x16x32_bf16 v[20:23], v[84:87], v[116:119], v[20:23]
    v_mfma_f32_16x16x32_bf16 v[24:27], v[156:159], v[44:47], v[24:27]
    v_mfma_f32_16x16x32_bf16 v[28:31], v[156:159], v[116:119], v[28:31]
    ds_read_b128 v[44:47], v12 offset:30720
    ds_read_b128 v[116:119], v12 offset:31744
    s_waitcnt lgkmcnt(6)
    v_mfma_f32_16x16x32_bf16 v[16:19], v[88:91], v[48:51], v[16:19]
    v_mfma_f32_16x16x32_bf16 v[20:23], v[88:91], v[120:123], v[20:23]
    v_mfma_f32_16x16x32_bf16 v[24:27], v[160:163], v[48:51], v[24:27]
    v_mfma_f32_16x16x32_bf16 v[28:31], v[160:163], v[120:123], v[28:31]
    ds_read2_b32 v[48:49], v13 offset0:0 offset1:32
    ds_read2_b32 v[50:51], v13 offset0:64 offset1:96
    ds_read2_b32 v[120:121], v13 offset0:16 offset1:48
    ds_read2_b32 v[122:123], v13 offset0:80 offset1:112
    s_waitcnt lgkmcnt(8)
    v_mfma_f32_16x16x32_bf16 v[16:19], v[92:95], v[40:43], v[16:19]
    v_mfma_f32_16x16x32_bf16 v[20:23], v[92:95], v[112:115], v[20:23]
    v_mfma_f32_16x16x32_bf16 v[24:27], v[164:167], v[40:43], v[24:27]
    v_mfma_f32_16x16x32_bf16 v[28:31], v[164:167], v[112:115], v[28:31]
    ds_read2_b32 v[40:41], v14 offset0:0 offset1:32
    ds_read2_b32 v[42:43], v14 offset0:64 offset1:96
    ds_read2_b32 v[112:113], v14 offset0:16 offset1:48
    ds_read2_b32 v[114:115], v14 offset0:80 offset1:112
    s_waitcnt lgkmcnt(10)
    v_mfma_f32_16x16x32_bf16 v[16:19], v[96:99], v[32:35], v[16:19]
    v_mfma_f32_16x16x32_bf16 v[20:23], v[96:99], v[36:39], v[20:23]
    v_mfma_f32_16x16x32_bf16 v[24:27], v[168:171], v[32:35], v[24:27]
    v_mfma_f32_16x16x32_bf16 v[28:31], v[168:171], v[36:39], v[28:31]
    s_waitcnt lgkmcnt(8)
    v_mfma_f32_16x16x32_bf16 v[16:19], v[100:103], v[44:47], v[16:19]
    v_mfma_f32_16x16x32_bf16 v[20:23], v[100:103], v[116:119], v[20:23]
    v_mfma_f32_16x16x32_bf16 v[24:27], v[172:175], v[44:47], v[24:27]
    v_mfma_f32_16x16x32_bf16 v[28:31], v[172:175], v[116:119], v[28:31]
    s_waitcnt lgkmcnt(4)
    v_mfma_f32_16x16x32_bf16 v[16:19], v[104:107], v[48:51], v[16:19]
    v_mfma_f32_16x16x32_bf16 v[20:23], v[104:107], v[120:123], v[20:23]
    v_mfma_f32_16x16x32_bf16 v[24:27], v[176:179], v[48:51], v[24:27]
    v_mfma_f32_16x16x32_bf16 v[28:31], v[176:179], v[120:123], v[28:31]
    s_waitcnt lgkmcnt(0)
    v_mfma_f32_16x16x32_bf16 v[16:19], v[108:111], v[40:43], v[16:19]
    v_mfma_f32_16x16x32_bf16 v[20:23], v[108:111], v[112:115], v[20:23]
    v_mfma_f32_16x16x32_bf16 v[24:27], v[180:183], v[40:43], v[24:27]
    v_mfma_f32_16x16x32_bf16 v[28:31], v[180:183], v[112:115], v[28:31]
    s_cmp_lg_u32 s60, 3
    s_cbranch_scc1 at_sdone
    ds_read_b128 v[72:75], v12 offset:0
    ds_read_b128 v[76:79], v12 offset:1024
    ds_read_b128 v[80:83], v12 offset:2048
    ds_read_b128 v[84:87], v12 offset:3072
    ds_read_b128 v[88:91], v12 offset:4096
    ds_read_b128 v[92:95], v12 offset:5120
    ds_read_b128 v[96:99], v12 offset:6144
    ds_read_b128 v[100:103], v12 offset:7168
    s_waitcnt lgkmcnt(6)
    v_mfma_f32_16x16x32_bf16 v[32:35], v[184:187], v[72:75], 0
    v_mfma_f32_16x16x32_bf16 v[36:39], v[184:187], v[76:79], 0
    ds_read_b128 v[72:75], v12 offset:8192
    ds_read_b128 v[76:79], v12 offset:9216
    s_waitcnt lgkmcnt(6)
    v_mfma_f32_16x16x32_bf16 v[32:35], v[188:191], v[80:83], v[32:35]
    v_mfma_f32_16x16x32_bf16 v[36:39], v[188:191], v[84:87], v[36:39]
    ds_read_b128 v[80:83], v12 offset:10240
    ds_read_b128 v[84:87], v12 offset:11264
    s_waitcnt lgkmcnt(6)
    v_mfma_f32_16x16x32_bf16 v[32:35], v[192:195], v[88:91], v[32:35]
    v_mfma_f32_16x16x32_bf16 v[36:39], v[192:195], v[92:95], v[36:39]
    ds_read_b128 v[88:91], v12 offset:12288
    ds_read_b128 v[92:95], v12 offset:13312
    s_waitcnt lgkmcnt(6)
    v_mfma_f32_16x16x32_bf16 v[32:35], v[196:199], v[96:99], v[32:35]
    v_mfma_f32_16x16x32_bf16 v[36:39], v[196:199], v[100:103], v[36:39]
    ds_read_b128 v[96:99], v12 offset:14336
    ds_read_b128 v[100:103], v12 offset:15360
    s_waitcnt lgkmcnt(6)
    v_mfma_f32_16x16x32_bf16 v[32:35], v[200:203], v[72:75], v[32:35]
    v_mfma_f32_16x16x32_bf16 v[36:39], v[200:203], v[76:79], v[36:39]
    ds_read_b128 v[72:75], v12 offset:16384
    ds_read_b128 v[76:79], v12 offset:17408
    s_waitcnt lgkmcnt(6)
    v_mfma_f32_16x16x32_bf16 v[32:35], v[204:207], v[80:83], v[32:35]
    v_mfma_f32_16x16x32_bf16 v[36:39], v[204:207], v[84:87], v[36:39]
    ds_read_b128 v[80:83], v12 offset:18432
    ds_read_b128 v[84:87], v12 offset:19456
    s_waitcnt lgkmcnt(6)
    v_mfma_f32_16x16x32_bf16 v[32:35], v[208:211], v[88:91], v[32:35]
    v_mfma_f32_16x16x32_bf16 v[36:39], v[208:211], v[92:95], v[36:39]
    ds_read_b128 v[88:91], v12 offset:20480
    ds_read_b128 v[92:95], v12 offset:21504
    s_waitcnt lgkmcnt(6)
    v_mfma_f32_16x16x32_bf16 v[32:35], v[212:215], v[96:99], v[32:35]
    v_mfma_f32_16x16x32_bf16 v[36:39], v[212:215], v[100:103], v[36:39]
    ds_read_b128 v[96:99], v12 offset:22528
    ds_read_b128 v[100:103], v12 offset:23552
    s_waitcnt lgkmcnt(6)
    v_mfma_f32_16x16x32_bf16 v[32:35], v[216:219], v[72:75], v[32:35]
    v_mfma_f32_16x16x32_bf16 v[36:39], v[216:219], v[76:79], v[36:39]
    ds_read_b128 v[72:75], v12 offset:24576
    ds_read_b128 v[76:79], v12 offset:25600
    s_waitcnt lgkmcnt(6)
    v_mfma_f32_16x16x32_bf16 v[32:35], v[220:223], v[80:83], v[32:35]
    v_mfma_f32_16x16x32_bf16 v[36:39], v[220:223], v[84:87], v[36:39]
    ds_read_b128 v[80:83], v12 offset:26624
    ds_read_b128 v[84:87], v12 offset:27648
    s_waitcnt lgkmcnt(6)
    v_mfma_f32_16x16x32_bf16 v[32:35], v[224:227], v[88:91], v[32:35]
    v_mfma_f32_16x16x32_bf16 v[36:39], v[224:227], v[92:95], v[36:39]
    ds_read_b128 v[88:91], v12 offset:28672
    ds_read_b128 v[92:95], v12 offset:29696
    s_waitcnt lgkmcnt(6)
    v_mfma_f32_16x16x32_bf16 v[32:35], v[228:231], v[96:99], v[32:35]
    v_mfma_f32_16x16x32_bf16 v[36:39], v[228:231], v[100:103], v[36:39]
    ds_read_b128 v[96:99], v12 offset:30720
    ds_read_b128 v[100:103], v12 offset:31744
    s_waitcnt lgkmcnt(6)
    v_mfma_f32_16x16x32_bf16 v[32:35], v[232:235], v[72:75], v[32:35]
    v_mfma_f32_16x16x32_bf16 v[36:39], v[232:235], v[76:79], v[36:39]
    ds_read2_b32 v[72:73], v13 offset0:0 offset1:32
    ds_read2_b32 v[74:75], v13 offset0:64 offset1:96
    ds_read2_b32 v[76:77], v13 offset0:16 offset1:48
    ds_read2_b32 v[78:79], v13 offset0:80 offset1:112
    s_waitcnt lgkmcnt(8)
    v_mfma_f32_16x16x32_bf16 v[32:35], v[236:239], v[80:83], v[32:35]
    v_mfma_f32_16x16x32_bf16 v[36:39], v[236:239], v[84:87], v[36:39]
    ds_read2_b32 v[80:81], v14 offset0:0 offset1:32
    ds_read2_b32 v[82:83], v14 offset0:64 offset1:96
    ds_read2_b32 v[84:85], v14 offset0:16 offset1:48
    ds_read2_b32 v[86:87], v14 offset0:80 offset1:112
    s_waitcnt lgkmcnt(10)
    v_mfma_f32_16x16x32_bf16 v[32:35], v[240:243], v[88:91], v[32:35]
    v_mfma_f32_16x16x32_bf16 v[36:39], v[240:243], v[92:95], v[36:39]
    s_waitcnt lgkmcnt(8)
    v_mfma_f32_16x16x32_bf16 v[32:35], v[244:247], v[96:99], v[32:35]
    v_mfma_f32_16x16x32_bf16 v[36:39], v[244:247], v[100:103], v[36:39]
    s_waitcnt lgkmcnt(4)
    v_mfma_f32_16x16x32_bf16 v[32:35], v[248:251], v[72:75], v[32:35]
    v_mfma_f32_16x16x32_bf16 v[36:39], v[248:251], v[76:79], v[36:39]
    s_waitcnt lgkmcnt(0)
    v_mfma_f32_16x16x32_bf16 v[32:35], v[252:255], v[80:83], v[32:35]
    v_mfma_f32_16x16x32_bf16 v[36:39], v[252:255], v[84:87], v[36:39]
at_sdone:
    s_setprio 0
    s_mov_b32 s12, s32
    s_mov_b32 s13, s33
    s_mov_b32 s14, 2359296
    s_mov_b32 s15, 0x00020000
    s_mov_b32 s16, s50
    s_mov_b32 s17, s51
    s_mov_b32 s18, 2359296
    s_mov_b32 s19, 0x00020000
    v_and_b32 v7, 15, v1
    v_mul_u32_u24 v12, 1152, v7
    v_lshrrev_b32 v7, 4, v1
    v_lshl_add_u32 v12, v7, 3, v12
    v_add_u32 v13, 18432, v12
    s_cmp_eq_u32 s60, 3
    s_cselect_b32 s59, 0, 0x40000000
    s_add_u32 s57, s67, s59
    v_mov_b32 v9, 0
    buffer_load_dwordx2 v[48:49], v12, s[12:15], s67 offen offset:0
    buffer_load_dwordx2 v[50:51], v13, s[12:15], s67 offen offset:0
    buffer_load_dwordx2 v[120:121], v12, s[12:15], s67 offen offset:32
    buffer_load_dwordx2 v[122:123], v13, s[12:15], s67 offen offset:32
    buffer_load_dwordx2 v[192:193], v12, s[12:15], s57 offen offset:64
    buffer_load_dwordx2 v[194:195], v13, s[12:15], s57 offen offset:64
    v_and_b32 v7, 3, v1
    v_lshlrev_b32 v7, 8, v7
    v_lshl_add_u32 v7, v1, 2, v7
    v_add_u32 v7, 147456, v7
    s_add_u32 s70, s66, 0
    s_add_u32 s71, s66, 2359296
    s_add_u32 s72, s66, 4718592
    s_add_u32 s73, s66, 7077888
at_wge:
    s_sleep 4
    ds_read_b32 v8, v7
    s_sub_u32 s91, s91, 16
    s_cmp_lt_i32 s91, 0
    s_cbranch_scc1 at_wgex
    s_waitcnt lgkmcnt(0)
    v_cmp_gt_u32 vcc, 50, v8
    s_cbranch_vccnz at_wge
at_wgex:
at_pcf:
    buffer_load_dword v8, v9, s[24:27], s63 offen sc1
    s_sub_u32 s91, s91, 16
    s_cmp_lt_i32 s91, 0
    s_cbranch_scc1 at_pcfx
    s_waitcnt vmcnt(0)
    v_cmp_ne_u32 vcc, 4, v8
    s_cbranch_vccz at_pcfx
    s_sleep 6
    s_branch at_pcf
at_pcfx:
    buffer_load_dwordx4 v[56:59], v2, s[24:27], s70 offen offset:0 sc1
    buffer_load_dwordx4 v[60:63], v2, s[24:27], s71 offen offset:0 sc1
    buffer_load_dwordx4 v[64:67], v2, s[24:27], s72 offen offset:0 sc1
    buffer_load_dwordx4 v[68:71], v2, s[24:27], s73 offen offset:0 sc1
    buffer_load_dwordx4 v[128:131], v2, s[24:27], s70 offen offset:1024 sc1
    s_add_u32 s70, s70, s59
    buffer_load_dwordx4 v[132:135], v2, s[24:27], s71 offen offset:1024 sc1
    s_add_u32 s71, s71, s59
    buffer_load_dwordx4 v[136:139], v2, s[24:27], s72 offen offset:1024 sc1
    s_add_u32 s72, s72, s59
    buffer_load_dwordx4 v[140:143], v2, s[24:27], s73 offen offset:1024 sc1
    s_add_u32 s73, s73, s59
    buffer_load_dwordx4 v[200:203], v2, s[24:27], s70 offen offset:2048 sc1
    buffer_load_dwordx4 v[204:207], v2, s[24:27], s71 offen offset:2048 sc1
    buffer_load_dwordx4 v[208:211], v2, s[24:27], s72 offen offset:2048 sc1
    buffer_load_dwordx4 v[212:215], v2, s[24:27], s73 offen offset:2048 sc1
    s_waitcnt vmcnt(11)
    v_lshlrev_b32 v72, 16, v56
    v_and_b32 v73, 0xffff0000, v56
    v_lshlrev_b32 v74, 16, v57
    v_and_b32 v75, 0xffff0000, v57
    v_lshlrev_b32 v76, 16, v58
    v_and_b32 v77, 0xffff0000, v58
    v_lshlrev_b32 v78, 16, v59
    v_and_b32 v79, 0xffff0000, v59
    s_waitcnt vmcnt(10)
    v_lshlrev_b32 v80, 16, v60
    v_and_b32 v81, 0xffff0000, v60
    v_lshlrev_b32 v82, 16, v61
    v_and_b32 v83, 0xffff0000, v61
    v_lshlrev_b32 v84, 16, v62
    v_and_b32 v85, 0xffff0000, v62
    v_lshlrev_b32 v86, 16, v63
    v_and_b32 v87, 0xffff0000, v63
    v_add_f32 v72, v72, v80
    v_add_f32 v73, v73, v81
    v_add_f32 v74, v74, v82
    v_add_f32 v75, v75, v83
    v_add_f32 v76, v76, v84
    v_add_f32 v77, v77, v85
    v_add_f32 v78, v78, v86
    v_add_f32 v79, v79, v87
    s_waitcnt vmcnt(9)
    v_lshlrev_b32 v80, 16, v64
    v_and_b32 v81, 0xffff0000, v64
    v_lshlrev_b32 v82, 16, v65
    v_and_b32 v83, 0xffff0000, v65
    v_lshlrev_b32 v84, 16, v66
    v_and_b32 v85, 0xffff0000, v66
    v_lshlrev_b32 v86, 16, v67
    v_and_b32 v87, 0xffff0000, v67
    v_add_f32 v72, v72, v80
    v_add_f32 v73, v73, v81
    v_add_f32 v74, v74, v82
    v_add_f32 v75, v75, v83
    v_add_f32 v76, v76, v84
    v_add_f32 v77, v77, v85
    v_add_f32 v78, v78, v86
    v_add_f32 v79, v79, v87
    s_waitcnt vmcnt(8)
    v_lshlrev_b32 v80, 16, v68
    v_and_b32 v81, 0xffff0000, v68
    v_lshlrev_b32 v82, 16, v69
    v_and_b32 v83, 0xffff0000, v69
    v_lshlrev_b32 v84, 16, v70
    v_and_b32 v85, 0xffff0000, v70
    v_lshlrev_b32 v86, 16, v71
    v_and_b32 v87, 0xffff0000, v71
    v_add_f32 v72, v72, v80
    v_add_f32 v73, v73, v81
    v_add_f32 v74, v74, v82
    v_add_f32 v75, v75, v83
    v_add_f32 v76, v76, v84
    v_add_f32 v77, v77, v85
    v_add_f32 v78, v78, v86
    v_add_f32 v79, v79, v87
    v_mul_f32 v80, 0xbfb8aa3b, v72
    v_mul_f32 v81, 0xbfb8aa3b, v73
    v_mul_f32 v82, 0xbfb8aa3b, v74
    v_mul_f32 v83, 0xbfb8aa3b, v75
    v_mul_f32 v84, 0xbfb8aa3b, v76
    v_mul_f32 v85, 0xbfb8aa3b, v77
    v_mul_f32 v86, 0xbfb8aa3b, v78
    v_mul_f32 v87, 0xbfb8aa3b, v79
    v_exp_f32 v80, v80
    v_exp_f32 v81, v81
    v_exp_f32 v82, v82
    v_exp_f32 v83, v83
    v_exp_f32 v84, v84
    v_exp_f32 v85, v85
    v_exp_f32 v86, v86
    v_exp_f32 v87, v87
    v_lshlrev_b32 v88, 16, v48
    v_and_b32 v89, 0xffff0000, v48
    v_lshlrev_b32 v90, 16, v49
    v_and_b32 v91, 0xffff0000, v49
    v_lshlrev_b32 v92, 16, v50
    v_and_b32 v93, 0xffff0000, v50
    v_lshlrev_b32 v94, 16, v51
    v_and_b32 v95, 0xffff0000, v51
    v_add_f32 v80, 1.0, v80
    v_add_f32 v81, 1.0, v81
    v_add_f32 v82, 1.0, v82
    v_add_f32 v83, 1.0, v83
    v_add_f32 v84, 1.0, v84
    v_add_f32 v85, 1.0, v85
    v_add_f32 v86, 1.0, v86
    v_add_f32 v87, 1.0, v87
    v_rcp_f32 v80, v80
    v_rcp_f32 v81, v81
    v_rcp_f32 v82, v82
    v_rcp_f32 v83, v83
    v_rcp_f32 v84, v84
    v_rcp_f32 v85, v85
    v_rcp_f32 v86, v86
    v_rcp_f32 v87, v87
    v_mul_f32 v72, v72, v16
    v_mul_f32 v73, v73, v17
    v_mul_f32 v74, v74, v18
    v_mul_f32 v75, v75, v19
    v_mul_f32 v76, v76, v20
    v_mul_f32 v77, v77, v21
    v_mul_f32 v78, v78, v22
    v_mul_f32 v79, v79, v23
    v_fma_f32 v88, v72, v80, v88
    v_fma_f32 v89, v73, v81, v89
    v_fma_f32 v90, v74, v82, v90
    v_fma_f32 v91, v75, v83, v91
    v_fma_f32 v92, v76, v84, v92
    v_fma_f32 v93, v77, v85, v93
    v_fma_f32 v94, v78, v86, v94
    v_fma_f32 v95, v79, v87, v95
    v_cvt_pk_bf16_f32 v80, v88, v89
    v_cvt_pk_bf16_f32 v81, v90, v91
    v_cvt_pk_bf16_f32 v82, v92, v93
    v_cvt_pk_bf16_f32 v83, v94, v95
    buffer_store_dwordx2 v[80:81], v12, s[16:19], s67 offen offset:0
    buffer_store_dwordx2 v[82:83], v13, s[16:19], s67 offen offset:0
    s_waitcnt vmcnt(9)
    v_lshlrev_b32 v144, 16, v128
    v_and_b32 v145, 0xffff0000, v128
    v_lshlrev_b32 v146, 16, v129
    v_and_b32 v147, 0xffff0000, v129
    v_lshlrev_b32 v148, 16, v130
    v_and_b32 v149, 0xffff0000, v130
    v_lshlrev_b32 v150, 16, v131
    v_and_b32 v151, 0xffff0000, v131
    s_waitcnt vmcnt(8)
    v_lshlrev_b32 v152, 16, v132
    v_and_b32 v153, 0xffff0000, v132
    v_lshlrev_b32 v154, 16, v133
    v_and_b32 v155, 0xffff0000, v133
    v_lshlrev_b32 v156, 16, v134
    v_and_b32 v157, 0xffff0000, v134
    v_lshlrev_b32 v158, 16, v135
    v_and_b32 v159, 0xffff0000, v135
    v_add_f32 v144, v144, v152
    v_add_f32 v145, v145, v153
    v_add_f32 v146, v146, v154
    v_add_f32 v147, v147, v155
    v_add_f32 v148, v148, v156
    v_add_f32 v149, v149, v157
    v_add_f32 v150, v150, v158
    v_add_f32 v151, v151, v159
    s_waitcnt vmcnt(7)
    v_lshlrev_b32 v152, 16, v136
    v_and_b32 v153, 0xffff0000, v136
    v_lshlrev_b32 v154, 16, v137
    v_and_b32 v155, 0xffff0000, v137
    v_lshlrev_b32 v156, 16, v138
    v_and_b32 v157, 0xffff0000, v138
    v_lshlrev_b32 v158, 16, v139
    v_and_b32 v159, 0xffff0000, v139
    v_add_f32 v144, v144, v152
    v_add_f32 v145, v145, v153
    v_add_f32 v146, v146, v154
    v_add_f32 v147, v147, v155
    v_add_f32 v148, v148, v156
    v_add_f32 v149, v149, v157
    v_add_f32 v150, v150, v158
    v_add_f32 v151, v151, v159
    s_waitcnt vmcnt(6)
    v_lshlrev_b32 v152, 16, v140
    v_and_b32 v153, 0xffff0000, v140
    v_lshlrev_b32 v154, 16, v141
    v_and_b32 v155, 0xffff0000, v141
    v_lshlrev_b32 v156, 16, v142
    v_and_b32 v157, 0xffff0000, v142
    v_lshlrev_b32 v158, 16, v143
    v_and_b32 v159, 0xffff0000, v143
    v_add_f32 v144, v144, v152
    v_add_f32 v145, v145, v153
    v_add_f32 v146, v146, v154
    v_add_f32 v147, v147, v155
    v_add_f32 v148, v148, v156
    v_add_f32 v149, v149, v157
    v_add_f32 v150, v150, v158
    v_add_f32 v151, v151, v159
    v_mul_f32 v152, 0xbfb8aa3b, v144
    v_mul_f32 v153, 0xbfb8aa3b, v145
    v_mul_f32 v154, 0xbfb8aa3b, v146
    v_mul_f32 v155, 0xbfb8aa3b, v147
    v_mul_f32 v156, 0xbfb8aa3b, v148
    v_mul_f32 v157, 0xbfb8aa3b, v149
    v_mul_f32 v158, 0xbfb8aa3b, v150
    v_mul_f32 v159, 0xbfb8aa3b, v151
    v_exp_f32 v152, v152
    v_exp_f32 v153, v153
    v_exp_f32 v154, v154
    v_exp_f32 v155, v155
    v_exp_f32 v156, v156
    v_exp_f32 v157, v157
    v_exp_f32 v158, v158
    v_exp_f32 v159, v159
    v_lshlrev_b32 v160, 16, v120
    v_and_b32 v161, 0xffff0000, v120
    v_lshlrev_b32 v162, 16, v121
    v_and_b32 v163, 0xffff0000, v121
    v_lshlrev_b32 v164, 16, v122
    v_and_b32 v165, 0xffff0000, v122
    v_lshlrev_b32 v166, 16, v123
    v_and_b32 v167, 0xffff0000, v123
    v_add_f32 v152, 1.0, v152
    v_add_f32 v153, 1.0, v153
    v_add_f32 v154, 1.0, v154
    v_add_f32 v155, 1.0, v155
    v_add_f32 v156, 1.0, v156
    v_add_f32 v157, 1.0, v157
    v_add_f32 v158, 1.0, v158
    v_add_f32 v159, 1.0, v159
    v_rcp_f32 v152, v152
    v_rcp_f32 v153, v153
    v_rcp_f32 v154, v154
    v_rcp_f32 v155, v155
    v_rcp_f32 v156, v156
    v_rcp_f32 v157, v157
    v_rcp_f32 v158, v158
    v_rcp_f32 v159, v159
    v_mul_f32 v144, v144, v24
    v_mul_f32 v145, v145, v25
    v_mul_f32 v146, v146, v26
    v_mul_f32 v147, v147, v27
    v_mul_f32 v148, v148, v28
    v_mul_f32 v149, v149, v29
    v_mul_f32 v150, v150, v30
    v_mul_f32 v151, v151, v31
    v_fma_f32 v160, v144, v152, v160
    v_fma_f32 v161, v145, v153, v161
    v_fma_f32 v162, v146, v154, v162
    v_fma_f32 v163, v147, v155, v163
    v_fma_f32 v164, v148, v156, v164
    v_fma_f32 v165, v149, v157, v165
    v_fma_f32 v166, v150, v158, v166
    v_fma_f32 v167, v151, v159, v167
    v_cvt_pk_bf16_f32 v152, v160, v161
    v_cvt_pk_bf16_f32 v153, v162, v163
    v_cvt_pk_bf16_f32 v154, v164, v165
    v_cvt_pk_bf16_f32 v155, v166, v167
    buffer_store_dwordx2 v[152:153], v12, s[16:19], s67 offen offset:32
    buffer_store_dwordx2 v[154:155], v13, s[16:19], s67 offen offset:32
    s_cmp_lg_u32 s60, 3
    s_cbranch_scc1 at_odone
    s_waitcnt vmcnt(7)
    v_lshlrev_b32 v216, 16, v200
    v_and_b32 v217, 0xffff0000, v200
    v_lshlrev_b32 v218, 16, v201
    v_and_b32 v219, 0xffff0000, v201
    v_lshlrev_b32 v220, 16, v202
    v_and_b32 v221, 0xffff0000, v202
    v_lshlrev_b32 v222, 16, v203
    v_and_b32 v223, 0xffff0000, v203
    s_waitcnt vmcnt(6)
    v_lshlrev_b32 v224, 16, v204
    v_and_b32 v225, 0xffff0000, v204
    v_lshlrev_b32 v226, 16, v205
    v_and_b32 v227, 0xffff0000, v205
    v_lshlrev_b32 v228, 16, v206
    v_and_b32 v229, 0xffff0000, v206
    v_lshlrev_b32 v230, 16, v207
    v_and_b32 v231, 0xffff0000, v207
    v_add_f32 v216, v216, v224
    v_add_f32 v217, v217, v225
    v_add_f32 v218, v218, v226
    v_add_f32 v219, v219, v227
    v_add_f32 v220, v220, v228
    v_add_f32 v221, v221, v229
    v_add_f32 v222, v222, v230
    v_add_f32 v223, v223, v231
    s_waitcnt vmcnt(5)
    v_lshlrev_b32 v224, 16, v208
    v_and_b32 v225, 0xffff0000, v208
    v_lshlrev_b32 v226, 16, v209
    v_and_b32 v227, 0xffff0000, v209
    v_lshlrev_b32 v228, 16, v210
    v_and_b32 v229, 0xffff0000, v210
    v_lshlrev_b32 v230, 16, v211
    v_and_b32 v231, 0xffff0000, v211
    v_add_f32 v216, v216, v224
    v_add_f32 v217, v217, v225
    v_add_f32 v218, v218, v226
    v_add_f32 v219, v219, v227
    v_add_f32 v220, v220, v228
    v_add_f32 v221, v221, v229
    v_add_f32 v222, v222, v230
    v_add_f32 v223, v223, v231
    s_waitcnt vmcnt(4)
    v_lshlrev_b32 v224, 16, v212
    v_and_b32 v225, 0xffff0000, v212
    v_lshlrev_b32 v226, 16, v213
    v_and_b32 v227, 0xffff0000, v213
    v_lshlrev_b32 v228, 16, v214
    v_and_b32 v229, 0xffff0000, v214
    v_lshlrev_b32 v230, 16, v215
    v_and_b32 v231, 0xffff0000, v215
    v_add_f32 v216, v216, v224
    v_add_f32 v217, v217, v225
    v_add_f32 v218, v218, v226
    v_add_f32 v219, v219, v227
    v_add_f32 v220, v220, v228
    v_add_f32 v221, v221, v229
    v_add_f32 v222, v222, v230
    v_add_f32 v223, v223, v231
    v_mul_f32 v224, 0xbfb8aa3b, v216
    v_mul_f32 v225, 0xbfb8aa3b, v217
    v_mul_f32 v226, 0xbfb8aa3b, v218
    v_mul_f32 v227, 0xbfb8aa3b, v219
    v_mul_f32 v228, 0xbfb8aa3b, v220
    v_mul_f32 v229, 0xbfb8aa3b, v221
    v_mul_f32 v230, 0xbfb8aa3b, v222
    v_mul_f32 v231, 0xbfb8aa3b, v223
    v_exp_f32 v224, v224
    v_exp_f32 v225, v225
    v_exp_f32 v226, v226
    v_exp_f32 v227, v227
    v_exp_f32 v228, v228
    v_exp_f32 v229, v229
    v_exp_f32 v230, v230
    v_exp_f32 v231, v231
    v_lshlrev_b32 v232, 16, v192
    v_and_b32 v233, 0xffff0000, v192
    v_lshlrev_b32 v234, 16, v193
    v_and_b32 v235, 0xffff0000, v193
    v_lshlrev_b32 v236, 16, v194
    v_and_b32 v237, 0xffff0000, v194
    v_lshlrev_b32 v238, 16, v195
    v_and_b32 v239, 0xffff0000, v195
    v_add_f32 v224, 1.0, v224
    v_add_f32 v225, 1.0, v225
    v_add_f32 v226, 1.0, v226
    v_add_f32 v227, 1.0, v227
    v_add_f32 v228, 1.0, v228
    v_add_f32 v229, 1.0, v229
    v_add_f32 v230, 1.0, v230
    v_add_f32 v231, 1.0, v231
    v_rcp_f32 v224, v224
    v_rcp_f32 v225, v225
    v_rcp_f32 v226, v226
    v_rcp_f32 v227, v227
    v_rcp_f32 v228, v228
    v_rcp_f32 v229, v229
    v_rcp_f32 v230, v230
    v_rcp_f32 v231, v231
    v_mul_f32 v216, v216, v32
    v_mul_f32 v217, v217, v33
    v_mul_f32 v218, v218, v34
    v_mul_f32 v219, v219, v35
    v_mul_f32 v220, v220, v36
    v_mul_f32 v221, v221, v37
    v_mul_f32 v222, v222, v38
    v_mul_f32 v223, v223, v39
    v_fma_f32 v232, v216, v224, v232
    v_fma_f32 v233, v217, v225, v233
    v_fma_f32 v234, v218, v226, v234
    v_fma_f32 v235, v219, v227, v235
    v_fma_f32 v236, v220, v228, v236
    v_fma_f32 v237, v221, v229, v237
    v_fma_f32 v238, v222, v230, v238
    v_fma_f32 v239, v223, v231, v239
    v_cvt_pk_bf16_f32 v224, v232, v233
    v_cvt_pk_bf16_f32 v225, v234, v235
    v_cvt_pk_bf16_f32 v226, v236, v237
    v_cvt_pk_bf16_f32 v227, v238, v239
    buffer_store_dwordx2 v[224:225], v12, s[16:19], s67 offen offset:64
    buffer_store_dwordx2 v[226:227], v13, s[16:19], s67 offen offset:64
at_odone:
recurrent_scan__grouped_kv_mqa__glu_gated_swiglu__prompt_kernel_end:
    s_endpgm
code_end:
.section .rodata,"a"
.p2align 6
.amdhsa_kernel recurrent_scan__grouped_kv_mqa__glu_gated_swiglu__prompt_kernel
  .amdhsa_next_free_vgpr 256
  .amdhsa_next_free_sgpr 102
  .amdhsa_accum_offset 256
  .amdhsa_group_segment_fixed_size 0
  .amdhsa_kernarg_size 96
  .amdhsa_user_sgpr_count 2
  .amdhsa_user_sgpr_kernarg_segment_ptr 1
  .amdhsa_system_sgpr_workgroup_id_x 1
.end_amdhsa_kernel
```
